```python
import torch

def _softmax(x, axis=-1):
    return torch.softmax(x, dim=axis)
def _gelu(x):
    return torch.nn.functional.gelu(x, approximate="tanh")
def _silu(x):
    return torch.nn.functional.silu(x)
def _sigmoid(x):
    return torch.sigmoid(x)
def _layernorm(x, axis=-1, eps=1e-5):
    m = x.mean(dim=axis, keepdim=True)
    v = x.var(dim=axis, keepdim=True, unbiased=False)
    return (x - m) / torch.sqrt(v + eps)
def _scatter_add(tgt, idx, src, axis=0):
    return tgt.clone().index_add_(axis, idx, src)
def _segment_sum(src, seg, n):
    out = torch.zeros((n,) + src.shape[1:], dtype=src.dtype)
    return out.index_add_(0, seg, src)
def _pad(x, pw):
    flat = tuple(v for pair in reversed(pw) for v in pair)
    return torch.nn.functional.pad(x, flat)

kernel_name = 'gated_mix__sliding_local_dilated__swiglu_ffn__prompt'

def setup_inputs():

    _w = (lambda a: (lambda t: t.to(torch.bfloat16) if t.is_floating_point() else t)(torch.as_tensor(a)))
    def _A_setup():
        B, S, D = 1, 2048, 640
        return {
            "x": _w((lambda *s: torch.randn(*s, dtype=torch.bfloat16) * 0.05)(B, S, D)),
            "wqkv": _w((lambda *s: torch.randn(*s, dtype=torch.bfloat16) * 0.8)(D, 3 * D)),
            "wo": _w((lambda *s: torch.randn(*s, dtype=torch.bfloat16) * 0.05)(D, D)),
        }
    _A_in = _A_setup()

    def _B_setup():
        B, S, D, F = 1, 2048, 640, 1536
        return {
            "x": _w((lambda *s: torch.randn(*s, dtype=torch.bfloat16) * 0.05)(B, S, D)),
            "w_gate": _w((lambda *s: torch.randn(*s, dtype=torch.bfloat16) * 0.2)(D, F)),
            "w_up": _w((lambda *s: torch.randn(*s, dtype=torch.bfloat16) * 0.2)(D, F)),
            "w_down": _w((lambda *s: torch.randn(*s, dtype=torch.bfloat16) * 0.2)(F, D)),
        }
    _B_in = _B_setup()

    return {
        "A_x": _A_in["x"],
        "A_wqkv": _A_in["wqkv"],
        "A_wo": _A_in["wo"],
        "B_x": _B_in["x"],
        "B_w_gate": _B_in["w_gate"],
        "B_w_up": _B_in["w_up"],
        "B_w_down": _B_in["w_down"],
        "gate_w": _w((lambda *s: torch.randn(*s, dtype=torch.bfloat16) * 0.05)(640) * 16.0),
    }

def reference(A_x, A_wqkv, A_wo, B_x, B_w_gate, B_w_up, B_w_down, gate_w):
    def _A_ref(x, wqkv, wo):
        B, S, D = x.shape
        H = 32; Dh = D // H
        W, dil = 8, 2
        qkv = (lambda x, *d: x.permute(*d))((x @ wqkv).reshape(B, S, 3, H, Dh), 2, 0, 3, 1, 4)
        q, k, v = qkv[0], qkv[1], qkv[2]
        scale = Dh ** -0.5
        pos = torch.arange(S)
        off = torch.arange(W) * dil
        idx = pos[:, None] - off[None, :]
        mask = idx >= 0
        idx_c = torch.where(mask, idx, 0).reshape(-1)
        kg = k[:, :, idx_c, :].reshape(B, H, S, W, Dh)
        vg = v[:, :, idx_c, :].reshape(B, H, S, W, Dh)
        logits = torch.einsum("bhsd,bhswd->bhsw", q, kg) * scale
        logits = torch.where(mask[None, None, :, :], logits, -1e9)
        attn = _softmax(logits, axis=-1)
        o = torch.einsum("bhsw,bhswd->bhsd", attn, vg)
        return (lambda x, *d: x.permute(*d))(o, 0, 2, 1, 3).reshape(B, S, D) @ wo

    def _B_ref(x, w_gate, w_up, w_down):
        g = _silu(x @ w_gate)
        u = x @ w_up
        return (g * u) @ w_down

    x = A_x
    g = _sigmoid((x * gate_w).sum(-1, keepdims=True))
    a = _A_ref(x, A_wqkv, A_wo)
    b = _B_ref(x, B_w_gate, B_w_up, B_w_down)
    return g * a + (1 - g) * b
```

```asm
; @launch grid=(256,1,1) block=(256,1,1) lds=163840
.amdgcn_target "amdgcn-amd-amdhsa--gfx950"
.text
.globl gated_mix__sliding_local_dilated__swiglu_ffn__prompt_kernel
.p2align 8
.type gated_mix__sliding_local_dilated__swiglu_ffn__prompt_kernel,@function
gated_mix__sliding_local_dilated__swiglu_ffn__prompt_kernel:
    s_cmp_ge_u32 s2, 256
    s_cbranch_scc1 L_exit
    s_load_dwordx16 s[4:19], s[0:1], 0
    s_load_dwordx2 s[20:21], s[0:1], 80
    s_load_dwordx2 s[22:23], s[0:1], 72
    s_load_dwordx2 s[82:83], s[0:1], 64
    s_getpc_b64 s[46:47]
    s_lshr_b32 s3, s2, 3
    s_mul_i32 s3, s3, 2560
    v_lshrrev_b32 v1, 6, v0
    v_mul_u32_u24 v2, 640, v1
    v_and_b32 v3, 7, v0
    v_min_u32 v3, 4, v3
    v_lshl_add_u32 v2, v3, 7, v2
    v_add_u32_e64 v2, s3, v2
    v_min_u32 v2, CODE_END - gated_mix__sliding_local_dilated__swiglu_ffn__prompt_kernel - 128, v2
    global_load_dword v4, v2, s[46:47]
    v_and_b32 v185, 63, v0
    s_and_b32 s3, s2, 7
    v_readfirstlane_b32 s44, v1
    s_lshr_b32 s53, s2, 3
    s_and_b32 s54, s3, 1
    s_lshr_b32 s3, s3, 1
    s_mul_i32 s51, s54, 3
    s_sub_u32 s51, 18, s51
    s_cmp_lt_u32 s53, s51
    s_cbranch_scc1 L_F
    s_sub_u32 s53, s53, s51
    s_and_b32 s80, s53, 1
    s_lshl_b32 s52, s3, 1
    s_add_u32 s80, s80, s52
    s_lshr_b32 s81, s53, 1
    s_mul_i32 s52, s54, 7
    s_add_u32 s81, s81, s52
    s_cmp_ge_u32 s81, 13
    s_cbranch_scc1 L_P
    v_mov_b32 v255, v185
    s_lshl_b32 s52, s44, 2
    v_lshrrev_b32 v254, 4, v255
    v_add_u32 v254, s52, v254
    v_xor_b32 v254, v254, v255
    v_and_b32 v254, 7, v254
    v_lshlrev_b32 v254, 4, v254
    v_lshrrev_b32_e64 v253, 3, v255
    v_mul_u32_u24 v253, 1280, v253
    v_add_u32_e64 v229, v254, v253
    s_mul_i32 s46, s81, 160
    s_lshl_b32 s52, s44, 3
    s_add_u32 s46, s46, s52
    s_sub_u32 s46, s46, 16
    s_mul_i32 s46, s46, 1280
    s_max_i32 s49, s46, 0
    s_lshl_b32 s48, s44, 10
    s_add_u32 s48, s48, 79104
    s_and_b32 s52, s44, 1
    s_mul_i32 s50, s52, 13680
    v_lshrrev_b32_e64 v254, 2, v255
    v_mul_u32_u24 v254, 171, v254
    v_lshlrev_b32 v239, 4, v255
    s_movk_i32 s60, 1088
    v_add_u32 v253, s50, v254
    v_lshrrev_b32 v224, 9, v253
    v_mad_u32_u24 v224, v224, s60, v239
    v_add_u32 v225, 2736, v253
    v_lshrrev_b32_e64 v225, 9, v225
    v_mad_u32_u24 v225, v225, s60, v239
    v_add_u32 v226, 5472, v253
    v_lshrrev_b32_e64 v226, 9, v226
    v_mad_u32_u24 v226, v226, s60, v239
    v_add_u32 v227, 8208, v253
    v_lshrrev_b32_e64 v227, 9, v227
    v_mad_u32_u24 v227, v227, s60, v239
    v_add_u32 v228, 10944, v254
    v_lshrrev_b32_e64 v228, 9, v228
    v_mad_u32_u24 v228, v228, s60, v239
    v_lshrrev_b32_e64 v254, 5, v255
    v_mul_u32_u24 v254, 30720, v254
    v_add_u32 v228, v228, v254
    s_lshr_b32 s59, s44, 1
    s_mul_i32 s45, s59, 30720
    s_mul_i32 s47, s59, 9248
    s_mul_i32 s59, s52, 5120
    s_add_u32 s50, s47, s59
    s_mul_i32 s59, s52, 35840
    s_add_u32 s45, s45, s59
    s_mul_i32 s52, s80, 160
    s_and_b32 s61, s80, 1
    s_lshl_b32 s61, s61, 5
    s_sub_u32 s52, s52, s61
    s_add_u32 s45, s45, s52
    s_waitcnt lgkmcnt(0)
    s_mov_b32 s24, s4
    s_mov_b32 s25, s5
    s_mov_b32 s26, 2621440
    s_mov_b32 s27, 0x20000
    s_mov_b32 s28, s6
    s_mov_b32 s29, s7
    s_mov_b32 s30, 2457600
    s_mov_b32 s31, 0x20000
    s_add_u32 m0, s47, 4096
    s_add_u32 s51, s45, 0xffff8400
    s_bitcmp1_b32 s44, 0
    s_cbranch_scc0 L_sk1
    buffer_load_dwordx4 v228, s[28:31], s51 offen lds
L_sk1:
    s_add_u32 m0, s50, 0
    s_add_u32 s62, s45, 0
    buffer_load_dwordx4 v224, s[28:31], s62 offen offset:0 lds
    buffer_load_dwordx4 v225, s[28:31], s62 offen offset:1024 lds
    buffer_load_dwordx4 v226, s[28:31], s62 offen offset:2048 lds
    buffer_load_dwordx4 v227, s[28:31], s62 offen offset:3072 lds
    s_add_u32 m0, s48, 20480
    s_add_u32 s51, s46, 204800
    s_cmp_lt_u32 s44, 2
    s_cbranch_scc0 L_sk2
    buffer_load_dwordx4 v229, s[24:27], s51 offen lds
L_sk2:
    s_add_u32 m0, s48, 0
    s_add_u32 s51, s49, 0
    buffer_load_dwordx4 v229, s[24:27], s51 offen lds
    s_add_u32 m0, s48, 4096
    s_add_u32 s51, s46, 40960
    buffer_load_dwordx4 v229, s[24:27], s51 offen lds
    s_add_u32 m0, s48, 8192
    s_add_u32 s51, s46, 81920
    buffer_load_dwordx4 v229, s[24:27], s51 offen lds
    s_add_u32 m0, s48, 12288
    s_add_u32 s51, s46, 122880
    buffer_load_dwordx4 v229, s[24:27], s51 offen lds
    s_add_u32 m0, s48, 16384
    s_add_u32 s51, s46, 163840
    buffer_load_dwordx4 v229, s[24:27], s51 offen lds
    s_branch L_Qmain
L_F:
    s_mul_i32 s81, s53, 43
    s_lshr_b32 s81, s81, 7
    s_mul_i32 s52, s81, 3
    s_sub_u32 s80, s53, s52
    s_mul_i32 s52, s3, 3
    s_add_u32 s80, s80, s52
    s_mul_i32 s52, s54, 6
    s_add_u32 s81, s81, s52
    s_lshl_b32 s52, s44, 2
    v_lshrrev_b32 v186, 4, v185
    v_add_u32 v186, s52, v186
    v_xor_b32 v186, v186, v185
    v_and_b32 v186, 7, v186
    v_lshlrev_b32 v186, 4, v186
    v_lshrrev_b32_e64 v187, 3, v185
    v_mul_u32_u24 v187, 1280, v187
    v_add_u32_e64 v183, v186, v187
    s_mul_i32 s46, s81, 192
    s_lshl_b32 s52, s44, 3
    s_add_u32 s46, s46, s52
    s_mul_i32 s46, s46, 1280
    s_lshl_b32 s48, s44, 10
    s_add_u32 s48, s48, 98304
    s_and_b32 s52, s44, 1
    s_lshl_b32 s52, s52, 2
    v_lshrrev_b32 v186, 4, v185
    v_or_b32 v187, s52, v186
    v_lshlrev_b32 v187, 1, v187
    v_xor_b32 v187, v187, v185
    v_and_b32 v187, 15, v187
    v_lshlrev_b32_e64 v187, 4, v187
    v_mul_u32_u24 v186, 3072, v186
    v_add_u32 v182, v186, v187
    s_lshr_b32 s52, s44, 1
    s_mul_i32 s45, s52, 12288
    s_lshl_b32 s61, s80, 8
    s_add_u32 s45, s45, s61
    s_sub_u32 s45, s45, 24576
    s_lshl_b32 s47, s44, 10
    s_waitcnt lgkmcnt(0)
    s_mov_b32 s24, s4
    s_mov_b32 s25, s5
    s_mov_b32 s26, 2621440
    s_mov_b32 s27, 0x20000
    s_and_b32 s52, s44, 1
    s_cmp_eq_u32 s52, 0
    s_cselect_b32 s28, s12, s14
    s_cselect_b32 s29, s13, s15
    s_mov_b32 s30, 1966080
    s_mov_b32 s31, 0x20000
    s_add_u32 m0, s47, 0
    s_add_u32 s45, s45, 24576
    buffer_load_dwordx4 v182, s[28:31], s45 offen lds
    s_add_u32 m0, s47, 4096
    s_add_u32 s45, s45, 24576
    buffer_load_dwordx4 v182, s[28:31], s45 offen lds
    s_add_u32 m0, s48, 0
    s_add_u32 s61, s46, 0
    buffer_load_dwordx4 v183, s[24:27], s61 offen lds
    s_add_u32 m0, s48, 4096
    s_add_u32 s61, s46, 40960
    buffer_load_dwordx4 v183, s[24:27], s61 offen lds
    s_add_u32 m0, s48, 8192
    s_add_u32 s61, s46, 81920
    buffer_load_dwordx4 v183, s[24:27], s61 offen lds
    s_add_u32 m0, s48, 12288
    s_add_u32 s61, s46, 122880
    buffer_load_dwordx4 v183, s[24:27], s61 offen lds
    s_add_u32 m0, s47, 8192
    s_add_u32 s45, s45, 24576
    buffer_load_dwordx4 v182, s[28:31], s45 offen lds
    s_add_u32 m0, s47, 12288
    s_add_u32 s45, s45, 24576
    buffer_load_dwordx4 v182, s[28:31], s45 offen lds
    s_branch L_Fmain
L_P:
    s_sub_u32 s80, s53, 12
    s_lshl_b32 s80, s80, 2
    s_add_u32 s80, s80, s3
    v_add_u32 v186, 0, v185
    v_mul_u32_u24 v189, 205, v186
    v_lshrrev_b32 v189, 13, v189
    v_mul_u32_u24 v176, 40, v189
    v_sub_u32 v176, v186, v176
    v_lshlrev_b32 v176, 4, v176
    v_and_b32_e64 v186, 3, v189
    v_mul_u32_u24 v186, 1280, v186
    v_add_u32 v176, v176, v186
    v_lshrrev_b32 v160, 2, v189
    v_add_u32_e64 v186, 64, v185
    v_mul_u32_u24 v189, 205, v186
    v_lshrrev_b32 v189, 13, v189
    v_mul_u32_u24 v177, 40, v189
    v_sub_u32 v177, v186, v177
    v_lshlrev_b32 v177, 4, v177
    v_and_b32_e64 v186, 3, v189
    v_mul_u32_u24 v186, 1280, v186
    v_add_u32 v177, v177, v186
    v_lshrrev_b32 v161, 2, v189
    v_add_u32 v186, 128, v185
    v_mul_u32_u24 v189, 205, v186
    v_lshrrev_b32 v189, 13, v189
    v_mul_u32_u24 v178, 40, v189
    v_sub_u32 v178, v186, v178
    v_lshlrev_b32 v178, 4, v178
    v_and_b32_e64 v186, 3, v189
    v_mul_u32_u24 v186, 1280, v186
    v_add_u32 v178, v178, v186
    v_lshrrev_b32 v162, 2, v189
    v_add_u32 v186, 192, v185
    v_mul_u32_u24 v189, 205, v186
    v_lshrrev_b32 v189, 13, v189
    v_mul_u32_u24 v179, 40, v189
    v_sub_u32 v179, v186, v179
    v_lshlrev_b32 v179, 4, v179
    v_and_b32_e64 v186, 3, v189
    v_mul_u32_u24 v186, 1280, v186
    v_add_u32 v179, v179, v186
    v_lshrrev_b32 v163, 2, v189
    v_add_u32 v186, 256, v185
    v_mul_u32_u24 v189, 205, v186
    v_lshrrev_b32 v189, 13, v189
    v_mul_u32_u24 v180, 40, v189
    v_sub_u32 v180, v186, v180
    v_lshlrev_b32 v180, 4, v180
    v_and_b32_e64 v186, 3, v189
    v_mul_u32_u24 v186, 1280, v186
    v_add_u32 v180, v180, v186
    v_lshrrev_b32 v164, 2, v189
    v_lshrrev_b32_e64 v186, 4, v185
    v_mul_u32_u24 v187, 5184, v186
    v_bfe_u32 v186, v185, 2, 2
    v_mul_u32_u24 v186, 640, v186
    v_add_u32 v187, v187, v186
    v_and_b32 v186, 3, v185
    v_lshlrev_b32_e64 v186, 3, v186
    s_mul_i32 s62, s44, 160
    v_add3_u32 v187, v187, v186, s62
    v_add_u32 v190, 62208, v187
    v_add_u32 v191, 124416, v187
    v_lshlrev_b32_e64 v188, 4, v185
    s_mul_i32 s62, s44, 5184
    s_waitcnt lgkmcnt(0)
    s_add_u32 s68, s20, 0xc10000
    s_addc_u32 s69, s21, 0
    s_mov_b32 s70, 81920
    s_mov_b32 s71, 0x20000
    s_mov_b32 s32, s20
    s_mov_b32 s33, s21
    s_mov_b32 s34, 8912896
    s_mov_b32 s35, 0x20000
    s_add_u32 s40, s20, 0x900000
    s_addc_u32 s41, s21, 0
    s_mov_b32 s42, 2785280
    s_mov_b32 s43, 0x20000
    s_add_u32 s64, s20, 0xc00000
    s_addc_u32 s65, s21, 0
    s_mov_b32 s66, 32768
    s_mov_b32 s67, 0x20000
    s_mov_b32 s72, s22
    s_mov_b32 s73, s23
    s_mov_b32 s74, 256
    s_mov_b32 s75, 0x20000
    s_mov_b32 s76, s82
    s_mov_b32 s77, s83
    s_mov_b32 s78, 2621440
    s_mov_b32 s79, 0x20000
    s_add_u32 s53, s80, 0
    s_min_u32 s53, s53, 135
    s_sub_u32 s53, 135, s53
    s_lshr_b32 s59, s53, 1
    s_and_b32 s60, s53, 1
    s_sub_u32 s54, s59, 20
    s_lshl_b32 s54, s54, 5
    s_mov_b32 s55, 16
    s_mov_b32 s56, 4
    s_mov_b32 s57, 8
    s_mul_i32 s61, s59, 160
    s_sub_u32 s61, s61, 2544
    s_cmp_lt_u32 s59, 20
    s_cselect_b32 s36, s8, s16
    s_cselect_b32 s37, s9, s17
    s_mov_b32 s38, 1966080
    s_cselect_b32 s38, 819200, s38
    s_mov_b32 s39, 0x20000
    s_cselect_b32 s54, s61, s54
    s_cselect_b32 s55, 80, s55
    s_cselect_b32 s56, 40, s56
    s_cselect_b32 s57, 20, s57
    s_mul_i32 s61, s59, 40
    s_cmp_lt_u32 s59, 16
    s_cselect_b32 s54, s61, s54
    s_cselect_b32 s55, 20, s55
    s_cselect_b32 s56, 4, s56
    s_cselect_b32 s57, 8, s57
    s_lshr_b32 s61, s44, 1
    s_mul_i32 s61, s61, s55
    s_add_u32 s54, s54, s61
    s_and_b32 s61, s44, 1
    s_mul_i32 s61, s61, s56
    s_add_u32 s54, s54, s61
    s_mul_i32 s54, s54, 1280
    s_mul_i32 s57, s57, 1280
    s_mul_i32 s61, s60, 640
    s_add_u32 s54, s54, s61
    s_lshl_b32 s60, s60, 2
    s_add_u32 s60, s60, s44
    s_mul_i32 s45, s60, 68
    s_add_u32 s45, s45, s59
    s_mul_i32 s45, s45, 5120
    v_mad_u32_u24 v165, v160, s57, v176
    s_add_u32 m0, s62, 0
    s_nop 0
    buffer_load_dwordx4 v165, s[36:39], s54 offen lds
    v_mad_u32_u24 v166, v161, s57, v177
    s_add_u32 m0, s62, 1024
    s_nop 0
    buffer_load_dwordx4 v166, s[36:39], s54 offen lds
    v_mad_u32_u24 v167, v162, s57, v178
    s_add_u32 m0, s62, 2048
    s_nop 0
    buffer_load_dwordx4 v167, s[36:39], s54 offen lds
    v_mad_u32_u24 v168, v163, s57, v179
    s_add_u32 m0, s62, 3072
    s_nop 0
    buffer_load_dwordx4 v168, s[36:39], s54 offen lds
    v_mad_u32_u24 v169, v164, s57, v180
    s_add_u32 m0, s62, 4096
    s_nop 0
    buffer_load_dwordx4 v169, s[36:39], s54 offen lds
    s_add_u32 s53, s80, 20
    s_min_u32 s53, s53, 135
    s_sub_u32 s53, 135, s53
    s_lshr_b32 s59, s53, 1
    s_and_b32 s60, s53, 1
    s_sub_u32 s54, s59, 20
    s_lshl_b32 s54, s54, 5
    s_mov_b32 s55, 16
    s_mov_b32 s56, 4
    s_mov_b32 s57, 8
    s_mul_i32 s61, s59, 160
    s_sub_u32 s61, s61, 2544
    s_cmp_lt_u32 s59, 20
    s_cselect_b32 s36, s8, s16
    s_cselect_b32 s37, s9, s17
    s_mov_b32 s38, 1966080
    s_cselect_b32 s38, 819200, s38
    s_mov_b32 s39, 0x20000
    s_cselect_b32 s54, s61, s54
    s_cselect_b32 s55, 80, s55
    s_cselect_b32 s56, 40, s56
    s_cselect_b32 s57, 20, s57
    s_mul_i32 s61, s59, 40
    s_cmp_lt_u32 s59, 16
    s_cselect_b32 s54, s61, s54
    s_cselect_b32 s55, 20, s55
    s_cselect_b32 s56, 4, s56
    s_cselect_b32 s57, 8, s57
    s_lshr_b32 s61, s44, 1
    s_mul_i32 s61, s61, s55
    s_add_u32 s54, s54, s61
    s_and_b32 s61, s44, 1
    s_mul_i32 s61, s61, s56
    s_add_u32 s54, s54, s61
    s_mul_i32 s54, s54, 1280
    s_mul_i32 s57, s57, 1280
    s_mul_i32 s61, s60, 640
    s_add_u32 s54, s54, s61
    s_lshl_b32 s60, s60, 2
    s_add_u32 s60, s60, s44
    s_mul_i32 s46, s60, 68
    s_add_u32 s46, s46, s59
    s_mul_i32 s46, s46, 5120
    v_mad_u32_u24 v165, v160, s57, v176
    s_add_u32 m0, s62, 20736
    s_nop 0
    buffer_load_dwordx4 v165, s[36:39], s54 offen lds
    v_mad_u32_u24 v166, v161, s57, v177
    s_add_u32 m0, s62, 21760
    s_nop 0
    buffer_load_dwordx4 v166, s[36:39], s54 offen lds
    v_mad_u32_u24 v167, v162, s57, v178
    s_add_u32 m0, s62, 22784
    s_nop 0
    buffer_load_dwordx4 v167, s[36:39], s54 offen lds
    v_mad_u32_u24 v168, v163, s57, v179
    s_add_u32 m0, s62, 23808
    s_nop 0
    buffer_load_dwordx4 v168, s[36:39], s54 offen lds
    v_mad_u32_u24 v169, v164, s57, v180
    s_add_u32 m0, s62, 24832
    s_nop 0
    buffer_load_dwordx4 v169, s[36:39], s54 offen lds
    s_add_u32 s53, s80, 40
    s_min_u32 s53, s53, 135
    s_sub_u32 s53, 135, s53
    s_lshr_b32 s59, s53, 1
    s_and_b32 s60, s53, 1
    s_sub_u32 s54, s59, 20
    s_lshl_b32 s54, s54, 5
    s_mov_b32 s55, 16
    s_mov_b32 s56, 4
    s_mov_b32 s57, 8
    s_mul_i32 s61, s59, 160
    s_sub_u32 s61, s61, 2544
    s_cmp_lt_u32 s59, 20
    s_cselect_b32 s36, s8, s16
    s_cselect_b32 s37, s9, s17
    s_mov_b32 s38, 1966080
    s_cselect_b32 s38, 819200, s38
    s_mov_b32 s39, 0x20000
    s_cselect_b32 s54, s61, s54
    s_cselect_b32 s55, 80, s55
    s_cselect_b32 s56, 40, s56
    s_cselect_b32 s57, 20, s57
    s_mul_i32 s61, s59, 40
    s_cmp_lt_u32 s59, 16
    s_cselect_b32 s54, s61, s54
    s_cselect_b32 s55, 20, s55
    s_cselect_b32 s56, 4, s56
    s_cselect_b32 s57, 8, s57
    s_lshr_b32 s61, s44, 1
    s_mul_i32 s61, s61, s55
    s_add_u32 s54, s54, s61
    s_and_b32 s61, s44, 1
    s_mul_i32 s61, s61, s56
    s_add_u32 s54, s54, s61
    s_mul_i32 s54, s54, 1280
    s_mul_i32 s57, s57, 1280
    s_mul_i32 s61, s60, 640
    s_add_u32 s54, s54, s61
    s_lshl_b32 s60, s60, 2
    s_add_u32 s60, s60, s44
    s_mul_i32 s47, s60, 68
    s_add_u32 s47, s47, s59
    s_mul_i32 s47, s47, 5120
    v_mad_u32_u24 v165, v160, s57, v176
    s_add_u32 m0, s62, 41472
    s_nop 0
    buffer_load_dwordx4 v165, s[36:39], s54 offen lds
    v_mad_u32_u24 v166, v161, s57, v177
    s_add_u32 m0, s62, 42496
    s_nop 0
    buffer_load_dwordx4 v166, s[36:39], s54 offen lds
    v_mad_u32_u24 v167, v162, s57, v178
    s_add_u32 m0, s62, 43520
    s_nop 0
    buffer_load_dwordx4 v167, s[36:39], s54 offen lds
    v_mad_u32_u24 v168, v163, s57, v179
    s_add_u32 m0, s62, 44544
    s_nop 0
    buffer_load_dwordx4 v168, s[36:39], s54 offen lds
    v_mad_u32_u24 v169, v164, s57, v180
    s_add_u32 m0, s62, 45568
    s_nop 0
    buffer_load_dwordx4 v169, s[36:39], s54 offen lds
    s_lshl_b32 s59, s80, 2
    s_add_u32 s59, s59, s44
    s_lshl_b32 s59, s59, 10
    v_mov_b32 v172, 0
    v_mov_b32 v173, 0
    v_mov_b32 v174, 0
    v_mov_b32_e64 v175, 0
    buffer_store_dwordx4 v[172:175], v188, s[68:71], s59 offen sc1
    s_add_u32 s53, s80, 60
    s_min_u32 s53, s53, 135
    s_sub_u32 s53, 135, s53
    s_lshr_b32 s59, s53, 1
    s_and_b32 s60, s53, 1
    s_sub_u32 s54, s59, 20
    s_lshl_b32 s54, s54, 5
    s_mov_b32 s55, 16
    s_mov_b32 s56, 4
    s_mov_b32 s57, 8
    s_mul_i32 s61, s59, 160
    s_sub_u32 s61, s61, 2544
    s_cmp_lt_u32 s59, 20
    s_cselect_b32 s36, s8, s16
    s_cselect_b32 s37, s9, s17
    s_mov_b32 s38, 1966080
    s_cselect_b32 s38, 819200, s38
    s_mov_b32 s39, 0x20000
    s_cselect_b32 s54, s61, s54
    s_cselect_b32 s55, 80, s55
    s_cselect_b32 s56, 40, s56
    s_cselect_b32 s57, 20, s57
    s_mul_i32 s61, s59, 40
    s_cmp_lt_u32 s59, 16
    s_cselect_b32 s54, s61, s54
    s_cselect_b32 s55, 20, s55
    s_cselect_b32 s56, 4, s56
    s_cselect_b32 s57, 8, s57
    s_lshr_b32 s61, s44, 1
    s_mul_i32 s61, s61, s55
    s_add_u32 s54, s54, s61
    s_and_b32 s61, s44, 1
    s_mul_i32 s61, s61, s56
    s_add_u32 s54, s54, s61
    s_mul_i32 s54, s54, 1280
    s_mul_i32 s57, s57, 1280
    s_mul_i32 s61, s60, 640
    s_add_u32 s54, s54, s61
    s_lshl_b32 s60, s60, 2
    s_add_u32 s60, s60, s44
    s_mul_i32 s48, s60, 68
    s_add_u32 s48, s48, s59
    s_mul_i32 s48, s48, 5120
    v_mad_u32_u24 v165, v160, s57, v176
    s_add_u32 m0, s62, 62208
    s_nop 0
    buffer_load_dwordx4 v165, s[36:39], s54 offen lds
    v_mad_u32_u24 v166, v161, s57, v177
    s_add_u32 m0, s62, 63232
    s_nop 0
    buffer_load_dwordx4 v166, s[36:39], s54 offen lds
    v_mad_u32_u24 v167, v162, s57, v178
    s_add_u32 m0, s62, 64256
    s_nop 0
    buffer_load_dwordx4 v167, s[36:39], s54 offen lds
    v_mad_u32_u24 v168, v163, s57, v179
    s_add_u32 m0, s62, 65280
    s_nop 0
    buffer_load_dwordx4 v168, s[36:39], s54 offen lds
    v_mad_u32_u24 v169, v164, s57, v180
    s_add_u32 m0, s62, 66304
    s_nop 0
    buffer_load_dwordx4 v169, s[36:39], s54 offen lds
    s_waitcnt vmcnt(16)
    s_barrier
    ds_read_b64_tr_b16 a[0:1], v187 offset:0
    ds_read_b64_tr_b16 a[2:3], v187 offset:2560
    ds_read_b64_tr_b16 a[4:5], v187 offset:32
    ds_read_b64_tr_b16 a[6:7], v187 offset:2592
    ds_read_b64_tr_b16 a[8:9], v187 offset:64
    ds_read_b64_tr_b16 a[10:11], v187 offset:2624
    ds_read_b64_tr_b16 a[12:13], v187 offset:96
    ds_read_b64_tr_b16 a[14:15], v187 offset:2656
    ds_read_b64_tr_b16 a[16:17], v187 offset:128
    ds_read_b64_tr_b16 a[18:19], v187 offset:2688
    s_waitcnt lgkmcnt(8)
    buffer_store_dwordx4 a[0:3], v188, s[40:43], s45 offen offset:0 sc1
    s_waitcnt lgkmcnt(6)
    buffer_store_dwordx4 a[4:7], v188, s[40:43], s45 offen offset:1024 sc1
    s_waitcnt lgkmcnt(4)
    buffer_store_dwordx4 a[8:11], v188, s[40:43], s45 offen offset:2048 sc1
    s_waitcnt lgkmcnt(2)
    buffer_store_dwordx4 a[12:15], v188, s[40:43], s45 offen offset:3072 sc1
    s_waitcnt lgkmcnt(0)
    s_add_u32 s61, s45, 4096
    buffer_store_dwordx4 a[16:19], v188, s[40:43], s61 offen sc1
    s_add_u32 s53, s80, 80
    s_min_u32 s53, s53, 135
    s_sub_u32 s53, 135, s53
    s_lshr_b32 s59, s53, 1
    s_and_b32 s60, s53, 1
    s_sub_u32 s54, s59, 20
    s_lshl_b32 s54, s54, 5
    s_mov_b32 s55, 16
    s_mov_b32 s56, 4
    s_mov_b32 s57, 8
    s_mul_i32 s61, s59, 160
    s_sub_u32 s61, s61, 2544
    s_cmp_lt_u32 s59, 20
    s_cselect_b32 s36, s8, s16
    s_cselect_b32 s37, s9, s17
    s_mov_b32 s38, 1966080
    s_cselect_b32 s38, 819200, s38
    s_mov_b32 s39, 0x20000
    s_cselect_b32 s54, s61, s54
    s_cselect_b32 s55, 80, s55
    s_cselect_b32 s56, 40, s56
    s_cselect_b32 s57, 20, s57
    s_mul_i32 s61, s59, 40
    s_cmp_lt_u32 s59, 16
    s_cselect_b32 s54, s61, s54
    s_cselect_b32 s55, 20, s55
    s_cselect_b32 s56, 4, s56
    s_cselect_b32 s57, 8, s57
    s_lshr_b32 s61, s44, 1
    s_mul_i32 s61, s61, s55
    s_add_u32 s54, s54, s61
    s_and_b32 s61, s44, 1
    s_mul_i32 s61, s61, s56
    s_add_u32 s54, s54, s61
    s_mul_i32 s54, s54, 1280
    s_mul_i32 s57, s57, 1280
    s_mul_i32 s61, s60, 640
    s_add_u32 s54, s54, s61
    s_lshl_b32 s60, s60, 2
    s_add_u32 s60, s60, s44
    s_mul_i32 s49, s60, 68
    s_add_u32 s49, s49, s59
    s_mul_i32 s49, s49, 5120
    v_mad_u32_u24 v165, v160, s57, v176
    s_add_u32 m0, s62, 82944
    s_nop 0
    buffer_load_dwordx4 v165, s[36:39], s54 offen lds
    v_mad_u32_u24 v166, v161, s57, v177
    s_add_u32 m0, s62, 83968
    s_nop 0
    buffer_load_dwordx4 v166, s[36:39], s54 offen lds
    v_mad_u32_u24 v167, v162, s57, v178
    s_add_u32 m0, s62, 84992
    s_nop 0
    buffer_load_dwordx4 v167, s[36:39], s54 offen lds
    v_mad_u32_u24 v168, v163, s57, v179
    s_add_u32 m0, s62, 86016
    s_nop 0
    buffer_load_dwordx4 v168, s[36:39], s54 offen lds
    v_mad_u32_u24 v169, v164, s57, v180
    s_add_u32 m0, s62, 87040
    s_nop 0
    buffer_load_dwordx4 v169, s[36:39], s54 offen lds
    s_waitcnt vmcnt(21)
    s_barrier
    ds_read_b64_tr_b16 a[20:21], v187 offset:20736
    ds_read_b64_tr_b16 a[22:23], v187 offset:23296
    ds_read_b64_tr_b16 a[24:25], v187 offset:20768
    ds_read_b64_tr_b16 a[26:27], v187 offset:23328
    ds_read_b64_tr_b16 a[28:29], v187 offset:20800
    ds_read_b64_tr_b16 a[30:31], v187 offset:23360
    ds_read_b64_tr_b16 a[32:33], v187 offset:20832
    ds_read_b64_tr_b16 a[34:35], v187 offset:23392
    ds_read_b64_tr_b16 a[36:37], v187 offset:20864
    ds_read_b64_tr_b16 a[38:39], v187 offset:23424
    s_waitcnt lgkmcnt(8)
    buffer_store_dwordx4 a[20:23], v188, s[40:43], s46 offen offset:0 sc1
    s_waitcnt lgkmcnt(6)
    buffer_store_dwordx4 a[24:27], v188, s[40:43], s46 offen offset:1024 sc1
    s_waitcnt lgkmcnt(4)
    buffer_store_dwordx4 a[28:31], v188, s[40:43], s46 offen offset:2048 sc1
    s_waitcnt lgkmcnt(2)
    buffer_store_dwordx4 a[32:35], v188, s[40:43], s46 offen offset:3072 sc1
    s_waitcnt lgkmcnt(0)
    s_add_u32 s61, s46, 4096
    buffer_store_dwordx4 a[36:39], v188, s[40:43], s61 offen sc1
    s_add_u32 s53, s80, 100
    s_min_u32 s53, s53, 135
    s_sub_u32 s53, 135, s53
    s_lshr_b32 s59, s53, 1
    s_and_b32 s60, s53, 1
    s_sub_u32 s54, s59, 20
    s_lshl_b32 s54, s54, 5
    s_mov_b32 s55, 16
    s_mov_b32 s56, 4
    s_mov_b32 s57, 8
    s_mul_i32 s61, s59, 160
    s_sub_u32 s61, s61, 2544
    s_cmp_lt_u32 s59, 20
    s_cselect_b32 s36, s8, s16
    s_cselect_b32 s37, s9, s17
    s_mov_b32 s38, 1966080
    s_cselect_b32 s38, 819200, s38
    s_mov_b32 s39, 0x20000
    s_cselect_b32 s54, s61, s54
    s_cselect_b32 s55, 80, s55
    s_cselect_b32 s56, 40, s56
    s_cselect_b32 s57, 20, s57
    s_mul_i32 s61, s59, 40
    s_cmp_lt_u32 s59, 16
    s_cselect_b32 s54, s61, s54
    s_cselect_b32 s55, 20, s55
    s_cselect_b32 s56, 4, s56
    s_cselect_b32 s57, 8, s57
    s_lshr_b32 s61, s44, 1
    s_mul_i32 s61, s61, s55
    s_add_u32 s54, s54, s61
    s_and_b32 s61, s44, 1
    s_mul_i32 s61, s61, s56
    s_add_u32 s54, s54, s61
    s_mul_i32 s54, s54, 1280
    s_mul_i32 s57, s57, 1280
    s_mul_i32 s61, s60, 640
    s_add_u32 s54, s54, s61
    s_lshl_b32 s60, s60, 2
    s_add_u32 s60, s60, s44
    s_mul_i32 s50, s60, 68
    s_add_u32 s50, s50, s59
    s_mul_i32 s50, s50, 5120
    v_mad_u32_u24 v165, v160, s57, v176
    s_add_u32 m0, s62, 103680
    s_nop 0
    buffer_load_dwordx4 v165, s[36:39], s54 offen lds
    v_mad_u32_u24 v166, v161, s57, v177
    s_add_u32 m0, s62, 104704
    s_nop 0
    buffer_load_dwordx4 v166, s[36:39], s54 offen lds
    v_mad_u32_u24 v167, v162, s57, v178
    s_add_u32 m0, s62, 105728
    s_nop 0
    buffer_load_dwordx4 v167, s[36:39], s54 offen lds
    v_mad_u32_u24 v168, v163, s57, v179
    s_add_u32 m0, s62, 106752
    s_nop 0
    buffer_load_dwordx4 v168, s[36:39], s54 offen lds
    v_mad_u32_u24 v169, v164, s57, v180
    s_add_u32 m0, s62, 107776
    s_nop 0
    buffer_load_dwordx4 v169, s[36:39], s54 offen lds
    s_waitcnt vmcnt(26)
    s_barrier
    ds_read_b64_tr_b16 a[40:41], v187 offset:41472
    ds_read_b64_tr_b16 a[42:43], v187 offset:44032
    ds_read_b64_tr_b16 a[44:45], v187 offset:41504
    ds_read_b64_tr_b16 a[46:47], v187 offset:44064
    ds_read_b64_tr_b16 a[48:49], v187 offset:41536
    ds_read_b64_tr_b16 a[50:51], v187 offset:44096
    ds_read_b64_tr_b16 a[52:53], v187 offset:41568
    ds_read_b64_tr_b16 a[54:55], v187 offset:44128
    ds_read_b64_tr_b16 a[56:57], v187 offset:41600
    ds_read_b64_tr_b16 a[58:59], v187 offset:44160
    s_waitcnt lgkmcnt(8)
    buffer_store_dwordx4 a[40:43], v188, s[40:43], s47 offen offset:0 sc1
    s_waitcnt lgkmcnt(6)
    buffer_store_dwordx4 a[44:47], v188, s[40:43], s47 offen offset:1024 sc1
    s_waitcnt lgkmcnt(4)
    buffer_store_dwordx4 a[48:51], v188, s[40:43], s47 offen offset:2048 sc1
    s_waitcnt lgkmcnt(2)
    buffer_store_dwordx4 a[52:55], v188, s[40:43], s47 offen offset:3072 sc1
    s_waitcnt lgkmcnt(0)
    s_add_u32 s61, s47, 4096
    buffer_store_dwordx4 a[56:59], v188, s[40:43], s61 offen sc1
    s_add_u32 s53, s80, 120
    s_min_u32 s53, s53, 135
    s_sub_u32 s53, 135, s53
    s_lshr_b32 s59, s53, 1
    s_and_b32 s60, s53, 1
    s_sub_u32 s54, s59, 20
    s_lshl_b32 s54, s54, 5
    s_mov_b32 s55, 16
    s_mov_b32 s56, 4
    s_mov_b32 s57, 8
    s_mul_i32 s61, s59, 160
    s_sub_u32 s61, s61, 2544
    s_cmp_lt_u32 s59, 20
    s_cselect_b32 s36, s8, s16
    s_cselect_b32 s37, s9, s17
    s_mov_b32 s38, 1966080
    s_cselect_b32 s38, 819200, s38
    s_mov_b32 s39, 0x20000
    s_cselect_b32 s54, s61, s54
    s_cselect_b32 s55, 80, s55
    s_cselect_b32 s56, 40, s56
    s_cselect_b32 s57, 20, s57
    s_mul_i32 s61, s59, 40
    s_cmp_lt_u32 s59, 16
    s_cselect_b32 s54, s61, s54
    s_cselect_b32 s55, 20, s55
    s_cselect_b32 s56, 4, s56
    s_cselect_b32 s57, 8, s57
    s_lshr_b32 s61, s44, 1
    s_mul_i32 s61, s61, s55
    s_add_u32 s54, s54, s61
    s_and_b32 s61, s44, 1
    s_mul_i32 s61, s61, s56
    s_add_u32 s54, s54, s61
    s_mul_i32 s54, s54, 1280
    s_mul_i32 s57, s57, 1280
    s_mul_i32 s61, s60, 640
    s_add_u32 s54, s54, s61
    s_lshl_b32 s60, s60, 2
    s_add_u32 s60, s60, s44
    s_mul_i32 s51, s60, 68
    s_add_u32 s51, s51, s59
    s_mul_i32 s51, s51, 5120
    v_mad_u32_u24 v165, v160, s57, v176
    s_add_u32 m0, s62, 124416
    s_nop 0
    buffer_load_dwordx4 v165, s[36:39], s54 offen lds
    v_mad_u32_u24 v166, v161, s57, v177
    s_add_u32 m0, s62, 125440
    s_nop 0
    buffer_load_dwordx4 v166, s[36:39], s54 offen lds
    v_mad_u32_u24 v167, v162, s57, v178
    s_add_u32 m0, s62, 126464
    s_nop 0
    buffer_load_dwordx4 v167, s[36:39], s54 offen lds
    v_mad_u32_u24 v168, v163, s57, v179
    s_add_u32 m0, s62, 127488
    s_nop 0
    buffer_load_dwordx4 v168, s[36:39], s54 offen lds
    v_mad_u32_u24 v169, v164, s57, v180
    s_add_u32 m0, s62, 128512
    s_nop 0
    buffer_load_dwordx4 v169, s[36:39], s54 offen lds
    s_waitcnt vmcnt(30)
    s_barrier
    ds_read_b64_tr_b16 a[60:61], v190 offset:0
    ds_read_b64_tr_b16 a[62:63], v190 offset:2560
    ds_read_b64_tr_b16 a[64:65], v190 offset:32
    ds_read_b64_tr_b16 a[66:67], v190 offset:2592
    ds_read_b64_tr_b16 a[68:69], v190 offset:64
    ds_read_b64_tr_b16 a[70:71], v190 offset:2624
    ds_read_b64_tr_b16 a[72:73], v190 offset:96
    ds_read_b64_tr_b16 a[74:75], v190 offset:2656
    ds_read_b64_tr_b16 a[76:77], v190 offset:128
    ds_read_b64_tr_b16 a[78:79], v190 offset:2688
    s_waitcnt lgkmcnt(8)
    buffer_store_dwordx4 a[60:63], v188, s[40:43], s48 offen offset:0 sc1
    s_waitcnt lgkmcnt(6)
    buffer_store_dwordx4 a[64:67], v188, s[40:43], s48 offen offset:1024 sc1
    s_waitcnt lgkmcnt(4)
    buffer_store_dwordx4 a[68:71], v188, s[40:43], s48 offen offset:2048 sc1
    s_waitcnt lgkmcnt(2)
    buffer_store_dwordx4 a[72:75], v188, s[40:43], s48 offen offset:3072 sc1
    s_waitcnt lgkmcnt(0)
    s_add_u32 s61, s48, 4096
    buffer_store_dwordx4 a[76:79], v188, s[40:43], s61 offen sc1
    s_waitcnt vmcnt(25)
    s_barrier
    ds_read_b64_tr_b16 a[80:81], v190 offset:20736
    ds_read_b64_tr_b16 a[82:83], v190 offset:23296
    ds_read_b64_tr_b16 a[84:85], v190 offset:20768
    ds_read_b64_tr_b16 a[86:87], v190 offset:23328
    ds_read_b64_tr_b16 a[88:89], v190 offset:20800
    ds_read_b64_tr_b16 a[90:91], v190 offset:23360
    ds_read_b64_tr_b16 a[92:93], v190 offset:20832
    ds_read_b64_tr_b16 a[94:95], v190 offset:23392
    ds_read_b64_tr_b16 a[96:97], v190 offset:20864
    ds_read_b64_tr_b16 a[98:99], v190 offset:23424
    s_waitcnt lgkmcnt(8)
    buffer_store_dwordx4 a[80:83], v188, s[40:43], s49 offen offset:0 sc1
    s_waitcnt lgkmcnt(6)
    buffer_store_dwordx4 a[84:87], v188, s[40:43], s49 offen offset:1024 sc1
    s_waitcnt lgkmcnt(4)
    buffer_store_dwordx4 a[88:91], v188, s[40:43], s49 offen offset:2048 sc1
    s_waitcnt lgkmcnt(2)
    buffer_store_dwordx4 a[92:95], v188, s[40:43], s49 offen offset:3072 sc1
    s_waitcnt lgkmcnt(0)
    s_add_u32 s61, s49, 4096
    buffer_store_dwordx4 a[96:99], v188, s[40:43], s61 offen sc1
    s_waitcnt vmcnt(20)
    s_barrier
    ds_read_b64_tr_b16 a[100:101], v190 offset:41472
    ds_read_b64_tr_b16 a[102:103], v190 offset:44032
    ds_read_b64_tr_b16 a[104:105], v190 offset:41504
    ds_read_b64_tr_b16 a[106:107], v190 offset:44064
    ds_read_b64_tr_b16 a[108:109], v190 offset:41536
    ds_read_b64_tr_b16 a[110:111], v190 offset:44096
    ds_read_b64_tr_b16 a[112:113], v190 offset:41568
    ds_read_b64_tr_b16 a[114:115], v190 offset:44128
    ds_read_b64_tr_b16 a[116:117], v190 offset:41600
    ds_read_b64_tr_b16 a[118:119], v190 offset:44160
    s_waitcnt lgkmcnt(8)
    buffer_store_dwordx4 a[100:103], v188, s[40:43], s50 offen offset:0 sc1
    s_waitcnt lgkmcnt(6)
    buffer_store_dwordx4 a[104:107], v188, s[40:43], s50 offen offset:1024 sc1
    s_waitcnt lgkmcnt(4)
    buffer_store_dwordx4 a[108:111], v188, s[40:43], s50 offen offset:2048 sc1
    s_waitcnt lgkmcnt(2)
    buffer_store_dwordx4 a[112:115], v188, s[40:43], s50 offen offset:3072 sc1
    s_waitcnt lgkmcnt(0)
    s_add_u32 s61, s50, 4096
    buffer_store_dwordx4 a[116:119], v188, s[40:43], s61 offen sc1
    s_waitcnt vmcnt(5)
    s_barrier
    s_cmp_lg_u32 s44, 0
    s_cbranch_scc1 L_sig85
    v_mov_b32 v170, 1
    v_mov_b32 v171, 128
    s_mov_b64 exec, 1
    buffer_atomic_add v170, v171, s[72:75], 0 offen sc1
    s_mov_b64 exec, -1
L_sig85:
    s_barrier
    ds_read_b64_tr_b16 a[120:121], v191 offset:0
    ds_read_b64_tr_b16 a[122:123], v191 offset:2560
    ds_read_b64_tr_b16 a[124:125], v191 offset:32
    ds_read_b64_tr_b16 a[126:127], v191 offset:2592
    ds_read_b64_tr_b16 a[128:129], v191 offset:64
    ds_read_b64_tr_b16 a[130:131], v191 offset:2624
    ds_read_b64_tr_b16 a[132:133], v191 offset:96
    ds_read_b64_tr_b16 a[134:135], v191 offset:2656
    ds_read_b64_tr_b16 a[136:137], v191 offset:128
    ds_read_b64_tr_b16 a[138:139], v191 offset:2688
    s_waitcnt lgkmcnt(8)
    buffer_store_dwordx4 a[120:123], v188, s[40:43], s51 offen offset:0 sc1
    s_waitcnt lgkmcnt(6)
    buffer_store_dwordx4 a[124:127], v188, s[40:43], s51 offen offset:1024 sc1
    s_waitcnt lgkmcnt(4)
    buffer_store_dwordx4 a[128:131], v188, s[40:43], s51 offen offset:2048 sc1
    s_waitcnt lgkmcnt(2)
    buffer_store_dwordx4 a[132:135], v188, s[40:43], s51 offen offset:3072 sc1
    s_waitcnt lgkmcnt(0)
    s_add_u32 s61, s51, 4096
    buffer_store_dwordx4 a[136:139], v188, s[40:43], s61 offen sc1
    s_waitcnt vmcnt(0)
    s_barrier
    s_cmp_lg_u32 s44, 0
    s_cbranch_scc1 L_sig86
    v_mov_b32_e64 v170, 1
    v_mov_b32 v171, 132
    s_mov_b64 exec, 1
    buffer_atomic_add v170, v171, s[72:75], 0 offen sc1
    s_mov_b64 exec, -1
L_sig86:
L_P2only:
    s_lshr_b32 s53, s2, 3
    s_lshr_b32 s54, s2, 6
    s_and_b32 s55, s2, 1
    s_lshl_b32 s55, s55, 2
    s_add_u32 s54, s54, s55
    s_and_b32 s55, s53, 3
    s_mov_b32 s56, 4
    s_mul_i32 s59, s54, 348160
    s_mul_i32 s10, s44, 61440
    s_add_u32 s10, s10, s59
    s_add_u32 s10, s10, 102400
    s_mul_i32 s11, s44, 20480
    s_add_u32 s11, s11, s59
    s_mul_i32 s3, s44, 5120
    s_add_u32 s3, s3, s59
    s_add_u32 s3, s3, 81920
    v_lshlrev_b32 v190, 2, v185
    v_cmp_ne_u32 vcc, 0, v185
    v_add_u32 v190, 124, v190
    s_nop 0
    v_cndmask_b32 v190, 0, v190, vcc
    buffer_load_dword v191, v190, s[72:75], 0 offen sc1
    s_waitcnt vmcnt(0)
    v_cmp_le_u32 vcc, 20, v191
    s_nop 0
    s_andn2_b32 s84, 0x6, vcc_lo
    s_cbranch_scc1 L_retry87
L_ok87:
    s_add_u32 s63, s10, 0
    buffer_load_dwordx4 v[0:3], v188, s[40:43], s63 offen offset:0 sc1
    buffer_load_dwordx4 v[4:7], v188, s[40:43], s63 offen offset:1024 sc1
    buffer_load_dwordx4 v[8:11], v188, s[40:43], s63 offen offset:2048 sc1
    buffer_load_dwordx4 v[12:15], v188, s[40:43], s63 offen offset:3072 sc1
    s_add_u32 s63, s10, 4096
    buffer_load_dwordx4 v[16:19], v188, s[40:43], s63 offen offset:0 sc1
    buffer_load_dwordx4 v[20:23], v188, s[40:43], s63 offen offset:1024 sc1
    buffer_load_dwordx4 v[24:27], v188, s[40:43], s63 offen offset:2048 sc1
    buffer_load_dwordx4 v[28:31], v188, s[40:43], s63 offen offset:3072 sc1
    s_add_u32 s63, s10, 8192
    buffer_load_dwordx4 v[32:35], v188, s[40:43], s63 offen offset:0 sc1
    buffer_load_dwordx4 v[36:39], v188, s[40:43], s63 offen offset:1024 sc1
    buffer_load_dwordx4 v[40:43], v188, s[40:43], s63 offen offset:2048 sc1
    buffer_load_dwordx4 v[44:47], v188, s[40:43], s63 offen offset:3072 sc1
    s_add_u32 s63, s10, 12288
    buffer_load_dwordx4 v[48:51], v188, s[40:43], s63 offen offset:0 sc1
    buffer_load_dwordx4 v[52:55], v188, s[40:43], s63 offen offset:1024 sc1
    buffer_load_dwordx4 v[56:59], v188, s[40:43], s63 offen offset:2048 sc1
    buffer_load_dwordx4 v[60:63], v188, s[40:43], s63 offen offset:3072 sc1
    s_add_u32 s63, s10, 16384
    buffer_load_dwordx4 v[64:67], v188, s[40:43], s63 offen offset:0 sc1
    buffer_load_dwordx4 v[68:71], v188, s[40:43], s63 offen offset:1024 sc1
    buffer_load_dwordx4 v[72:75], v188, s[40:43], s63 offen offset:2048 sc1
    buffer_load_dwordx4 v[76:79], v188, s[40:43], s63 offen offset:3072 sc1
    s_add_u32 s63, s10, 20480
    buffer_load_dwordx4 v[80:83], v188, s[40:43], s63 offen offset:0 sc1
    buffer_load_dwordx4 a[0:3], v188, s[40:43], s63 offen offset:1024 sc1
    buffer_load_dwordx4 a[4:7], v188, s[40:43], s63 offen offset:2048 sc1
    buffer_load_dwordx4 a[8:11], v188, s[40:43], s63 offen offset:3072 sc1
    s_add_u32 s63, s10, 24576
    buffer_load_dwordx4 a[12:15], v188, s[40:43], s63 offen offset:0 sc1
    buffer_load_dwordx4 a[16:19], v188, s[40:43], s63 offen offset:1024 sc1
    buffer_load_dwordx4 a[20:23], v188, s[40:43], s63 offen offset:2048 sc1
    buffer_load_dwordx4 a[24:27], v188, s[40:43], s63 offen offset:3072 sc1
    s_add_u32 s63, s10, 28672
    buffer_load_dwordx4 a[28:31], v188, s[40:43], s63 offen offset:0 sc1
    buffer_load_dwordx4 a[32:35], v188, s[40:43], s63 offen offset:1024 sc1
    buffer_load_dwordx4 a[36:39], v188, s[40:43], s63 offen offset:2048 sc1
    buffer_load_dwordx4 a[40:43], v188, s[40:43], s63 offen offset:3072 sc1
    s_add_u32 s63, s10, 32768
    buffer_load_dwordx4 a[44:47], v188, s[40:43], s63 offen offset:0 sc1
    buffer_load_dwordx4 a[48:51], v188, s[40:43], s63 offen offset:1024 sc1
    buffer_load_dwordx4 a[52:55], v188, s[40:43], s63 offen offset:2048 sc1
    buffer_load_dwordx4 a[56:59], v188, s[40:43], s63 offen offset:3072 sc1
    s_add_u32 s63, s10, 36864
    buffer_load_dwordx4 a[60:63], v188, s[40:43], s63 offen offset:0 sc1
    buffer_load_dwordx4 a[64:67], v188, s[40:43], s63 offen offset:1024 sc1
    buffer_load_dwordx4 a[68:71], v188, s[40:43], s63 offen offset:2048 sc1
    buffer_load_dwordx4 a[72:75], v188, s[40:43], s63 offen offset:3072 sc1
    s_add_u32 s63, s10, 40960
    buffer_load_dwordx4 a[76:79], v188, s[40:43], s63 offen offset:0 sc1
    s_waitcnt vmcnt(40)
    buffer_load_dwordx4 a[80:83], v188, s[40:43], s63 offen offset:1024 sc1
    s_waitcnt vmcnt(40)
    buffer_load_dwordx4 a[84:87], v188, s[40:43], s63 offen offset:2048 sc1
    s_waitcnt vmcnt(40)
    buffer_load_dwordx4 a[88:91], v188, s[40:43], s63 offen offset:3072 sc1
    s_waitcnt vmcnt(40)
    s_add_u32 s63, s10, 45056
    buffer_load_dwordx4 a[92:95], v188, s[40:43], s63 offen offset:0 sc1
    s_waitcnt vmcnt(40)
    buffer_load_dwordx4 a[96:99], v188, s[40:43], s63 offen offset:1024 sc1
    s_waitcnt vmcnt(40)
    buffer_load_dwordx4 a[100:103], v188, s[40:43], s63 offen offset:2048 sc1
    s_waitcnt vmcnt(40)
    buffer_load_dwordx4 a[104:107], v188, s[40:43], s63 offen offset:3072 sc1
    s_waitcnt vmcnt(40)
    s_add_u32 s63, s10, 49152
    buffer_load_dwordx4 a[108:111], v188, s[40:43], s63 offen offset:0 sc1
    s_waitcnt vmcnt(40)
    buffer_load_dwordx4 a[112:115], v188, s[40:43], s63 offen offset:1024 sc1
    s_waitcnt vmcnt(40)
    buffer_load_dwordx4 a[116:119], v188, s[40:43], s63 offen offset:2048 sc1
    s_waitcnt vmcnt(40)
    buffer_load_dwordx4 a[120:123], v188, s[40:43], s63 offen offset:3072 sc1
    s_waitcnt vmcnt(40)
    s_add_u32 s63, s10, 53248
    buffer_load_dwordx4 a[124:127], v188, s[40:43], s63 offen offset:0 sc1
    s_waitcnt vmcnt(40)
    buffer_load_dwordx4 a[128:131], v188, s[40:43], s63 offen offset:1024 sc1
    s_waitcnt vmcnt(40)
    buffer_load_dwordx4 a[132:135], v188, s[40:43], s63 offen offset:2048 sc1
    s_waitcnt vmcnt(40)
    buffer_load_dwordx4 a[136:139], v188, s[40:43], s63 offen offset:3072 sc1
    s_waitcnt vmcnt(40)
    s_add_u32 s63, s10, 57344
    buffer_load_dwordx4 a[140:143], v188, s[40:43], s63 offen offset:0 sc1
    s_waitcnt vmcnt(40)
    buffer_load_dwordx4 a[144:147], v188, s[40:43], s63 offen offset:1024 sc1
    s_waitcnt vmcnt(40)
    buffer_load_dwordx4 a[148:151], v188, s[40:43], s63 offen offset:2048 sc1
    s_waitcnt vmcnt(40)
    buffer_load_dwordx4 a[152:155], v188, s[40:43], s63 offen offset:3072 sc1
    s_waitcnt vmcnt(40)
    s_add_u32 s63, s11, 0
    buffer_load_dwordx4 a[156:159], v188, s[40:43], s63 offen offset:0 sc1
    s_waitcnt vmcnt(40)
    buffer_load_dwordx4 a[160:163], v188, s[40:43], s63 offen offset:1024 sc1
    s_waitcnt vmcnt(40)
    buffer_load_dwordx4 a[164:167], v188, s[40:43], s63 offen offset:2048 sc1
    s_waitcnt vmcnt(40)
    buffer_load_dwordx4 a[168:171], v188, s[40:43], s63 offen offset:3072 sc1
    s_waitcnt vmcnt(40)
    s_add_u32 s63, s11, 4096
    buffer_load_dwordx4 a[172:175], v188, s[40:43], s63 offen offset:0 sc1
    s_waitcnt vmcnt(40)
    buffer_load_dwordx4 a[176:179], v188, s[40:43], s63 offen offset:1024 sc1
    s_waitcnt vmcnt(40)
    buffer_load_dwordx4 a[180:183], v188, s[40:43], s63 offen offset:2048 sc1
    s_waitcnt vmcnt(40)
    buffer_load_dwordx4 a[184:187], v188, s[40:43], s63 offen offset:3072 sc1
    s_waitcnt vmcnt(40)
    s_add_u32 s63, s11, 8192
    buffer_load_dwordx4 a[188:191], v188, s[40:43], s63 offen offset:0 sc1
    s_waitcnt vmcnt(40)
    buffer_load_dwordx4 a[192:195], v188, s[40:43], s63 offen offset:1024 sc1
    s_waitcnt vmcnt(40)
    buffer_load_dwordx4 a[196:199], v188, s[40:43], s63 offen offset:2048 sc1
    s_waitcnt vmcnt(40)
    buffer_load_dwordx4 a[200:203], v188, s[40:43], s63 offen offset:3072 sc1
    s_waitcnt vmcnt(40)
    s_add_u32 s63, s11, 12288
    buffer_load_dwordx4 a[204:207], v188, s[40:43], s63 offen offset:0 sc1
    s_waitcnt vmcnt(40)
    buffer_load_dwordx4 a[208:211], v188, s[40:43], s63 offen offset:1024 sc1
    s_waitcnt vmcnt(40)
    buffer_load_dwordx4 a[212:215], v188, s[40:43], s63 offen offset:2048 sc1
    s_waitcnt vmcnt(40)
    buffer_load_dwordx4 a[216:219], v188, s[40:43], s63 offen offset:3072 sc1
    s_waitcnt vmcnt(40)
    s_add_u32 s63, s11, 16384
    buffer_load_dwordx4 a[220:223], v188, s[40:43], s63 offen offset:0 sc1
    s_waitcnt vmcnt(40)
    buffer_load_dwordx4 a[224:227], v188, s[40:43], s63 offen offset:1024 sc1
    s_waitcnt vmcnt(40)
    buffer_load_dwordx4 a[228:231], v188, s[40:43], s63 offen offset:2048 sc1
    s_waitcnt vmcnt(40)
    buffer_load_dwordx4 a[232:235], v188, s[40:43], s63 offen offset:3072 sc1
    s_waitcnt vmcnt(40)
    s_add_u32 s63, s3, 0
    buffer_load_dwordx4 a[236:239], v188, s[40:43], s63 offen offset:0 sc1
    s_waitcnt vmcnt(40)
    buffer_load_dwordx4 a[240:243], v188, s[40:43], s63 offen offset:1024 sc1
    s_waitcnt vmcnt(40)
    buffer_load_dwordx4 a[244:247], v188, s[40:43], s63 offen offset:2048 sc1
    s_waitcnt vmcnt(40)
    buffer_load_dwordx4 a[248:251], v188, s[40:43], s63 offen offset:3072 sc1
    s_waitcnt vmcnt(40)
    s_add_u32 s63, s3, 4096
    buffer_load_dwordx4 a[252:255], v188, s[40:43], s63 offen offset:0 sc1
    s_waitcnt vmcnt(40)
    s_and_b32 s57, s2, 6
    s_lshl_b32 s57, s57, 2
    s_bfe_u32 s58, s2, 0x10005
    s_lshl_b32 s58, s58, 2
    s_add_u32 s57, s57, s58
    s_and_b32 s58, s55, 3
    s_add_u32 s58, s58, s57
    s_mul_i32 s59, s58, 43
    s_lshr_b32 s59, s59, 7
    s_bfe_u32 s60, s55, 0x20002
    s_mul_i32 s45, s59, 6144
    s_lshl_b32 s53, s60, 7
    s_add_u32 s45, s45, s53
    s_cmp_lt_u32 s58, 30
    s_cselect_b32 s53, 3, 2
    s_mul_i32 s60, s60, s53
    s_mul_i32 s4, s59, 9
    s_add_u32 s4, s4, s58
    s_add_u32 s4, s4, s60
    s_add_u32 s55, s55, s56
    s_and_b32 s58, s55, 3
    s_add_u32 s58, s58, s57
    s_mul_i32 s59, s58, 43
    s_lshr_b32 s59, s59, 7
    s_bfe_u32 s60, s55, 0x20002
    s_mul_i32 s46, s59, 6144
    s_lshl_b32 s53, s60, 7
    s_add_u32 s46, s46, s53
    s_cmp_lt_u32 s58, 30
    s_cselect_b32 s53, 3, 2
    s_mul_i32 s60, s60, s53
    s_mul_i32 s5, s59, 9
    s_add_u32 s5, s5, s58
    s_add_u32 s5, s5, s60
    s_mul_i32 s12, s44, 12288
    s_add_u32 s12, s12, 20480
    s_mul_i32 s59, s44, 3
    v_add_u32 v190, s59, v185
    v_lshlrev_b32 v190, 9, v190
    s_mov_b32 vcc_lo, 7
    s_mov_b32 vcc_hi, 0
    v_mov_b32_e64 v191, 0x40000000
    v_cndmask_b32 v190, v191, v190, vcc
    buffer_load_dword v191, v190, s[68:71], s45 offen sc1
    s_add_u32 s55, s55, s56
    s_and_b32 s58, s55, 3
    s_add_u32 s58, s58, s57
    s_mul_i32 s59, s58, 43
    s_lshr_b32 s59, s59, 7
    s_bfe_u32 s60, s55, 0x20002
    s_mul_i32 s47, s59, 6144
    s_lshl_b32 s53, s60, 7
    s_add_u32 s47, s47, s53
    s_cmp_lt_u32 s58, 30
    s_cselect_b32 s53, 3, 2
    s_mul_i32 s60, s60, s53
    s_mul_i32 s6, s59, 9
    s_add_u32 s6, s6, s58
    s_add_u32 s6, s6, s60
    s_waitcnt vmcnt(0)
    v_cmp_le_u32 vcc, 1, v191
    s_nop 0
    s_andn2_b32 s84, 0x7, vcc_lo
    s_cbranch_scc1 L_retry88
L_ok88:
    s_mul_i32 s51, s4, 69632
    s_add_u32 s62, s51, s12
    buffer_load_dwordx4 v[84:87], v188, s[32:35], s62 offen offset:0 sc1
    buffer_load_dwordx4 v[88:91], v188, s[32:35], s62 offen offset:1024 sc1
    buffer_load_dwordx4 v[92:95], v188, s[32:35], s62 offen offset:2048 sc1
    v_mov_b32_e64 v191, 0
    s_nop 0
    buffer_load_dword v191, v190, s[68:71], s46 offen sc1
    buffer_load_dwordx4 v[96:99], v188, s[32:35], s62 offen offset:3072 sc1
    s_add_u32 s62, s62, 4096
    buffer_load_dwordx4 v[100:103], v188, s[32:35], s62 offen offset:0 sc1
    buffer_load_dwordx4 v[104:107], v188, s[32:35], s62 offen offset:1024 sc1
    buffer_load_dwordx4 v[108:111], v188, s[32:35], s62 offen offset:2048 sc1
    buffer_load_dwordx4 v[112:115], v188, s[32:35], s62 offen offset:3072 sc1
    s_add_u32 s62, s62, 4096
    buffer_load_dwordx4 v[116:119], v188, s[32:35], s62 offen offset:0 sc1
    buffer_load_dwordx4 v[120:123], v188, s[32:35], s62 offen offset:1024 sc1
    buffer_load_dwordx4 v[124:127], v188, s[32:35], s62 offen offset:2048 sc1
    buffer_load_dwordx4 v[128:131], v188, s[32:35], s62 offen offset:3072 sc1
    s_waitcnt vmcnt(12)
    v_mfma_f32_16x16x32_bf16 v[192:195], v[0:3], v[84:87], 0
    s_add_u32 s55, s55, s56
    s_and_b32 s58, s55, 3
    s_add_u32 s58, s58, s57
    v_mfma_f32_16x16x32_bf16 v[196:199], v[4:7], v[84:87], 0
    v_cmp_le_u32_e64 vcc, 1, v191
    s_mul_i32 s59, s58, 43
    s_lshr_b32 s59, s59, 7
    v_mfma_f32_16x16x32_bf16 v[200:203], v[8:11], v[84:87], 0
    s_andn2_b32 s84, 0x7, vcc_lo
    s_cbranch_scc1 L_retry89
L_ok89:
    s_bfe_u32 s60, s55, 0x20002
    v_mfma_f32_16x16x32_bf16 v[204:207], v[12:15], v[84:87], 0
    s_mul_i32 s51, s5, 69632
    s_mul_i32 s48, s59, 6144
    s_lshl_b32 s53, s60, 7
    v_mfma_f32_16x16x32_bf16 v[208:211], v[16:19], v[84:87], 0
    s_waitcnt vmcnt(11)
    s_add_u32 s62, s51, s12
    s_add_u32 s48, s48, s53
    v_mfma_f32_16x16x32_bf16 v[192:195], v[20:23], v[88:91], v[192:195]
    buffer_load_dwordx4 v[84:87], v188, s[32:35], s62 offen offset:0 sc1
    v_mfma_f32_16x16x32_bf16 v[196:199], v[24:27], v[88:91], v[196:199]
    s_cmp_lt_u32 s58, 30
    s_cselect_b32 s53, 3, 2
    s_mul_i32 s60, s60, s53
    v_mfma_f32_16x16x32_bf16 v[200:203], v[28:31], v[88:91], v[200:203]
    s_mul_i32 s7, s59, 9
    s_add_u32 s7, s7, s58
    s_add_u32 s7, s7, s60
    v_mfma_f32_16x16x32_bf16 v[204:207], v[32:35], v[88:91], v[204:207]
    v_lshlrev_b32_e64 v252, 7, v185
    s_mul_i32 s59, s4, 205
    s_lshr_b32 s59, s59, 11
    v_mfma_f32_16x16x32_bf16 v[208:211], v[36:39], v[88:91], v[208:211]
    s_waitcnt vmcnt(11)
    s_lshl_b32 s59, s59, 10
    s_lshl_b32 s60, s44, 8
    v_mfma_f32_16x16x32_bf16 v[192:195], v[40:43], v[92:95], v[192:195]
    buffer_load_dwordx4 v[88:91], v188, s[32:35], s62 offen offset:1024 sc1
    v_mfma_f32_16x16x32_bf16 v[196:199], v[44:47], v[92:95], v[196:199]
    s_add_u32 s59, s59, s60
    s_add_u32 s59, s59, 67584
    v_add_u32 v173, s59, v252
    v_mfma_f32_16x16x32_bf16 v[200:203], v[48:51], v[92:95], v[200:203]
    s_mul_i32 s59, s5, 205
    s_lshr_b32 s59, s59, 11
    s_lshl_b32 s59, s59, 10
    v_mfma_f32_16x16x32_bf16 v[204:207], v[52:55], v[92:95], v[204:207]
    s_lshl_b32 s60, s44, 8
    s_add_u32 s59, s59, s60
    s_add_u32 s59, s59, 67328
    v_mfma_f32_16x16x32_bf16 v[208:211], v[56:59], v[92:95], v[208:211]
    s_waitcnt vmcnt(10)
    v_cmp_le_u32 s[8:9], 2, v185
    v_add_u32 v174, s59, v252
    v_mfma_f32_16x16x32_bf16 v[192:195], v[60:63], v[96:99], v[192:195]
    buffer_load_dwordx4 v[92:95], v188, s[32:35], s62 offen offset:2048 sc1
    v_mfma_f32_16x16x32_bf16 v[196:199], v[64:67], v[96:99], v[196:199]
    s_nop 0
    v_cndmask_b32 v173, v173, v174, s[8:9]
    s_mul_i32 s59, s6, 205
    v_mfma_f32_16x16x32_bf16 v[200:203], v[68:71], v[96:99], v[200:203]
    s_lshr_b32 s59, s59, 11
    s_lshl_b32 s59, s59, 10
    s_lshl_b32 s60, s44, 8
    v_mfma_f32_16x16x32_bf16 v[204:207], v[72:75], v[96:99], v[204:207]
    v_mov_b32 v191, 0
    s_add_u32 s59, s59, s60
    s_add_u32 s59, s59, 67072
    v_mfma_f32_16x16x32_bf16 v[208:211], v[76:79], v[96:99], v[208:211]
    s_waitcnt vmcnt(10)
    v_cmp_le_u32 s[8:9], 4, v185
    v_add_u32 v174, s59, v252
    v_mfma_f32_16x16x32_bf16 v[192:195], v[80:83], v[100:103], v[192:195]
    buffer_load_dword v191, v190, s[68:71], s47 offen sc1
    v_mfma_f32_16x16x32_bf16 v[196:199], a[0:3], v[100:103], v[196:199]
    buffer_load_dwordx4 v[96:99], v188, s[32:35], s62 offen offset:3072 sc1
    v_mfma_f32_16x16x32_bf16 v[200:203], a[4:7], v[100:103], v[200:203]
    s_nop 0
    v_cndmask_b32 v173, v173, v174, s[8:9]
    s_mul_i32 s59, s7, 205
    v_mfma_f32_16x16x32_bf16 v[204:207], a[8:11], v[100:103], v[204:207]
    s_lshr_b32 s59, s59, 11
    s_lshl_b32 s59, s59, 10
    s_lshl_b32 s60, s44, 8
    v_mfma_f32_16x16x32_bf16 v[208:211], a[12:15], v[100:103], v[208:211]
    s_waitcnt vmcnt(11)
    s_add_u32 s62, s62, 4096
    s_add_u32 s59, s59, s60
    v_mfma_f32_16x16x32_bf16 v[192:195], a[16:19], v[104:107], v[192:195]
    buffer_load_dwordx4 v[100:103], v188, s[32:35], s62 offen offset:0 sc1
    v_mfma_f32_16x16x32_bf16 v[196:199], a[20:23], v[104:107], v[196:199]
    s_add_u32 s59, s59, 66816
    v_cmp_le_u32 s[8:9], 6, v185
    v_add_u32_e64 v174, s59, v252
    v_mfma_f32_16x16x32_bf16 v[200:203], a[24:27], v[104:107], v[200:203]
    s_nop 0
    v_cndmask_b32 v173, v173, v174, s[8:9]
    v_cmp_le_u32 s[8:9], 8, v185
    v_mfma_f32_16x16x32_bf16 v[204:207], a[28:31], v[104:107], v[204:207]
    v_mov_b32_e64 v174, 0x40000000
    s_nop 0
    v_cndmask_b32 v173, v173, v174, s[8:9]
    v_mfma_f32_16x16x32_bf16 v[208:211], a[32:35], v[104:107], v[208:211]
    s_waitcnt vmcnt(11)
    v_mov_b32_e64 v174, 0
    s_lshl_b32 s13, s44, 12
    v_mfma_f32_16x16x32_bf16 v[192:195], a[36:39], v[108:111], v[192:195]
    buffer_load_dwordx4 v[104:107], v188, s[32:35], s62 offen offset:1024 sc1
    v_mfma_f32_16x16x32_bf16 v[196:199], a[40:43], v[108:111], v[196:199]
    s_lshl_b32 s14, s44, 10
    s_add_u32 s14, s14, 16384
    v_lshrrev_b32 v252, 4, v185
    v_mfma_f32_16x16x32_bf16 v[200:203], a[44:47], v[108:111], v[200:203]
    v_lshlrev_b32 v252, 8, v252
    v_and_b32 v172, 15, v185
    v_mfma_f32_16x16x32_bf16 v[204:207], a[48:51], v[108:111], v[204:207]
    v_lshl_add_u32 v172, v172, 3, v252
    v_and_b32_e64 v176, 15, v185
    v_mfma_f32_16x16x32_bf16 v[208:211], a[52:55], v[108:111], v[208:211]
    s_waitcnt vmcnt(11)
    v_lshlrev_b32_e64 v176, 2, v176
    s_lshl_b32 s59, s44, 13
    v_mfma_f32_16x16x32_bf16 v[192:195], a[56:59], v[112:115], v[192:195]
    buffer_load_dwordx4 v[108:111], v188, s[32:35], s62 offen offset:2048 sc1
    v_mfma_f32_16x16x32_bf16 v[196:199], a[60:63], v[112:115], v[196:199]
    v_add_u32_e64 v176, s59, v176
    s_mul_i32 s59, s44, 5376
    s_add_u32 s59, s59, 0
    v_mfma_f32_16x16x32_bf16 v[200:203], a[64:67], v[112:115], v[200:203]
    v_bfe_u32 v252, v185, 4, 1
    v_mul_u32_u24 v252, 2624, v252
    v_mfma_f32_16x16x32_bf16 v[204:207], a[68:71], v[112:115], v[204:207]
    v_and_b32 v180, 15, v185
    v_mul_u32_u24 v180, 160, v180
    v_mfma_f32_16x16x32_bf16 v[208:211], a[72:75], v[112:115], v[208:211]
    s_waitcnt vmcnt(11)
    v_add3_u32 v180, v252, v180, s59
    v_lshrrev_b32 v252, 5, v185
    v_mfma_f32_16x16x32_bf16 v[192:195], a[76:79], v[116:119], v[192:195]
    buffer_load_dwordx4 v[112:115], v188, s[32:35], s62 offen offset:3072 sc1
    v_mfma_f32_16x16x32_bf16 v[196:199], a[80:83], v[116:119], v[196:199]
    v_lshl_add_u32 v180, v252, 4, v180
    v_add_u32 v181, 0xaa00, v180
    v_mfma_f32_16x16x32_bf16 v[200:203], a[84:87], v[116:119], v[200:203]
    v_mul_u32_u24 v252, 205, v185
    v_lshrrev_b32_e64 v252, 11, v252
    v_mfma_f32_16x16x32_bf16 v[204:207], a[88:91], v[116:119], v[204:207]
    v_mul_u32_u24 v175, 10, v252
    v_sub_u32_e64 v175, v185, v175
    s_lshl_b32 s59, s44, 2
    v_mfma_f32_16x16x32_bf16 v[208:211], a[92:95], v[116:119], v[208:211]
    s_waitcnt vmcnt(11)
    s_add_u32 s62, s62, 4096
    v_add_u32 v252, s59, v252
    v_mfma_f32_16x16x32_bf16 v[192:195], a[96:99], v[120:123], v[192:195]
    buffer_load_dwordx4 v[116:119], v188, s[32:35], s62 offen offset:0 sc1
    v_mfma_f32_16x16x32_bf16 v[196:199], a[100:103], v[120:123], v[196:199]
    v_and_b32_e64 v252, 15, v252
    s_mul_i32 s59, s44, 640
    s_add_u32 s59, s59, 0
    v_mfma_f32_16x16x32_bf16 v[200:203], a[104:107], v[120:123], v[200:203]
    v_add_u32 v182, s59, v188
    v_add_u32 v183, 0xaa00, v182
    v_mfma_f32_16x16x32_bf16 v[204:207], a[108:111], v[120:123], v[204:207]
    v_lshlrev_b32_e64 v175, 4, v175
    v_mul_u32_u24 v252, 1280, v252
    v_mfma_f32_16x16x32_bf16 v[208:211], a[112:115], v[120:123], v[208:211]
    s_waitcnt vmcnt(11)
    v_add_u32 v175, v175, v252
    v_cmp_gt_u32 s[8:9], 40, v185
    v_mfma_f32_16x16x32_bf16 v[192:195], a[116:119], v[124:127], v[192:195]
    buffer_load_dwordx4 v[120:123], v188, s[32:35], s62 offen offset:1024 sc1
    v_mfma_f32_16x16x32_bf16 v[196:199], a[120:123], v[124:127], v[196:199]
    v_mov_b32_e64 v252, 0x40000000
    s_mul_i32 s15, s54, 160
    v_cndmask_b32 v175, v252, v175, s[8:9]
    v_mfma_f32_16x16x32_bf16 v[200:203], a[124:127], v[124:127], v[200:203]
    v_mfma_f32_16x16x32_bf16 v[204:207], a[128:131], v[124:127], v[204:207]
    v_mfma_f32_16x16x32_bf16 v[208:211], a[132:135], v[124:127], v[208:211]
    s_waitcnt vmcnt(11)
    v_mfma_f32_16x16x32_bf16 v[192:195], a[136:139], v[128:131], v[192:195]
    buffer_load_dwordx4 v[124:127], v188, s[32:35], s62 offen offset:2048 sc1
    v_mfma_f32_16x16x32_bf16 v[196:199], a[140:143], v[128:131], v[196:199]
    v_mfma_f32_16x16x32_bf16 v[200:203], a[144:147], v[128:131], v[200:203]
    v_mfma_f32_16x16x32_bf16 v[204:207], a[148:151], v[128:131], v[204:207]
    v_mfma_f32_16x16x32_bf16 v[208:211], a[152:155], v[128:131], v[208:211]
    s_waitcnt vmcnt(11)
    v_mfma_f32_16x16x32_bf16 v[212:215], v[0:3], v[84:87], 0
    buffer_load_dwordx4 v[128:131], v188, s[32:35], s62 offen offset:3072 sc1
    v_mfma_f32_16x16x32_bf16 v[216:219], v[4:7], v[84:87], 0
    v_cmp_le_u32_e64 vcc, 1, v191
    v_mfma_f32_16x16x32_bf16 v[220:223], v[8:11], v[84:87], 0
    s_andn2_b32 s84, 0x7, vcc_lo
    s_cbranch_scc1 L_retry90
L_ok90:
    v_mfma_f32_16x16x32_bf16 v[224:227], v[12:15], v[84:87], 0
    s_mul_i32 s51, s6, 69632
    v_mfma_f32_16x16x32_bf16 v[228:231], v[16:19], v[84:87], 0
    s_waitcnt vmcnt(11)
    s_add_u32 s62, s51, s12
    v_mfma_f32_16x16x32_bf16 v[212:215], v[20:23], v[88:91], v[212:215]
    buffer_load_dwordx4 v[84:87], v188, s[32:35], s62 offen offset:0 sc1
    v_mfma_f32_16x16x32_bf16 v[216:219], v[24:27], v[88:91], v[216:219]
    v_mfma_f32_16x16x32_bf16 v[220:223], v[28:31], v[88:91], v[220:223]
    v_mfma_f32_16x16x32_bf16 v[224:227], v[32:35], v[88:91], v[224:227]
    v_mfma_f32_16x16x32_bf16 v[228:231], v[36:39], v[88:91], v[228:231]
    s_waitcnt vmcnt(11)
    v_mfma_f32_16x16x32_bf16 v[212:215], v[40:43], v[92:95], v[212:215]
    buffer_load_dwordx4 v[88:91], v188, s[32:35], s62 offen offset:1024 sc1
    v_mfma_f32_16x16x32_bf16 v[216:219], v[44:47], v[92:95], v[216:219]
    v_mfma_f32_16x16x32_bf16 v[220:223], v[48:51], v[92:95], v[220:223]
    v_mfma_f32_16x16x32_bf16 v[224:227], v[52:55], v[92:95], v[224:227]
    v_mfma_f32_16x16x32_bf16 v[228:231], v[56:59], v[92:95], v[228:231]
    s_waitcnt vmcnt(10)
    v_mfma_f32_16x16x32_bf16 v[212:215], v[60:63], v[96:99], v[212:215]
    buffer_load_dwordx4 v[92:95], v188, s[32:35], s62 offen offset:2048 sc1
    v_mfma_f32_16x16x32_bf16 v[216:219], v[64:67], v[96:99], v[216:219]
    v_mfma_f32_16x16x32_bf16 v[220:223], v[68:71], v[96:99], v[220:223]
    v_mfma_f32_16x16x32_bf16 v[224:227], v[72:75], v[96:99], v[224:227]
    v_mov_b32_e64 v191, 0
    v_mfma_f32_16x16x32_bf16 v[228:231], v[76:79], v[96:99], v[228:231]
    s_waitcnt vmcnt(10)
    v_mfma_f32_16x16x32_bf16 v[212:215], v[80:83], v[100:103], v[212:215]
    buffer_load_dword v191, v190, s[68:71], s48 offen sc1
    v_mfma_f32_16x16x32_bf16 v[216:219], a[0:3], v[100:103], v[216:219]
    buffer_load_dwordx4 v[96:99], v188, s[32:35], s62 offen offset:3072 sc1
    v_mfma_f32_16x16x32_bf16 v[220:223], a[4:7], v[100:103], v[220:223]
    v_mfma_f32_16x16x32_bf16 v[224:227], a[8:11], v[100:103], v[224:227]
    v_mfma_f32_16x16x32_bf16 v[228:231], a[12:15], v[100:103], v[228:231]
    s_waitcnt vmcnt(11)
    s_add_u32 s62, s62, 4096
    v_mfma_f32_16x16x32_bf16 v[212:215], a[16:19], v[104:107], v[212:215]
    buffer_load_dwordx4 v[100:103], v188, s[32:35], s62 offen offset:0 sc1
    v_mfma_f32_16x16x32_bf16 v[216:219], a[20:23], v[104:107], v[216:219]
    v_mfma_f32_16x16x32_bf16 v[220:223], a[24:27], v[104:107], v[220:223]
    v_mfma_f32_16x16x32_bf16 v[224:227], a[28:31], v[104:107], v[224:227]
    v_mfma_f32_16x16x32_bf16 v[228:231], a[32:35], v[104:107], v[228:231]
    s_waitcnt vmcnt(11)
    v_mfma_f32_16x16x32_bf16 v[212:215], a[36:39], v[108:111], v[212:215]
    buffer_load_dwordx4 v[104:107], v188, s[32:35], s62 offen offset:1024 sc1
    v_mfma_f32_16x16x32_bf16 v[216:219], a[40:43], v[108:111], v[216:219]
    v_mfma_f32_16x16x32_bf16 v[220:223], a[44:47], v[108:111], v[220:223]
    v_mfma_f32_16x16x32_bf16 v[224:227], a[48:51], v[108:111], v[224:227]
    v_mfma_f32_16x16x32_bf16 v[228:231], a[52:55], v[108:111], v[228:231]
    s_waitcnt vmcnt(11)
    v_mfma_f32_16x16x32_bf16 v[212:215], a[56:59], v[112:115], v[212:215]
    buffer_load_dwordx4 v[108:111], v188, s[32:35], s62 offen offset:2048 sc1
    v_mfma_f32_16x16x32_bf16 v[216:219], a[60:63], v[112:115], v[216:219]
    v_mfma_f32_16x16x32_bf16 v[220:223], a[64:67], v[112:115], v[220:223]
    v_mfma_f32_16x16x32_bf16 v[224:227], a[68:71], v[112:115], v[224:227]
    v_mfma_f32_16x16x32_bf16 v[228:231], a[72:75], v[112:115], v[228:231]
    s_waitcnt vmcnt(11)
    v_mfma_f32_16x16x32_bf16 v[212:215], a[76:79], v[116:119], v[212:215]
    buffer_load_dwordx4 v[112:115], v188, s[32:35], s62 offen offset:3072 sc1
    v_mfma_f32_16x16x32_bf16 v[216:219], a[80:83], v[116:119], v[216:219]
    v_mfma_f32_16x16x32_bf16 v[220:223], a[84:87], v[116:119], v[220:223]
    v_mfma_f32_16x16x32_bf16 v[224:227], a[88:91], v[116:119], v[224:227]
    v_mfma_f32_16x16x32_bf16 v[228:231], a[92:95], v[116:119], v[228:231]
    s_waitcnt vmcnt(11)
    s_add_u32 s62, s62, 4096
    v_mfma_f32_16x16x32_bf16 v[212:215], a[96:99], v[120:123], v[212:215]
    buffer_load_dwordx4 v[116:119], v188, s[32:35], s62 offen offset:0 sc1
    v_mfma_f32_16x16x32_bf16 v[216:219], a[100:103], v[120:123], v[216:219]
    v_mfma_f32_16x16x32_bf16 v[220:223], a[104:107], v[120:123], v[220:223]
    v_mfma_f32_16x16x32_bf16 v[224:227], a[108:111], v[120:123], v[224:227]
    v_mfma_f32_16x16x32_bf16 v[228:231], a[112:115], v[120:123], v[228:231]
    s_waitcnt vmcnt(11)
    v_mfma_f32_16x16x32_bf16 v[212:215], a[116:119], v[124:127], v[212:215]
    buffer_load_dwordx4 v[120:123], v188, s[32:35], s62 offen offset:1024 sc1
    v_mfma_f32_16x16x32_bf16 v[216:219], a[120:123], v[124:127], v[216:219]
    v_mfma_f32_16x16x32_bf16 v[220:223], a[124:127], v[124:127], v[220:223]
    v_mfma_f32_16x16x32_bf16 v[224:227], a[128:131], v[124:127], v[224:227]
    v_mfma_f32_16x16x32_bf16 v[228:231], a[132:135], v[124:127], v[228:231]
    s_waitcnt vmcnt(11)
    v_mfma_f32_16x16x32_bf16 v[212:215], a[136:139], v[128:131], v[212:215]
    buffer_load_dwordx4 v[124:127], v188, s[32:35], s62 offen offset:2048 sc1
    v_mfma_f32_16x16x32_bf16 v[216:219], a[140:143], v[128:131], v[216:219]
    v_mfma_f32_16x16x32_bf16 v[220:223], a[144:147], v[128:131], v[220:223]
    v_mfma_f32_16x16x32_bf16 v[224:227], a[148:151], v[128:131], v[224:227]
    v_mfma_f32_16x16x32_bf16 v[228:231], a[152:155], v[128:131], v[228:231]
    s_waitcnt vmcnt(11)
    v_mfma_f32_16x16x32_bf16 v[132:135], v[0:3], v[84:87], 0
    buffer_load_dwordx4 v[128:131], v188, s[32:35], s62 offen offset:3072 sc1
    v_mfma_f32_16x16x32_bf16 v[136:139], v[4:7], v[84:87], 0
    v_cmp_le_u32 vcc, 1, v191
    v_mfma_f32_16x16x32_bf16 v[140:143], v[8:11], v[84:87], 0
    s_andn2_b32 s84, 0x7, vcc_lo
    s_cbranch_scc1 L_retry91
L_ok91:
    v_mfma_f32_16x16x32_bf16 v[144:147], v[12:15], v[84:87], 0
    s_mul_i32 s51, s7, 69632
    v_mfma_f32_16x16x32_bf16 v[148:151], v[16:19], v[84:87], 0
    s_waitcnt vmcnt(11)
    s_add_u32 s62, s51, s12
    v_mfma_f32_16x16x32_bf16 v[132:135], v[20:23], v[88:91], v[132:135]
    buffer_load_dwordx4 v[84:87], v188, s[32:35], s62 offen offset:0 sc1
    v_mfma_f32_16x16x32_bf16 v[136:139], v[24:27], v[88:91], v[136:139]
    v_mfma_f32_16x16x32_bf16 v[140:143], v[28:31], v[88:91], v[140:143]
    v_mfma_f32_16x16x32_bf16 v[144:147], v[32:35], v[88:91], v[144:147]
    v_mfma_f32_16x16x32_bf16 v[148:151], v[36:39], v[88:91], v[148:151]
    s_waitcnt vmcnt(11)
    v_mfma_f32_16x16x32_bf16 v[132:135], v[40:43], v[92:95], v[132:135]
    buffer_load_dwordx4 v[88:91], v188, s[32:35], s62 offen offset:1024 sc1
    v_mfma_f32_16x16x32_bf16 v[136:139], v[44:47], v[92:95], v[136:139]
    v_mfma_f32_16x16x32_bf16 v[140:143], v[48:51], v[92:95], v[140:143]
    v_mfma_f32_16x16x32_bf16 v[144:147], v[52:55], v[92:95], v[144:147]
    v_mfma_f32_16x16x32_bf16 v[148:151], v[56:59], v[92:95], v[148:151]
    s_waitcnt vmcnt(10)
    v_mfma_f32_16x16x32_bf16 v[132:135], v[60:63], v[96:99], v[132:135]
    buffer_load_dwordx4 v[92:95], v188, s[32:35], s62 offen offset:2048 sc1
    v_mfma_f32_16x16x32_bf16 v[136:139], v[64:67], v[96:99], v[136:139]
    v_mfma_f32_16x16x32_bf16 v[140:143], v[68:71], v[96:99], v[140:143]
    v_mfma_f32_16x16x32_bf16 v[144:147], v[72:75], v[96:99], v[144:147]
    v_cmp_le_u32 s[22:23], 1, v174
    v_mfma_f32_16x16x32_bf16 v[148:151], v[76:79], v[96:99], v[148:151]
    s_waitcnt vmcnt(10)
    s_andn2_b32 s84, 0xff, s22
    s_cbranch_scc1 L_ps92
L_pr92:
    v_mfma_f32_16x16x32_bf16 v[132:135], v[80:83], v[100:103], v[132:135]
    buffer_load_dwordx4 v[96:99], v188, s[32:35], s62 offen offset:3072 sc1
    v_mfma_f32_16x16x32_bf16 v[136:139], a[0:3], v[100:103], v[136:139]
    v_mfma_f32_16x16x32_bf16 v[140:143], a[4:7], v[100:103], v[140:143]
    v_mfma_f32_16x16x32_bf16 v[144:147], a[8:11], v[100:103], v[144:147]
    v_mfma_f32_16x16x32_bf16 v[148:151], a[12:15], v[100:103], v[148:151]
    s_waitcnt vmcnt(10)
    s_add_u32 s62, s62, 4096
    v_mfma_f32_16x16x32_bf16 v[132:135], a[16:19], v[104:107], v[132:135]
    buffer_load_dwordx4 v[100:103], v188, s[32:35], s62 offen offset:0 sc1
    v_mfma_f32_16x16x32_bf16 v[136:139], a[20:23], v[104:107], v[136:139]
    v_mfma_f32_16x16x32_bf16 v[140:143], a[24:27], v[104:107], v[140:143]
    v_mfma_f32_16x16x32_bf16 v[144:147], a[28:31], v[104:107], v[144:147]
    v_mfma_f32_16x16x32_bf16 v[148:151], a[32:35], v[104:107], v[148:151]
    s_waitcnt vmcnt(10)
    v_mfma_f32_16x16x32_bf16 v[132:135], a[36:39], v[108:111], v[132:135]
    buffer_load_dwordx4 v[104:107], v188, s[32:35], s62 offen offset:1024 sc1
    v_mfma_f32_16x16x32_bf16 v[136:139], a[40:43], v[108:111], v[136:139]
    v_mfma_f32_16x16x32_bf16 v[140:143], a[44:47], v[108:111], v[140:143]
    v_mfma_f32_16x16x32_bf16 v[144:147], a[48:51], v[108:111], v[144:147]
    v_mfma_f32_16x16x32_bf16 v[148:151], a[52:55], v[108:111], v[148:151]
    s_waitcnt vmcnt(10)
    v_mfma_f32_16x16x32_bf16 v[132:135], a[56:59], v[112:115], v[132:135]
    buffer_load_dwordx4 v[108:111], v188, s[32:35], s62 offen offset:2048 sc1
    v_mfma_f32_16x16x32_bf16 v[136:139], a[60:63], v[112:115], v[136:139]
    v_mfma_f32_16x16x32_bf16 v[140:143], a[64:67], v[112:115], v[140:143]
    v_mfma_f32_16x16x32_bf16 v[144:147], a[68:71], v[112:115], v[144:147]
    v_mfma_f32_16x16x32_bf16 v[148:151], a[72:75], v[112:115], v[148:151]
    s_waitcnt vmcnt(10)
    v_mfma_f32_16x16x32_bf16 v[132:135], a[76:79], v[116:119], v[132:135]
    buffer_load_dwordx4 v[112:115], v188, s[32:35], s62 offen offset:3072 sc1
    v_mfma_f32_16x16x32_bf16 v[136:139], a[80:83], v[116:119], v[136:139]
    v_mfma_f32_16x16x32_bf16 v[140:143], a[84:87], v[116:119], v[140:143]
    v_mfma_f32_16x16x32_bf16 v[144:147], a[88:91], v[116:119], v[144:147]
    v_mfma_f32_16x16x32_bf16 v[148:151], a[92:95], v[116:119], v[148:151]
    s_waitcnt vmcnt(10)
    s_add_u32 s62, s62, 4096
    v_mfma_f32_16x16x32_bf16 v[132:135], a[96:99], v[120:123], v[132:135]
    buffer_load_dwordx4 v[116:119], v188, s[32:35], s62 offen offset:0 sc1
    v_mfma_f32_16x16x32_bf16 v[136:139], a[100:103], v[120:123], v[136:139]
    v_mfma_f32_16x16x32_bf16 v[140:143], a[104:107], v[120:123], v[140:143]
    v_mfma_f32_16x16x32_bf16 v[144:147], a[108:111], v[120:123], v[144:147]
    v_mfma_f32_16x16x32_bf16 v[148:151], a[112:115], v[120:123], v[148:151]
    s_waitcnt vmcnt(10)
    v_mfma_f32_16x16x32_bf16 v[132:135], a[116:119], v[124:127], v[132:135]
    buffer_load_dwordx4 v[120:123], v188, s[32:35], s62 offen offset:1024 sc1
    v_mfma_f32_16x16x32_bf16 v[136:139], a[120:123], v[124:127], v[136:139]
    v_mfma_f32_16x16x32_bf16 v[140:143], a[124:127], v[124:127], v[140:143]
    v_mfma_f32_16x16x32_bf16 v[144:147], a[128:131], v[124:127], v[144:147]
    v_mfma_f32_16x16x32_bf16 v[148:151], a[132:135], v[124:127], v[148:151]
    s_waitcnt vmcnt(10)
    v_mfma_f32_16x16x32_bf16 v[132:135], a[136:139], v[128:131], v[132:135]
    buffer_load_dwordx4 v[124:127], v188, s[32:35], s62 offen offset:2048 sc1
    v_mfma_f32_16x16x32_bf16 v[136:139], a[140:143], v[128:131], v[136:139]
    v_mfma_f32_16x16x32_bf16 v[140:143], a[144:147], v[128:131], v[140:143]
    v_mfma_f32_16x16x32_bf16 v[144:147], a[148:151], v[128:131], v[144:147]
    v_mfma_f32_16x16x32_bf16 v[148:151], a[152:155], v[128:131], v[148:151]
    s_waitcnt vmcnt(10)
    v_mfma_f32_16x16x32_bf16 v[152:155], v[0:3], v[84:87], 0
    buffer_load_dwordx4 v[128:131], v188, s[32:35], s62 offen offset:3072 sc1
    v_mfma_f32_16x16x32_bf16 v[156:159], v[4:7], v[84:87], 0
    v_cmp_le_u32_e64 vcc, 1, v174
    v_mfma_f32_16x16x32_bf16 v[160:163], v[8:11], v[84:87], 0
    s_andn2_b32 s84, 0x3, vcc_lo
    s_cbranch_scc1 L_retry93
L_ok93:
    v_mfma_f32_16x16x32_bf16 v[164:167], v[12:15], v[84:87], 0
    s_mul_i32 s51, s4, 69632
    v_mfma_f32_16x16x32_bf16 v[168:171], v[16:19], v[84:87], 0
    s_waitcnt vmcnt(10)
    v_cmp_le_u32 s[22:23], 1, v174
    v_mfma_f32_16x16x32_bf16 v[152:155], v[20:23], v[88:91], v[152:155]
    s_andn2_b32 s84, 0xff, s22
    s_cbranch_scc1 L_ps94
L_pr94:
    v_mfma_f32_16x16x32_bf16 v[156:159], v[24:27], v[88:91], v[156:159]
    s_lshl_b32 s62, s4, 6
    v_mfma_f32_16x16x32_bf16 v[160:163], v[28:31], v[88:91], v[160:163]
    buffer_load_dword v177, v176, s[64:67], s62 offen sc1
    v_mfma_f32_16x16x32_bf16 v[164:167], v[32:35], v[88:91], v[164:167]
    s_add_u32 s62, s51, s13
    v_mfma_f32_16x16x32_bf16 v[168:171], v[36:39], v[88:91], v[168:171]
    s_waitcnt vmcnt(10)
    v_mfma_f32_16x16x32_bf16 v[152:155], v[40:43], v[92:95], v[152:155]
    buffer_load_dwordx4 v[84:87], v188, s[32:35], s62 offen offset:0 sc1
    v_mfma_f32_16x16x32_bf16 v[156:159], v[44:47], v[92:95], v[156:159]
    buffer_load_dwordx4 v[88:91], v188, s[32:35], s62 offen offset:1024 sc1
    v_mfma_f32_16x16x32_bf16 v[160:163], v[48:51], v[92:95], v[160:163]
    v_mfma_f32_16x16x32_bf16 v[164:167], v[52:55], v[92:95], v[164:167]
    v_mfma_f32_16x16x32_bf16 v[168:171], v[56:59], v[92:95], v[168:171]
    s_waitcnt vmcnt(11)
    v_mfma_f32_16x16x32_bf16 v[152:155], v[60:63], v[96:99], v[152:155]
    buffer_load_dwordx4 v[92:95], v188, s[32:35], s62 offen offset:2048 sc1
    v_mfma_f32_16x16x32_bf16 v[156:159], v[64:67], v[96:99], v[156:159]
    v_mfma_f32_16x16x32_bf16 v[160:163], v[68:71], v[96:99], v[160:163]
    v_mfma_f32_16x16x32_bf16 v[164:167], v[72:75], v[96:99], v[164:167]
    v_mfma_f32_16x16x32_bf16 v[168:171], v[76:79], v[96:99], v[168:171]
    s_waitcnt vmcnt(11)
    v_mfma_f32_16x16x32_bf16 v[152:155], v[80:83], v[100:103], v[152:155]
    buffer_load_dwordx4 v[96:99], v188, s[32:35], s62 offen offset:3072 sc1
    v_mfma_f32_16x16x32_bf16 v[156:159], a[0:3], v[100:103], v[156:159]
    v_mfma_f32_16x16x32_bf16 v[160:163], a[4:7], v[100:103], v[160:163]
    v_mfma_f32_16x16x32_bf16 v[164:167], a[8:11], v[100:103], v[164:167]
    v_mfma_f32_16x16x32_bf16 v[168:171], a[12:15], v[100:103], v[168:171]
    s_waitcnt vmcnt(11)
    s_add_u32 s62, s51, s14
    v_mfma_f32_16x16x32_bf16 v[152:155], a[16:19], v[104:107], v[152:155]
    buffer_load_dwordx2 v[100:101], v172, s[32:35], s62 offen sc1
    v_mfma_f32_16x16x32_bf16 v[156:159], a[20:23], v[104:107], v[156:159]
    buffer_load_dwordx2 v[102:103], v172, s[32:35], s62 offen offset:128 sc1
    v_mfma_f32_16x16x32_bf16 v[160:163], a[24:27], v[104:107], v[160:163]
    v_cmp_le_u32 vcc, 1, v174
    v_mfma_f32_16x16x32_bf16 v[164:167], a[28:31], v[104:107], v[164:167]
    s_andn2_b32 s84, 0xc, vcc_lo
    s_cbranch_scc1 L_retry95
L_ok95:
    v_mfma_f32_16x16x32_bf16 v[168:171], a[32:35], v[104:107], v[168:171]
    s_waitcnt vmcnt(12)
    s_mul_i32 s51, s5, 69632
    v_mfma_f32_16x16x32_bf16 v[152:155], a[36:39], v[108:111], v[152:155]
    v_cmp_le_u32 s[22:23], 1, v174
    v_mfma_f32_16x16x32_bf16 v[156:159], a[40:43], v[108:111], v[156:159]
    s_andn2_b32 s84, 0xff, s22
    s_cbranch_scc1 L_ps96
L_pr96:
    v_mfma_f32_16x16x32_bf16 v[160:163], a[44:47], v[108:111], v[160:163]
    s_lshl_b32 s62, s5, 6
    v_mfma_f32_16x16x32_bf16 v[164:167], a[48:51], v[108:111], v[164:167]
    buffer_load_dword v178, v176, s[64:67], s62 offen sc1
    v_mfma_f32_16x16x32_bf16 v[168:171], a[52:55], v[108:111], v[168:171]
    s_waitcnt vmcnt(12)
    s_add_u32 s62, s51, s13
    v_mfma_f32_16x16x32_bf16 v[152:155], a[56:59], v[112:115], v[152:155]
    buffer_load_dwordx4 v[104:107], v188, s[32:35], s62 offen offset:0 sc1
    v_mfma_f32_16x16x32_bf16 v[156:159], a[60:63], v[112:115], v[156:159]
    buffer_load_dwordx4 v[108:111], v188, s[32:35], s62 offen offset:1024 sc1
    v_mfma_f32_16x16x32_bf16 v[160:163], a[64:67], v[112:115], v[160:163]
    s_waitcnt vmcnt(9)
    v_mul_f32 v192, v177, v192
    v_mul_f32 v193, v177, v193
    v_mfma_f32_16x16x32_bf16 v[164:167], a[68:71], v[112:115], v[164:167]
    v_mul_f32 v194, v177, v194
    v_mul_f32 v195, v177, v195
    v_mfma_f32_16x16x32_bf16 v[168:171], a[72:75], v[112:115], v[168:171]
    v_mul_f32 v196, v177, v196
    v_mul_f32 v197, v177, v197
    v_mfma_f32_16x16x32_bf16 v[152:155], a[76:79], v[116:119], v[152:155]
    buffer_load_dwordx4 v[112:115], v188, s[32:35], s62 offen offset:2048 sc1
    v_mfma_f32_16x16x32_bf16 v[156:159], a[80:83], v[116:119], v[156:159]
    v_mul_f32 v198, v177, v198
    v_mul_f32 v199, v177, v199
    v_mfma_f32_16x16x32_bf16 v[160:163], a[84:87], v[116:119], v[160:163]
    v_mul_f32 v200, v177, v200
    v_mul_f32 v201, v177, v201
    v_mfma_f32_16x16x32_bf16 v[164:167], a[88:91], v[116:119], v[164:167]
    v_mul_f32 v202, v177, v202
    v_mul_f32 v203, v177, v203
    v_mfma_f32_16x16x32_bf16 v[168:171], a[92:95], v[116:119], v[168:171]
    v_mul_f32 v204, v177, v204
    v_mul_f32 v205, v177, v205
    v_mfma_f32_16x16x32_bf16 v[152:155], a[96:99], v[120:123], v[152:155]
    buffer_load_dwordx4 v[116:119], v188, s[32:35], s62 offen offset:3072 sc1
    v_mfma_f32_16x16x32_bf16 v[156:159], a[100:103], v[120:123], v[156:159]
    v_mul_f32 v206, v177, v206
    v_mul_f32 v207, v177, v207
    v_mfma_f32_16x16x32_bf16 v[160:163], a[104:107], v[120:123], v[160:163]
    v_mul_f32 v208, v177, v208
    v_mul_f32 v209, v177, v209
    v_mfma_f32_16x16x32_bf16 v[164:167], a[108:111], v[120:123], v[164:167]
    v_mul_f32 v210, v177, v210
    v_mul_f32 v211, v177, v211
    v_mfma_f32_16x16x32_bf16 v[168:171], a[112:115], v[120:123], v[168:171]
    s_add_u32 s62, s51, s14
    v_mfma_f32_16x16x32_bf16 v[152:155], a[116:119], v[124:127], v[152:155]
    buffer_load_dwordx2 v[120:121], v172, s[32:35], s62 offen sc1
    v_mfma_f32_16x16x32_bf16 v[156:159], a[120:123], v[124:127], v[156:159]
    buffer_load_dwordx2 v[122:123], v172, s[32:35], s62 offen offset:128 sc1
    v_mfma_f32_16x16x32_bf16 v[160:163], a[124:127], v[124:127], v[160:163]
    v_cmp_le_u32 vcc, 1, v174
    v_mfma_f32_16x16x32_bf16 v[164:167], a[128:131], v[124:127], v[164:167]
    s_andn2_b32 s84, 0x30, vcc_lo
    s_cbranch_scc1 L_retry97
L_ok97:
    v_mfma_f32_16x16x32_bf16 v[168:171], a[132:135], v[124:127], v[168:171]
    s_mul_i32 s51, s6, 69632
    v_mfma_f32_16x16x32_bf16 v[152:155], a[136:139], v[128:131], v[152:155]
    v_cmp_le_u32 s[22:23], 1, v174
    v_mfma_f32_16x16x32_bf16 v[156:159], a[140:143], v[128:131], v[156:159]
    s_andn2_b32 s84, 0xff, s22
    s_cbranch_scc1 L_ps98
L_pr98:
    v_mfma_f32_16x16x32_bf16 v[160:163], a[144:147], v[128:131], v[160:163]
    s_lshl_b32 s62, s6, 6
    v_mfma_f32_16x16x32_bf16 v[164:167], a[148:151], v[128:131], v[164:167]
    buffer_load_dword v179, v176, s[64:67], s62 offen sc1
    v_mfma_f32_16x16x32_bf16 v[168:171], a[152:155], v[128:131], v[168:171]
    s_waitcnt vmcnt(13)
    s_add_u32 s62, s51, s13
    v_mfma_f32_16x16x32_bf16 v[192:195], a[156:159], v[84:87], v[192:195]
    buffer_load_dwordx4 v[124:127], v188, s[32:35], s62 offen offset:0 sc1
    v_mfma_f32_16x16x32_bf16 v[196:199], a[160:163], v[84:87], v[196:199]
    buffer_load_dwordx4 v[128:131], v188, s[32:35], s62 offen offset:1024 sc1
    v_mfma_f32_16x16x32_bf16 v[200:203], a[164:167], v[84:87], v[200:203]
    s_waitcnt vmcnt(9)
    v_mul_f32 v212, v178, v212
    v_mul_f32_e64 v213, v178, v213
    v_mfma_f32_16x16x32_bf16 v[204:207], a[168:171], v[84:87], v[204:207]
    v_mul_f32 v214, v178, v214
    v_mul_f32 v215, v178, v215
    v_mfma_f32_16x16x32_bf16 v[208:211], a[172:175], v[84:87], v[208:211]
    v_mul_f32 v216, v178, v216
    v_mul_f32 v217, v178, v217
    v_mfma_f32_16x16x32_bf16 v[192:195], a[176:179], v[88:91], v[192:195]
    buffer_load_dwordx4 v[84:87], v188, s[32:35], s62 offen offset:2048 sc1
    v_mfma_f32_16x16x32_bf16 v[196:199], a[180:183], v[88:91], v[196:199]
    v_mul_f32 v218, v178, v218
    v_mul_f32 v219, v178, v219
    v_mfma_f32_16x16x32_bf16 v[200:203], a[184:187], v[88:91], v[200:203]
    v_mul_f32 v220, v178, v220
    v_mul_f32 v221, v178, v221
    v_mfma_f32_16x16x32_bf16 v[204:207], a[188:191], v[88:91], v[204:207]
    v_mul_f32 v222, v178, v222
    v_mul_f32 v223, v178, v223
    v_mfma_f32_16x16x32_bf16 v[208:211], a[192:195], v[88:91], v[208:211]
    v_mul_f32 v224, v178, v224
    v_mul_f32 v225, v178, v225
    v_mfma_f32_16x16x32_bf16 v[192:195], a[196:199], v[92:95], v[192:195]
    buffer_load_dwordx4 v[88:91], v188, s[32:35], s62 offen offset:3072 sc1
    v_mfma_f32_16x16x32_bf16 v[196:199], a[200:203], v[92:95], v[196:199]
    v_mul_f32 v226, v178, v226
    v_mul_f32 v227, v178, v227
    v_mfma_f32_16x16x32_bf16 v[200:203], a[204:207], v[92:95], v[200:203]
    v_mul_f32 v228, v178, v228
    v_mul_f32 v229, v178, v229
    v_mfma_f32_16x16x32_bf16 v[204:207], a[208:211], v[92:95], v[204:207]
    v_mul_f32 v230, v178, v230
    v_mul_f32 v231, v178, v231
    v_mfma_f32_16x16x32_bf16 v[208:211], a[212:215], v[92:95], v[208:211]
    s_add_u32 s62, s51, s14
    v_mfma_f32_16x16x32_bf16 v[192:195], a[216:219], v[96:99], v[192:195]
    buffer_load_dwordx2 v[92:93], v172, s[32:35], s62 offen sc1
    v_mfma_f32_16x16x32_bf16 v[196:199], a[220:223], v[96:99], v[196:199]
    buffer_load_dwordx2 v[94:95], v172, s[32:35], s62 offen offset:128 sc1
    v_mfma_f32_16x16x32_bf16 v[200:203], a[224:227], v[96:99], v[200:203]
    v_cmp_le_u32 vcc, 1, v174
    v_mfma_f32_16x16x32_bf16 v[204:207], a[228:231], v[96:99], v[204:207]
    s_andn2_b32 s84, 0xc0, vcc_lo
    s_cbranch_scc1 L_retry99
L_ok99:
    v_mfma_f32_16x16x32_bf16 v[208:211], a[232:235], v[96:99], v[208:211]
    s_mul_i32 s51, s7, 69632
    v_mfma_f32_16x16x32_bf16 v[192:195], a[236:239], v[100:103], v[192:195]
    s_lshl_b32 s62, s7, 6
    v_mfma_f32_16x16x32_bf16 v[196:199], a[240:243], v[100:103], v[196:199]
    buffer_load_dword v177, v176, s[64:67], s62 offen sc1
    v_mfma_f32_16x16x32_bf16 v[200:203], a[244:247], v[100:103], v[200:203]
    s_add_u32 s62, s51, s13
    v_mfma_f32_16x16x32_bf16 v[204:207], a[248:251], v[100:103], v[204:207]
    buffer_load_dwordx4 v[96:99], v188, s[32:35], s62 offen offset:0 sc1
    v_mfma_f32_16x16x32_bf16 v[208:211], a[252:255], v[100:103], v[208:211]
    s_waitcnt vmcnt(14)
    v_mfma_f32_16x16x32_bf16 v[212:215], a[156:159], v[104:107], v[212:215]
    buffer_load_dwordx4 v[100:103], v188, s[32:35], s62 offen offset:1024 sc1
    v_mfma_f32_16x16x32_bf16 v[216:219], a[160:163], v[104:107], v[216:219]
    ds_write_b128 v180, v[192:195] offset:0
    v_mfma_f32_16x16x32_bf16 v[220:223], a[164:167], v[104:107], v[220:223]
    s_waitcnt vmcnt(9)
    v_mul_f32 v132, v179, v132
    v_mul_f32_e64 v133, v179, v133
    v_mfma_f32_16x16x32_bf16 v[224:227], a[168:171], v[104:107], v[224:227]
    v_mul_f32 v134, v179, v134
    v_mul_f32 v135, v179, v135
    v_mfma_f32_16x16x32_bf16 v[228:231], a[172:175], v[104:107], v[228:231]
    v_mul_f32 v136, v179, v136
    v_mul_f32 v137, v179, v137
    v_mfma_f32_16x16x32_bf16 v[212:215], a[176:179], v[108:111], v[212:215]
    buffer_load_dwordx4 v[104:107], v188, s[32:35], s62 offen offset:2048 sc1
    v_mfma_f32_16x16x32_bf16 v[216:219], a[180:183], v[108:111], v[216:219]
    ds_write_b128 v180, v[196:199] offset:32
    v_mfma_f32_16x16x32_bf16 v[220:223], a[184:187], v[108:111], v[220:223]
    v_mul_f32 v138, v179, v138
    v_mul_f32 v139, v179, v139
    v_mfma_f32_16x16x32_bf16 v[224:227], a[188:191], v[108:111], v[224:227]
    v_mul_f32 v140, v179, v140
    v_mul_f32 v141, v179, v141
    v_mfma_f32_16x16x32_bf16 v[228:231], a[192:195], v[108:111], v[228:231]
    v_mul_f32 v142, v179, v142
    v_mul_f32 v143, v179, v143
    v_mfma_f32_16x16x32_bf16 v[212:215], a[196:199], v[112:115], v[212:215]
    buffer_load_dwordx4 v[108:111], v188, s[32:35], s62 offen offset:3072 sc1
    v_mfma_f32_16x16x32_bf16 v[216:219], a[200:203], v[112:115], v[216:219]
    ds_write_b128 v180, v[200:203] offset:64
    v_mfma_f32_16x16x32_bf16 v[220:223], a[204:207], v[112:115], v[220:223]
    v_mul_f32 v144, v179, v144
    v_mul_f32 v145, v179, v145
    v_mfma_f32_16x16x32_bf16 v[224:227], a[208:211], v[112:115], v[224:227]
    v_mul_f32 v146, v179, v146
    v_mul_f32 v147, v179, v147
    v_mfma_f32_16x16x32_bf16 v[228:231], a[212:215], v[112:115], v[228:231]
    s_add_u32 s62, s51, s14
    v_mul_f32 v148, v179, v148
    v_mfma_f32_16x16x32_bf16 v[212:215], a[216:219], v[116:119], v[212:215]
    buffer_load_dwordx2 v[112:113], v172, s[32:35], s62 offen sc1
    v_mfma_f32_16x16x32_bf16 v[216:219], a[220:223], v[116:119], v[216:219]
    buffer_load_dwordx2 v[114:115], v172, s[32:35], s62 offen offset:128 sc1
    v_mfma_f32_16x16x32_bf16 v[220:223], a[224:227], v[116:119], v[220:223]
    ds_write_b128 v180, v[204:207] offset:96
    v_mfma_f32_16x16x32_bf16 v[224:227], a[228:231], v[116:119], v[224:227]
    v_mul_f32 v149, v179, v149
    v_mul_f32 v150, v179, v150
    v_mfma_f32_16x16x32_bf16 v[228:231], a[232:235], v[116:119], v[228:231]
    v_mul_f32_e64 v151, v179, v151
    v_mfma_f32_16x16x32_bf16 v[212:215], a[236:239], v[120:123], v[212:215]
    ds_write_b128 v180, v[208:211] offset:128
    v_mfma_f32_16x16x32_bf16 v[216:219], a[240:243], v[120:123], v[216:219]
    v_mfma_f32_16x16x32_bf16 v[220:223], a[244:247], v[120:123], v[220:223]
    v_mfma_f32_16x16x32_bf16 v[224:227], a[248:251], v[120:123], v[224:227]
    s_waitcnt lgkmcnt(0)
    s_barrier
    v_mfma_f32_16x16x32_bf16 v[228:231], a[252:255], v[120:123], v[228:231]
    s_waitcnt vmcnt(12)
    ds_read_b128 v[192:195], v182 offset:0
    v_mfma_f32_16x16x32_bf16 v[132:135], a[156:159], v[124:127], v[132:135]
    ds_read_b128 v[196:199], v182 offset:5376
    v_mfma_f32_16x16x32_bf16 v[136:139], a[160:163], v[124:127], v[136:139]
    ds_write_b128 v180, v[212:215] offset:21760
    v_mfma_f32_16x16x32_bf16 v[140:143], a[164:167], v[124:127], v[140:143]
    s_waitcnt vmcnt(6)
    v_mul_f32 v152, v177, v152
    v_mul_f32 v153, v177, v153
    v_mfma_f32_16x16x32_bf16 v[144:147], a[168:171], v[124:127], v[144:147]
    v_mul_f32 v154, v177, v154
    v_mul_f32 v155, v177, v155
    v_mfma_f32_16x16x32_bf16 v[148:151], a[172:175], v[124:127], v[148:151]
    v_mul_f32 v156, v177, v156
    v_mul_f32 v157, v177, v157
    v_mfma_f32_16x16x32_bf16 v[132:135], a[176:179], v[128:131], v[132:135]
    ds_write_b128 v180, v[216:219] offset:21792
    v_mfma_f32_16x16x32_bf16 v[136:139], a[180:183], v[128:131], v[136:139]
    v_mul_f32 v158, v177, v158
    v_mul_f32 v159, v177, v159
    v_mfma_f32_16x16x32_bf16 v[140:143], a[184:187], v[128:131], v[140:143]
    v_mul_f32 v160, v177, v160
    v_mul_f32 v161, v177, v161
    v_mfma_f32_16x16x32_bf16 v[144:147], a[188:191], v[128:131], v[144:147]
    ds_write_b128 v180, v[220:223] offset:21824
    v_mfma_f32_16x16x32_bf16 v[148:151], a[192:195], v[128:131], v[148:151]
    v_mul_f32 v162, v177, v162
    v_mul_f32 v163, v177, v163
    v_mfma_f32_16x16x32_bf16 v[132:135], a[196:199], v[84:87], v[132:135]
    v_mul_f32 v164, v177, v164
    v_mul_f32 v165, v177, v165
    v_mfma_f32_16x16x32_bf16 v[136:139], a[200:203], v[84:87], v[136:139]
    ds_write_b128 v180, v[224:227] offset:21856
    v_mfma_f32_16x16x32_bf16 v[140:143], a[204:207], v[84:87], v[140:143]
    v_mul_f32 v166, v177, v166
    v_mul_f32 v167, v177, v167
    v_mfma_f32_16x16x32_bf16 v[144:147], a[208:211], v[84:87], v[144:147]
    v_mul_f32 v168, v177, v168
    v_mul_f32 v169, v177, v169
    v_mfma_f32_16x16x32_bf16 v[148:151], a[212:215], v[84:87], v[148:151]
    v_mul_f32 v170, v177, v170
    v_mul_f32 v171, v177, v171
    v_mfma_f32_16x16x32_bf16 v[132:135], a[216:219], v[88:91], v[132:135]
    ds_write_b128 v180, v[228:231] offset:21888
    v_mfma_f32_16x16x32_bf16 v[136:139], a[220:223], v[88:91], v[136:139]
    ds_read_b128 v[200:203], v182 offset:10752
    v_mfma_f32_16x16x32_bf16 v[140:143], a[224:227], v[88:91], v[140:143]
    ds_read_b128 v[204:207], v182 offset:16128
    v_mfma_f32_16x16x32_bf16 v[144:147], a[228:231], v[88:91], v[144:147]
    s_waitcnt lgkmcnt(2)
    s_barrier
    v_mfma_f32_16x16x32_bf16 v[148:151], a[232:235], v[88:91], v[148:151]
    ds_read_b128 v[0:3], v182 offset:2624
    v_mfma_f32_16x16x32_bf16 v[132:135], a[236:239], v[92:95], v[132:135]
    ds_read_b128 v[4:7], v182 offset:8000
    v_mfma_f32_16x16x32_bf16 v[136:139], a[240:243], v[92:95], v[136:139]
    ds_read_b128 v[8:11], v182 offset:13376
    v_mfma_f32_16x16x32_bf16 v[140:143], a[244:247], v[92:95], v[140:143]
    ds_read_b128 v[12:15], v182 offset:18752
    v_mfma_f32_16x16x32_bf16 v[144:147], a[248:251], v[92:95], v[144:147]
    v_mfma_f32_16x16x32_bf16 v[148:151], a[252:255], v[92:95], v[148:151]
    s_waitcnt vmcnt(5)
    s_waitcnt lgkmcnt(4)
    v_add_f32 v192, v192, v196
    v_add_f32 v193, v193, v197
    v_mfma_f32_16x16x32_bf16 v[152:155], a[156:159], v[96:99], v[152:155]
    v_add_f32 v194, v194, v198
    v_add_f32 v195, v195, v199
    v_mfma_f32_16x16x32_bf16 v[156:159], a[160:163], v[96:99], v[156:159]
    ds_write_b128 v181, v[132:135] offset:0
    v_mfma_f32_16x16x32_bf16 v[160:163], a[164:167], v[96:99], v[160:163]
    v_add_f32 v200, v200, v204
    v_add_f32 v201, v201, v205
    v_mfma_f32_16x16x32_bf16 v[164:167], a[168:171], v[96:99], v[164:167]
    v_add_f32 v202, v202, v206
    v_add_f32 v203, v203, v207
    v_mfma_f32_16x16x32_bf16 v[168:171], a[172:175], v[96:99], v[168:171]
    s_waitcnt vmcnt(4)
    v_add_f32 v192, v192, v200
    v_add_f32_e64 v193, v193, v201
    v_mfma_f32_16x16x32_bf16 v[152:155], a[176:179], v[100:103], v[152:155]
    ds_write_b128 v181, v[136:139] offset:32
    v_mfma_f32_16x16x32_bf16 v[156:159], a[180:183], v[100:103], v[156:159]
    v_add_f32 v194, v194, v202
    v_add_f32 v195, v195, v203
    v_mfma_f32_16x16x32_bf16 v[160:163], a[184:187], v[100:103], v[160:163]
    v_cvt_pk_bf16_f32 v208, v192, v193
    v_cvt_pk_bf16_f32 v209, v194, v195
    v_mfma_f32_16x16x32_bf16 v[164:167], a[188:191], v[100:103], v[164:167]
    ds_write_b128 v181, v[140:143] offset:64
    v_mfma_f32_16x16x32_bf16 v[168:171], a[192:195], v[100:103], v[168:171]
    s_waitcnt vmcnt(3)
    s_waitcnt lgkmcnt(3)
    v_add_f32 v0, v0, v4
    v_add_f32 v1, v1, v5
    v_mfma_f32_16x16x32_bf16 v[152:155], a[196:199], v[104:107], v[152:155]
    v_add_f32 v2, v2, v6
    v_add_f32 v3, v3, v7
    v_mfma_f32_16x16x32_bf16 v[156:159], a[200:203], v[104:107], v[156:159]
    ds_write_b128 v181, v[144:147] offset:96
    v_mfma_f32_16x16x32_bf16 v[160:163], a[204:207], v[104:107], v[160:163]
    v_add_f32 v8, v8, v12
    v_add_f32 v9, v9, v13
    v_mfma_f32_16x16x32_bf16 v[164:167], a[208:211], v[104:107], v[164:167]
    v_add_f32 v10, v10, v14
    v_add_f32 v11, v11, v15
    v_mfma_f32_16x16x32_bf16 v[168:171], a[212:215], v[104:107], v[168:171]
    s_waitcnt vmcnt(2)
    v_add_f32 v0, v0, v8
    v_add_f32_e64 v1, v1, v9
    v_mfma_f32_16x16x32_bf16 v[152:155], a[216:219], v[108:111], v[152:155]
    ds_write_b128 v181, v[148:151] offset:128
    v_mfma_f32_16x16x32_bf16 v[156:159], a[220:223], v[108:111], v[156:159]
    v_add_f32 v2, v2, v10
    v_add_f32 v3, v3, v11
    v_mfma_f32_16x16x32_bf16 v[160:163], a[224:227], v[108:111], v[160:163]
    v_cvt_pk_bf16_f32 v210, v0, v1
    v_cvt_pk_bf16_f32 v211, v2, v3
    v_mfma_f32_16x16x32_bf16 v[164:167], a[228:231], v[108:111], v[164:167]
    s_waitcnt lgkmcnt(0)
    s_barrier
    v_mfma_f32_16x16x32_bf16 v[168:171], a[232:235], v[108:111], v[168:171]
    s_waitcnt vmcnt(0)
    v_mfma_f32_16x16x32_bf16 v[152:155], a[236:239], v[112:115], v[152:155]
    s_mul_i32 s60, s4, 20480
    s_add_u32 s60, s60, s15
    buffer_store_dwordx4 v[208:211], v175, s[76:79], s60 offen sc1
    v_mfma_f32_16x16x32_bf16 v[156:159], a[240:243], v[112:115], v[156:159]
    ds_read_b128 v[212:215], v182 offset:21760
    v_mfma_f32_16x16x32_bf16 v[160:163], a[244:247], v[112:115], v[160:163]
    ds_read_b128 v[216:219], v182 offset:27136
    v_mfma_f32_16x16x32_bf16 v[164:167], a[248:251], v[112:115], v[164:167]
    ds_read_b128 v[220:223], v182 offset:32512
    v_mfma_f32_16x16x32_bf16 v[168:171], a[252:255], v[112:115], v[168:171]
    ds_read_b128 v[224:227], v182 offset:37888
    ds_read_b128 v[16:19], v182 offset:24384
    ds_read_b128 v[20:23], v182 offset:29760
    ds_read_b128 v[24:27], v182 offset:35136
    ds_read_b128 v[28:31], v182 offset:40512
    s_waitcnt lgkmcnt(4)
    v_add_f32 v212, v212, v216
    v_add_f32 v213, v213, v217
    v_add_f32 v214, v214, v218
    v_add_f32 v215, v215, v219
    v_add_f32 v220, v220, v224
    v_add_f32 v221, v221, v225
    v_add_f32 v222, v222, v226
    v_add_f32_e64 v223, v223, v227
    ds_write_b128 v181, v[152:155] offset:21760
    v_add_f32 v212, v212, v220
    v_add_f32 v213, v213, v221
    v_add_f32 v214, v214, v222
    v_add_f32 v215, v215, v223
    v_cvt_pk_bf16_f32 v228, v212, v213
    ds_write_b128 v181, v[156:159] offset:21792
    v_cvt_pk_bf16_f32 v229, v214, v215
    s_waitcnt lgkmcnt(2)
    v_add_f32 v16, v16, v20
    v_add_f32 v17, v17, v21
    v_add_f32 v18, v18, v22
    v_add_f32_e64 v19, v19, v23
    ds_write_b128 v181, v[160:163] offset:21824
    v_add_f32 v24, v24, v28
    v_add_f32 v25, v25, v29
    v_add_f32 v26, v26, v30
    v_add_f32 v27, v27, v31
    v_add_f32_e64 v16, v16, v24
    ds_write_b128 v181, v[164:167] offset:21856
    v_add_f32 v17, v17, v25
    v_add_f32 v18, v18, v26
    v_add_f32_e64 v19, v19, v27
    v_cvt_pk_bf16_f32 v230, v16, v17
    ds_write_b128 v181, v[168:171] offset:21888
    s_waitcnt lgkmcnt(0)
    s_barrier
    ds_read_b128 v[152:155], v183 offset:21760
    ds_read_b128 v[156:159], v183 offset:27136
    ds_read_b128 v[160:163], v183 offset:32512
    ds_read_b128 v[164:167], v183 offset:37888
    ds_read_b128 v[48:51], v183 offset:24384
    ds_read_b128 v[52:55], v183 offset:29760
    ds_read_b128 v[56:59], v183 offset:35136
    ds_read_b128 v[60:63], v183 offset:40512
    v_cvt_pk_bf16_f32 v231, v18, v19
    s_mul_i32 s60, s5, 20480
    s_add_u32 s60, s60, s15
    buffer_store_dwordx4 v[228:231], v175, s[76:79], s60 offen sc1
    ds_read_b128 v[132:135], v183 offset:0
    ds_read_b128 v[136:139], v183 offset:5376
    ds_read_b128 v[140:143], v183 offset:10752
    ds_read_b128 v[144:147], v183 offset:16128
    ds_read_b128 v[32:35], v183 offset:2624
    ds_read_b128 v[36:39], v183 offset:8000
    ds_read_b128 v[40:43], v183 offset:13376
    ds_read_b128 v[44:47], v183 offset:18752
    s_waitcnt lgkmcnt(4)
    v_add_f32 v132, v132, v136
    v_add_f32 v133, v133, v137
    v_add_f32 v134, v134, v138
    v_add_f32 v135, v135, v139
    v_add_f32 v140, v140, v144
    v_add_f32 v141, v141, v145
    v_add_f32 v142, v142, v146
    v_add_f32 v143, v143, v147
    v_add_f32 v132, v132, v140
    v_add_f32 v133, v133, v141
    v_add_f32 v134, v134, v142
    v_add_f32 v135, v135, v143
    v_cvt_pk_bf16_f32 v148, v132, v133
    v_cvt_pk_bf16_f32 v149, v134, v135
    s_waitcnt lgkmcnt(0)
    v_add_f32 v32, v32, v36
    v_add_f32 v33, v33, v37
    v_add_f32 v34, v34, v38
    v_add_f32 v35, v35, v39
    v_add_f32 v40, v40, v44
    v_add_f32 v41, v41, v45
    v_add_f32 v42, v42, v46
    v_add_f32 v43, v43, v47
    v_add_f32 v32, v32, v40
    v_add_f32 v33, v33, v41
    v_add_f32 v34, v34, v42
    v_add_f32_e64 v35, v35, v43
    v_cvt_pk_bf16_f32 v150, v32, v33
    v_cvt_pk_bf16_f32 v151, v34, v35
    s_mul_i32 s60, s6, 20480
    s_add_u32 s60, s60, s15
    buffer_store_dwordx4 v[148:151], v175, s[76:79], s60 offen sc1
    v_pk_add_f32 v[152:153], v[152:153], v[156:157]
    v_pk_add_f32 v[154:155], v[154:155], v[158:159]
    v_pk_add_f32 v[160:161], v[160:161], v[164:165]
    v_pk_add_f32 v[162:163], v[162:163], v[166:167]
    v_pk_add_f32 v[152:153], v[152:153], v[160:161]
    v_pk_add_f32 v[154:155], v[154:155], v[162:163]
    v_cvt_pk_bf16_f32 v168, v152, v153
    v_cvt_pk_bf16_f32 v169, v154, v155
    v_pk_add_f32 v[48:49], v[48:49], v[52:53]
    v_pk_add_f32 v[50:51], v[50:51], v[54:55]
    v_pk_add_f32 v[56:57], v[56:57], v[60:61]
    v_pk_add_f32 v[58:59], v[58:59], v[62:63]
    v_pk_add_f32 v[48:49], v[48:49], v[56:57]
    v_pk_add_f32 v[50:51], v[50:51], v[58:59]
    v_cvt_pk_bf16_f32 v170, v48, v49
    v_cvt_pk_bf16_f32 v171, v50, v51
    s_mul_i32 s60, s7, 20480
    s_add_u32 s60, s60, s15
    buffer_store_dwordx4 v[168:171], v175, s[76:79], s60 offen sc1
    s_endpgm
L_ps92:
    buffer_load_dword v174, v173, s[68:71], 0 offen sc1
    s_branch L_pr92
L_ps94:
    buffer_load_dword v174, v173, s[68:71], 0 offen sc1
    s_branch L_pr94
L_ps96:
    buffer_load_dword v174, v173, s[68:71], 0 offen sc1
    s_branch L_pr96
L_ps98:
    buffer_load_dword v174, v173, s[68:71], 0 offen sc1
    s_branch L_pr98
L_retry87:
    s_mov_b32 s85, 0x8000
L_spin87:
    s_waitcnt vmcnt(0)
    v_cmp_le_u32_e64 vcc, 20, v191
    s_sub_u32 s85, s85, 1
    s_cbranch_scc1 L_ok87
    s_andn2_b32 s84, 0x6, vcc_lo
    s_cbranch_scc0 L_ok87
    s_cmp_eq_u32 s85, 0x7fff
    s_cbranch_scc1 L_nosl87
    s_sleep 8
L_nosl87:
    buffer_load_dword v191, v190, s[72:75], 0 offen sc1
    s_branch L_spin87
L_retry88:
    s_mov_b32 s85, 0x8000
L_spin88:
    s_waitcnt vmcnt(0)
    v_cmp_le_u32_e64 vcc, 1, v191
    s_sub_u32 s85, s85, 1
    s_cbranch_scc1 L_ok88
    s_andn2_b32 s84, 0x7, vcc_lo
    s_cbranch_scc0 L_ok88
    s_cmp_eq_u32 s85, 0x7fff
    s_cbranch_scc1 L_nosl88
    s_sleep 64
L_nosl88:
    buffer_load_dword v191, v190, s[68:71], s45 offen sc1
    s_branch L_spin88
L_retry89:
    s_mov_b32 s85, 0x8000
L_spin89:
    s_waitcnt vmcnt(0)
    v_cmp_le_u32_e64 vcc, 1, v191
    s_sub_u32 s85, s85, 1
    s_cbranch_scc1 L_ok89
    s_andn2_b32 s84, 0x7, vcc_lo
    s_cbranch_scc0 L_ok89
    s_cmp_eq_u32 s85, 0x7fff
    s_cbranch_scc1 L_nosl89
    s_sleep 8
L_nosl89:
    buffer_load_dword v191, v190, s[68:71], s46 offen sc1
    s_branch L_spin89
L_retry90:
    s_mov_b32 s85, 0x8000
L_spin90:
    s_waitcnt vmcnt(0)
    v_cmp_le_u32_e64 vcc, 1, v191
    s_sub_u32 s85, s85, 1
    s_cbranch_scc1 L_ok90
    s_andn2_b32 s84, 0x7, vcc_lo
    s_cbranch_scc0 L_ok90
    s_cmp_eq_u32 s85, 0x7fff
    s_cbranch_scc1 L_nosl90
    s_sleep 8
L_nosl90:
    buffer_load_dword v191, v190, s[68:71], s47 offen sc1
    s_branch L_spin90
L_retry91:
    s_mov_b32 s85, 0x8000
L_spin91:
    s_waitcnt vmcnt(0)
    v_cmp_le_u32_e64 vcc, 1, v191
    s_sub_u32 s85, s85, 1
    s_cbranch_scc1 L_ok91
    s_andn2_b32 s84, 0x7, vcc_lo
    s_cbranch_scc0 L_ok91
    s_cmp_eq_u32 s85, 0x7fff
    s_cbranch_scc1 L_nosl91
    s_sleep 8
L_nosl91:
    buffer_load_dword v191, v190, s[68:71], s48 offen sc1
    s_branch L_spin91
L_retry93:
    s_mov_b32 s85, 0x8000
L_spin93:
    s_waitcnt vmcnt(0)
    v_cmp_le_u32_e64 vcc, 1, v174
    s_sub_u32 s85, s85, 1
    s_cbranch_scc1 L_ok93
    s_andn2_b32 s84, 0x3, vcc_lo
    s_cbranch_scc0 L_ok93
    s_cmp_eq_u32 s85, 0x7fff
    s_cbranch_scc1 L_nosl93
    s_sleep 8
L_nosl93:
    buffer_load_dword v174, v173, s[68:71], 0 offen sc1
    s_branch L_spin93
L_retry95:
    s_mov_b32 s85, 0x8000
L_spin95:
    s_waitcnt vmcnt(0)
    v_cmp_le_u32_e64 vcc, 1, v174
    s_sub_u32 s85, s85, 1
    s_cbranch_scc1 L_ok95
    s_andn2_b32 s84, 0xc, vcc_lo
    s_cbranch_scc0 L_ok95
    s_cmp_eq_u32 s85, 0x7fff
    s_cbranch_scc1 L_nosl95
    s_sleep 8
L_nosl95:
    buffer_load_dword v174, v173, s[68:71], 0 offen sc1
    s_branch L_spin95
L_retry97:
    s_mov_b32 s85, 0x8000
L_spin97:
    s_waitcnt vmcnt(0)
    v_cmp_le_u32_e64 vcc, 1, v174
    s_sub_u32 s85, s85, 1
    s_cbranch_scc1 L_ok97
    s_andn2_b32 s84, 0x30, vcc_lo
    s_cbranch_scc0 L_ok97
    s_cmp_eq_u32 s85, 0x7fff
    s_cbranch_scc1 L_nosl97
    s_sleep 8
L_nosl97:
    buffer_load_dword v174, v173, s[68:71], 0 offen sc1
    s_branch L_spin97
L_retry99:
    s_mov_b32 s85, 0x8000
L_spin99:
    s_waitcnt vmcnt(0)
    v_cmp_le_u32_e64 vcc, 1, v174
    s_sub_u32 s85, s85, 1
    s_cbranch_scc1 L_ok99
    s_andn2_b32 s84, 0xc0, vcc_lo
    s_cbranch_scc0 L_ok99
    s_cmp_eq_u32 s85, 0x7fff
    s_cbranch_scc1 L_nosl99
    s_sleep 8
L_nosl99:
    buffer_load_dword v174, v173, s[68:71], 0 offen sc1
    s_branch L_spin99
.p2align 6
L_Qmain:
    s_mov_b32 s36, s18
    s_mov_b32 s37, s19
    s_mov_b32 s38, 1280
    s_mov_b32 s39, 0x20000
    v_lshlrev_b32_e64 v250, 1, v0
    buffer_load_ushort v176, v250, s[36:39], 0 offen offset:0
    buffer_load_ushort v178, v250, s[36:39], 0 offen offset:512
    buffer_load_ushort v180, v250, s[36:39], 0 offen offset:1024
    v_lshlrev_b32_e64 v230, 3, v0
    v_add_u32 v230, 73856, v230
    v_mov_b32 v177, 0
    v_mov_b32 v179, 0
    v_mov_b32 v181, 0
    s_lshl_b32 s18, s81, 3
    s_add_u32 s18, s18, s80
    s_lshl_b32 s18, s18, 7
    s_add_u32 s18, s18, 67584
    v_lshrrev_b32 v254, 5, v255
    v_lshlrev_b32 v254, 30, v254
    v_lshl_add_u32 v252, v255, 2, v254
    v_mov_b32 v251, 163584
    v_mov_b32_e64 v254, 0
    v_lshl_add_u32 v253, v255, 2, v251
    ds_write_b32 v253, v254
    s_lshl_b32 s58, 1, s44
    s_add_u32 s68, s20, 0xc10000
    s_addc_u32 s69, s21, 0
    s_mov_b32 s70, 81920
    s_mov_b32 s71, 0x20000
    s_add_u32 m0, s47, 22560
    s_add_u32 s51, s45, 0x16400
    s_bitcmp1_b32 s44, 0
    s_cbranch_scc0 L_sk3
    buffer_load_dwordx4 v228, s[28:31], s51 offen lds
L_sk3:
    s_add_u32 m0, s50, 18464
    s_add_u32 s62, s45, 122880
    buffer_load_dwordx4 v224, s[28:31], s62 offen offset:0 lds
    buffer_load_dwordx4 v225, s[28:31], s62 offen offset:1024 lds
    buffer_load_dwordx4 v226, s[28:31], s62 offen offset:2048 lds
    buffer_load_dwordx4 v227, s[28:31], s62 offen offset:3072 lds
    s_lshr_b32 s17, s53, 2
    s_and_b32 s59, s53, 3
    s_lshl_b32 s59, s59, 2
    s_add_u32 s59, s59, s44
    s_lshl_b32 s60, s59, 6
    v_add_u32 v240, s60, v255
    v_mul_u32_u24 v241, 3641, v240
    v_lshrrev_b32 v241, 15, v241
    v_mul_u32_u24 v242, 9, v241
    v_sub_u32 v240, v240, v242
    v_mul_u32_u24 v242, 11, v240
    v_lshrrev_b32_e64 v242, 5, v242
    v_mul_u32_u24 v242, 896, v242
    v_lshl_add_u32 v240, v240, 7, v242
    v_mul_u32_u24 v241, 3840, v241
    s_mul_i32 s60, s3, 320
    s_andn2_b32 s60, s60, 127
    v_add3_u32 v240, v240, v241, s60
    s_mul_i32 s60, s54, 6
    s_add_u32 s60, s60, s59
    s_sub_u32 s60, s60, 9
    s_mul_i32 s60, s60, 192
    s_add_u32 s60, s60, 128
    s_cmp_eq_u32 s59, 15
    s_cselect_b32 s60, 1088, s60
    v_add_u32_e64 v241, s60, v255
    v_mul_u32_u24 v241, 1280, v241
    s_cmp_lt_u32 s59, 9
    s_cselect_b64 vcc, -1, 0
    s_cselect_b32 s12, s6, s4
    s_cselect_b32 s13, s7, s5
    s_mov_b32 s14, 2621440
    s_cselect_b32 s14, 2457600, s14
    s_movk_i32 s16, 128
    s_cselect_b32 s16, 245760, s16
    s_mov_b32 s15, 0x20000
    v_cndmask_b32 v240, v241, v240, vcc
    s_cmp_lg_u32 s17, 1
    s_cbranch_scc1 L_t4
    s_mul_i32 s84, s16, 1
    buffer_load_dword v241, v240, s[12:15], s84 offen
L_t4:
    s_cmp_lg_u32 s17, 2
    s_cbranch_scc1 L_t5
    s_mul_i32 s84, s16, 2
    buffer_load_dword v241, v240, s[12:15], s84 offen
L_t5:
    s_mov_b32 s32, s20
    s_mov_b32 s33, s21
    s_mov_b32 s34, 8912896
    s_mov_b32 s35, 0x20000
    s_add_u32 s40, s20, 0x900000
    s_addc_u32 s41, s21, 0
    s_mov_b32 s42, 2785280
    s_mov_b32 s43, 0x20000
    s_add_u32 s64, s20, 0xc00000
    s_addc_u32 s65, s21, 0
    s_mov_b32 s66, 32768
    s_mov_b32 s67, 0x20000
    s_mov_b32 s72, s22
    s_mov_b32 s73, s23
    s_mov_b32 s74, 256
    s_mov_b32 s75, 0x20000
    s_mov_b32 s76, s82
    s_mov_b32 s77, s83
    s_mov_b32 s78, 2621440
    s_mov_b32 s79, 0x20000
    v_bfe_u32 v254, v255, 1, 3
    v_lshrrev_b32 v253, 4, v255
    v_xor_b32 v254, v254, v253
    v_lshlrev_b32 v254, 4, v254
    v_and_b32 v253, 15, v255
    v_lshl_add_u32 v254, v253, 7, v254
    v_add_u32 v216, 79104, v254
    v_xor_b32_e64 v217, 64, v216
    v_add_u32 v218, 45056, v216
    v_add_u32 v219, 45056, v217
    v_bfe_u32 v254, v255, 4, 1
    v_mul_u32_u24 v254, 9248, v254
    v_lshrrev_b32_e64 v253, 5, v255
    v_mul_u32_u24 v253, 4608, v253
    v_add_u32_e64 v254, v254, v253
    v_bfe_u32 v253, v255, 2, 2
    v_mul_u32_u24 v253, 576, v253
    s_mul_i32 s52, s44, 40
    s_add_u32 s52, s52, s61
    v_add3_u32 v254, v254, v253, s52
    v_and_b32_e64 v253, 3, v255
    v_lshl_add_u32 v220, v253, 3, v254
    v_add_u32 v221, 384, v220
    v_add_u32 v222, 32, v254
    v_cmp_eq_u32 vcc, 0, v253
    v_cmp_eq_u32 s[52:53], 1, v253
    v_cmp_eq_u32 s[54:55], 2, v253
    v_cmp_eq_u32 s[56:57], 3, v253
    v_cndmask_b32 v221, v221, v222, vcc
    v_add_u32 v222, 224, v254
    v_add_u32 v251, 384, v254
    v_cndmask_b32 v222, v222, v251, s[52:53]
    v_add_u32 v251, 416, v254
    v_cndmask_b32 v222, v222, v251, s[54:55]
    v_add_u32 v223, 2304, v222
    v_lshrrev_b32 v254, 4, v255
    v_lshlrev_b32_e64 v254, 6, v254
    v_bfe_u32 v251, v255, 2, 2
    v_lshl_add_u32 v251, v251, 3, v254
    v_add_u32 v251, 73856, v251
    v_cndmask_b32 v222, v222, v251, s[56:57]
    v_add_u32_e64 v251, 32, v251
    v_cndmask_b32 v223, v223, v251, s[56:57]
    v_lshlrev_b32_e64 v239, 4, v255
    v_mov_b32 v251, 256
    v_mov_b32 v182, 18464
    v_mov_b32 v183, -55392
    v_cndmask_b32 v182, v182, v251, s[56:57]
    v_cndmask_b32 v183, v183, v251, s[56:57]
    s_waitcnt vmcnt(4)
    ds_write_b64 v230, v[176:177]
    ds_write_b64 v230, v[178:179] offset:2048
    s_cmp_lt_u32 s44, 2
    s_cbranch_scc0 L_sk6
    ds_write_b64 v230, v[180:181] offset:4096
L_sk6:
    s_add_u32 m0, s47, 41024
    s_add_u32 s51, s45, 0x34400
    s_bitcmp1_b32 s44, 0
    s_cbranch_scc0 L_sk7
    buffer_load_dwordx4 v228, s[28:31], s51 offen lds
L_sk7:
    s_add_u32 m0, s50, 36928
    s_add_u32 s62, s45, 245760
    buffer_load_dwordx4 v224, s[28:31], s62 offen offset:0 lds
    buffer_load_dwordx4 v225, s[28:31], s62 offen offset:1024 lds
    buffer_load_dwordx4 v226, s[28:31], s62 offen offset:2048 lds
    buffer_load_dwordx4 v227, s[28:31], s62 offen offset:3072 lds
    s_add_u32 m0, s48, 43008
    s_add_u32 s51, s46, 204928
    s_cmp_lt_u32 s44, 2
    s_cbranch_scc0 L_sk8
    buffer_load_dwordx4 v229, s[24:27], s51 offen lds
L_sk8:
    s_add_u32 m0, s48, 22528
    s_add_u32 s51, s49, 128
    buffer_load_dwordx4 v229, s[24:27], s51 offen lds
    s_add_u32 m0, s48, 26624
    s_add_u32 s51, s46, 41088
    buffer_load_dwordx4 v229, s[24:27], s51 offen lds
    s_add_u32 m0, s48, 30720
    s_add_u32 s51, s46, 82048
    buffer_load_dwordx4 v229, s[24:27], s51 offen lds
    s_add_u32 m0, s48, 34816
    s_add_u32 s51, s46, 123008
    buffer_load_dwordx4 v229, s[24:27], s51 offen lds
    s_add_u32 m0, s48, 38912
    s_add_u32 s51, s46, 163968
    buffer_load_dwordx4 v229, s[24:27], s51 offen lds
    s_add_u32 m0, s47, 59488
    s_add_u32 s51, s45, 0x52400
    s_bitcmp1_b32 s44, 0
    s_cbranch_scc0 L_sk9
    buffer_load_dwordx4 v228, s[28:31], s51 offen lds
L_sk9:
    s_waitcnt lgkmcnt(0)
    s_barrier
    ds_read_b64_tr_b16 a[88:89], v221 offset:0
    ds_read_b64_tr_b16 a[90:91], v221 offset:2304
    ds_read_b128 a[0:3], v216 offset:0
    ds_read_b64_tr_b16 a[92:93], v222 offset:0
    ds_read_b64_tr_b16 a[94:95], v223 offset:0
    ds_read_b64_tr_b16 a[96:97], v220 offset:192
    ds_read_b64_tr_b16 a[98:99], v220 offset:2496
    ds_read_b64_tr_b16 a[100:101], v220 offset:0
    ds_read_b64_tr_b16 a[102:103], v220 offset:2304
    ds_read_b128 a[4:7], v216 offset:2048
    ds_read_b128 a[8:11], v216 offset:4096
    ds_read_b128 a[12:15], v216 offset:6144
    ds_read_b128 a[16:19], v216 offset:8192
    ds_read_b128 a[20:23], v216 offset:10240
    ds_read_b128 a[24:27], v216 offset:12288
    ds_read_b128 a[28:31], v216 offset:14336
    ds_read_b128 a[32:35], v216 offset:16384
    ds_read_b128 a[36:39], v216 offset:18432
    ds_read_b128 a[40:43], v216 offset:20480
    s_waitcnt lgkmcnt(6)
    v_mfma_f32_16x16x32_bf16 v[0:3], a[88:91], a[0:3], 0
    s_cmp_lg_u32 s17, 0
    s_cbranch_scc1 L_t10
    s_mul_i32 s84, s16, 3
    buffer_load_dword v241, v240, s[12:15], s84 offen
L_t10:
    v_mfma_f32_16x16x32_bf16 v[4:7], a[92:95], a[0:3], 0
    v_mfma_f32_16x16x32_bf16 v[8:11], a[96:99], a[0:3], 0
    v_add_u32 v222, v182, v222
    s_add_u32 s62, s45, 368640
    v_mfma_f32_16x16x32_bf16 v[16:19], a[88:91], a[4:7], 0
    v_add_u32_e64 v223, v182, v223
    s_add_u32 m0, s50, 55392
    v_mfma_f32_16x16x32_bf16 v[20:23], a[92:95], a[4:7], 0
    buffer_load_dwordx4 v224, s[28:31], s62 offen offset:0 lds
    v_mfma_f32_16x16x32_bf16 v[24:27], a[96:99], a[4:7], 0
    v_mfma_f32_16x16x32_bf16 v[28:31], a[100:103], a[4:7], 0
    s_waitcnt vmcnt(10) lgkmcnt(0)
    s_barrier
    v_mfma_f32_16x16x32_bf16 v[32:35], a[88:91], a[8:11], 0
    ds_read_b64_tr_b16 a[104:105], v221 offset:18464
    v_mfma_f32_16x16x32_bf16 v[36:39], a[92:95], a[8:11], 0
    ds_read_b64_tr_b16 a[106:107], v221 offset:20768
    v_mfma_f32_16x16x32_bf16 v[40:43], a[96:99], a[8:11], 0
    buffer_load_dwordx4 v225, s[28:31], s62 offen offset:1024 lds
    v_mfma_f32_16x16x32_bf16 v[44:47], a[100:103], a[8:11], 0
    ds_read_b128 a[44:47], v217 offset:0
    v_mfma_f32_16x16x32_bf16 v[48:51], a[88:91], a[12:15], 0
    v_mfma_f32_16x16x32_bf16 v[52:55], a[92:95], a[12:15], 0
    ds_read_b64_tr_b16 a[108:109], v222 offset:0
    v_mfma_f32_16x16x32_bf16 v[56:59], a[96:99], a[12:15], 0
    buffer_load_dwordx4 v226, s[28:31], s62 offen offset:2048 lds
    v_mfma_f32_16x16x32_bf16 v[60:63], a[100:103], a[12:15], 0
    ds_read_b64_tr_b16 a[110:111], v223 offset:0
    v_mfma_f32_16x16x32_bf16 v[64:67], a[88:91], a[16:19], 0
    ds_read_b64_tr_b16 a[112:113], v220 offset:18656
    v_mfma_f32_16x16x32_bf16 v[68:71], a[92:95], a[16:19], 0
    v_mfma_f32_16x16x32_bf16 v[72:75], a[96:99], a[16:19], 0
    ds_read_b64_tr_b16 a[114:115], v220 offset:20960
    v_mfma_f32_16x16x32_bf16 v[76:79], a[100:103], a[16:19], 0
    buffer_load_dwordx4 v227, s[28:31], s62 offen offset:3072 lds
    v_mfma_f32_16x16x32_bf16 v[80:83], a[88:91], a[20:23], 0
    ds_read_b64_tr_b16 a[116:117], v220 offset:18464
    v_mfma_f32_16x16x32_bf16 v[84:87], a[92:95], a[20:23], 0
    v_mfma_f32_16x16x32_bf16 v[88:91], a[96:99], a[20:23], 0
    ds_read_b64_tr_b16 a[118:119], v220 offset:20768
    s_add_u32 s51, s46, 205056
    v_mfma_f32_16x16x32_bf16 v[92:95], a[100:103], a[20:23], 0
    ds_read_b128 a[48:51], v217 offset:2048
    s_add_u32 m0, s48, 65536
    v_mfma_f32_16x16x32_bf16 v[96:99], a[88:91], a[24:27], 0
    s_cmp_lt_u32 s44, 2
    s_cbranch_scc0 L_sk11
    buffer_load_dwordx4 v229, s[24:27], s51 offen lds
L_sk11:
    v_mfma_f32_16x16x32_bf16 v[100:103], a[92:95], a[24:27], 0
    ds_read_b128 a[52:55], v217 offset:4096
    v_mfma_f32_16x16x32_bf16 v[104:107], a[96:99], a[24:27], 0
    s_add_u32 s51, s49, 256
    v_mfma_f32_16x16x32_bf16 v[108:111], a[100:103], a[24:27], 0
    ds_read_b128 a[56:59], v217 offset:6144
    s_add_u32 m0, s48, 45056
    v_mfma_f32_16x16x32_bf16 v[112:115], a[88:91], a[28:31], 0
    buffer_load_dwordx4 v229, s[24:27], s51 offen lds
    v_mfma_f32_16x16x32_bf16 v[116:119], a[92:95], a[28:31], 0
    ds_read_b128 a[60:63], v217 offset:8192
    v_mfma_f32_16x16x32_bf16 v[120:123], a[96:99], a[28:31], 0
    ds_read_b128 a[64:67], v217 offset:10240
    v_mfma_f32_16x16x32_bf16 v[124:127], a[100:103], a[28:31], 0
    s_add_u32 s51, s46, 41216
    v_mfma_f32_16x16x32_bf16 v[128:131], a[88:91], a[32:35], 0
    ds_read_b128 a[68:71], v217 offset:12288
    s_add_u32 m0, s48, 49152
    v_mfma_f32_16x16x32_bf16 v[132:135], a[92:95], a[32:35], 0
    buffer_load_dwordx4 v229, s[24:27], s51 offen lds
    v_mfma_f32_16x16x32_bf16 v[136:139], a[96:99], a[32:35], 0
    ds_read_b128 a[72:75], v217 offset:14336
    v_mfma_f32_16x16x32_bf16 v[140:143], a[100:103], a[32:35], 0
    v_mfma_f32_16x16x32_bf16 v[144:147], a[88:91], a[36:39], 0
    ds_read_b128 a[76:79], v217 offset:16384
    s_add_u32 s51, s45, 0x70400
    v_mfma_f32_16x16x32_bf16 v[148:151], a[92:95], a[36:39], 0
    ds_read_b128 a[80:83], v217 offset:18432
    s_add_u32 m0, s47, 4096
    v_mfma_f32_16x16x32_bf16 v[152:155], a[96:99], a[36:39], 0
    s_bitcmp1_b32 s44, 0
    s_cbranch_scc0 L_sk12
    buffer_load_dwordx4 v228, s[28:31], s51 offen lds
L_sk12:
    v_mfma_f32_16x16x32_bf16 v[156:159], a[100:103], a[36:39], 0
    ds_read_b128 a[84:87], v217 offset:20480
    v_mfma_f32_16x16x32_bf16 v[160:163], a[88:91], a[40:43], 0
    s_add_u32 s62, s45, 491520
    v_mfma_f32_16x16x32_bf16 v[164:167], a[92:95], a[40:43], 0
    s_add_u32 m0, s50, 0
    v_mfma_f32_16x16x32_bf16 v[168:171], a[96:99], a[40:43], 0
    buffer_load_dwordx4 v224, s[28:31], s62 offen offset:0 lds
    v_mfma_f32_16x16x32_bf16 v[172:175], a[100:103], a[40:43], 0
    s_waitcnt lgkmcnt(6)
    v_mfma_f32_16x16x32_bf16 v[0:3], a[104:107], a[44:47], v[0:3]
    s_cmp_lg_u32 s17, 1
    s_cbranch_scc1 L_t13
    s_mul_i32 s84, s16, 4
    buffer_load_dword v241, v240, s[12:15], s84 offen
L_t13:
    v_mfma_f32_16x16x32_bf16 v[4:7], a[108:111], a[44:47], v[4:7]
    v_mfma_f32_16x16x32_bf16 v[8:11], a[112:115], a[44:47], v[8:11]
    v_add_u32 v222, v182, v222
    v_mfma_f32_16x16x32_bf16 v[16:19], a[104:107], a[48:51], v[16:19]
    v_add_u32_e64 v223, v182, v223
    v_mfma_f32_16x16x32_bf16 v[20:23], a[108:111], a[48:51], v[20:23]
    buffer_load_dwordx4 v225, s[28:31], s62 offen offset:1024 lds
    v_mfma_f32_16x16x32_bf16 v[24:27], a[112:115], a[48:51], v[24:27]
    v_mfma_f32_16x16x32_bf16 v[28:31], a[116:119], a[48:51], v[28:31]
    s_waitcnt vmcnt(8) lgkmcnt(0)
    s_barrier
    v_mfma_f32_16x16x32_bf16 v[32:35], a[104:107], a[52:55], v[32:35]
    ds_read_b64_tr_b16 a[88:89], v221 offset:36928
    v_mfma_f32_16x16x32_bf16 v[36:39], a[108:111], a[52:55], v[36:39]
    ds_read_b64_tr_b16 a[90:91], v221 offset:39232
    v_mfma_f32_16x16x32_bf16 v[40:43], a[112:115], a[52:55], v[40:43]
    buffer_load_dwordx4 v226, s[28:31], s62 offen offset:2048 lds
    v_mfma_f32_16x16x32_bf16 v[44:47], a[116:119], a[52:55], v[44:47]
    ds_read_b128 a[0:3], v216 offset:22528
    v_mfma_f32_16x16x32_bf16 v[48:51], a[104:107], a[56:59], v[48:51]
    v_mfma_f32_16x16x32_bf16 v[52:55], a[108:111], a[56:59], v[52:55]
    ds_read_b64_tr_b16 a[92:93], v222 offset:0
    v_mfma_f32_16x16x32_bf16 v[56:59], a[112:115], a[56:59], v[56:59]
    buffer_load_dwordx4 v227, s[28:31], s62 offen offset:3072 lds
    v_mfma_f32_16x16x32_bf16 v[60:63], a[116:119], a[56:59], v[60:63]
    ds_read_b64_tr_b16 a[94:95], v223 offset:0
    v_mfma_f32_16x16x32_bf16 v[64:67], a[104:107], a[60:63], v[64:67]
    ds_read_b64_tr_b16 a[96:97], v220 offset:37120
    v_mfma_f32_16x16x32_bf16 v[68:71], a[108:111], a[60:63], v[68:71]
    s_add_u32 s51, s46, 82176
    v_mfma_f32_16x16x32_bf16 v[72:75], a[112:115], a[60:63], v[72:75]
    ds_read_b64_tr_b16 a[98:99], v220 offset:39424
    s_add_u32 m0, s48, 53248
    v_mfma_f32_16x16x32_bf16 v[76:79], a[116:119], a[60:63], v[76:79]
    buffer_load_dwordx4 v229, s[24:27], s51 offen lds
    v_mfma_f32_16x16x32_bf16 v[80:83], a[104:107], a[64:67], v[80:83]
    ds_read_b64_tr_b16 a[100:101], v220 offset:36928
    v_mfma_f32_16x16x32_bf16 v[84:87], a[108:111], a[64:67], v[84:87]
    v_mfma_f32_16x16x32_bf16 v[88:91], a[112:115], a[64:67], v[88:91]
    ds_read_b64_tr_b16 a[102:103], v220 offset:39232
    s_add_u32 s51, s46, 123136
    v_mfma_f32_16x16x32_bf16 v[92:95], a[116:119], a[64:67], v[92:95]
    ds_read_b128 a[4:7], v216 offset:24576
    s_add_u32 m0, s48, 57344
    v_mfma_f32_16x16x32_bf16 v[96:99], a[104:107], a[68:71], v[96:99]
    buffer_load_dwordx4 v229, s[24:27], s51 offen lds
    v_mfma_f32_16x16x32_bf16 v[100:103], a[108:111], a[68:71], v[100:103]
    ds_read_b128 a[8:11], v216 offset:26624
    v_mfma_f32_16x16x32_bf16 v[104:107], a[112:115], a[68:71], v[104:107]
    s_add_u32 s51, s46, 164096
    v_mfma_f32_16x16x32_bf16 v[108:111], a[116:119], a[68:71], v[108:111]
    ds_read_b128 a[12:15], v216 offset:28672
    s_add_u32 m0, s48, 61440
    v_mfma_f32_16x16x32_bf16 v[112:115], a[104:107], a[72:75], v[112:115]
    buffer_load_dwordx4 v229, s[24:27], s51 offen lds
    v_mfma_f32_16x16x32_bf16 v[116:119], a[108:111], a[72:75], v[116:119]
    ds_read_b128 a[16:19], v216 offset:30720
    v_mfma_f32_16x16x32_bf16 v[120:123], a[112:115], a[72:75], v[120:123]
    ds_read_b128 a[20:23], v216 offset:32768
    v_mfma_f32_16x16x32_bf16 v[124:127], a[116:119], a[72:75], v[124:127]
    s_add_u32 s51, s45, 0x8e400
    v_mfma_f32_16x16x32_bf16 v[128:131], a[104:107], a[76:79], v[128:131]
    ds_read_b128 a[24:27], v216 offset:34816
    s_add_u32 m0, s47, 22560
    v_mfma_f32_16x16x32_bf16 v[132:135], a[108:111], a[76:79], v[132:135]
    s_bitcmp1_b32 s44, 0
    s_cbranch_scc0 L_sk14
    buffer_load_dwordx4 v228, s[28:31], s51 offen lds
L_sk14:
    v_mfma_f32_16x16x32_bf16 v[136:139], a[112:115], a[76:79], v[136:139]
    ds_read_b128 a[28:31], v216 offset:36864
    v_mfma_f32_16x16x32_bf16 v[140:143], a[116:119], a[76:79], v[140:143]
    v_mfma_f32_16x16x32_bf16 v[144:147], a[104:107], a[80:83], v[144:147]
    ds_read_b128 a[32:35], v216 offset:38912
    s_add_u32 s62, s45, 614400
    v_mfma_f32_16x16x32_bf16 v[148:151], a[108:111], a[80:83], v[148:151]
    ds_read_b128 a[36:39], v216 offset:40960
    s_add_u32 m0, s50, 18464
    v_mfma_f32_16x16x32_bf16 v[152:155], a[112:115], a[80:83], v[152:155]
    buffer_load_dwordx4 v224, s[28:31], s62 offen offset:0 lds
    v_mfma_f32_16x16x32_bf16 v[156:159], a[116:119], a[80:83], v[156:159]
    ds_read_b128 a[40:43], v216 offset:43008
    v_mfma_f32_16x16x32_bf16 v[160:163], a[104:107], a[84:87], v[160:163]
    v_mfma_f32_16x16x32_bf16 v[164:167], a[108:111], a[84:87], v[164:167]
    v_mfma_f32_16x16x32_bf16 v[168:171], a[112:115], a[84:87], v[168:171]
    buffer_load_dwordx4 v225, s[28:31], s62 offen offset:1024 lds
    v_mfma_f32_16x16x32_bf16 v[172:175], a[116:119], a[84:87], v[172:175]
    s_waitcnt lgkmcnt(6)
    v_mfma_f32_16x16x32_bf16 v[0:3], a[88:91], a[0:3], v[0:3]
    v_mfma_f32_16x16x32_bf16 v[4:7], a[92:95], a[0:3], v[4:7]
    v_mfma_f32_16x16x32_bf16 v[8:11], a[96:99], a[0:3], v[8:11]
    v_add_u32 v222, v182, v222
    v_mfma_f32_16x16x32_bf16 v[16:19], a[88:91], a[4:7], v[16:19]
    v_add_u32_e64 v223, v182, v223
    v_mfma_f32_16x16x32_bf16 v[20:23], a[92:95], a[4:7], v[20:23]
    buffer_load_dwordx4 v226, s[28:31], s62 offen offset:2048 lds
    v_mfma_f32_16x16x32_bf16 v[24:27], a[96:99], a[4:7], v[24:27]
    v_mfma_f32_16x16x32_bf16 v[28:31], a[100:103], a[4:7], v[28:31]
    s_waitcnt vmcnt(12) lgkmcnt(0)
    s_barrier
    v_mfma_f32_16x16x32_bf16 v[32:35], a[88:91], a[8:11], v[32:35]
    ds_read_b64_tr_b16 a[104:105], v221 offset:55392
    v_mfma_f32_16x16x32_bf16 v[36:39], a[92:95], a[8:11], v[36:39]
    ds_read_b64_tr_b16 a[106:107], v221 offset:57696
    v_mfma_f32_16x16x32_bf16 v[40:43], a[96:99], a[8:11], v[40:43]
    buffer_load_dwordx4 v227, s[28:31], s62 offen offset:3072 lds
    v_mfma_f32_16x16x32_bf16 v[44:47], a[100:103], a[8:11], v[44:47]
    ds_read_b128 a[44:47], v217 offset:22528
    v_mfma_f32_16x16x32_bf16 v[48:51], a[88:91], a[12:15], v[48:51]
    s_add_u32 s51, s46, 205184
    v_mfma_f32_16x16x32_bf16 v[52:55], a[92:95], a[12:15], v[52:55]
    ds_read_b64_tr_b16 a[108:109], v222 offset:0
    s_add_u32 m0, s48, 20480
    v_mfma_f32_16x16x32_bf16 v[56:59], a[96:99], a[12:15], v[56:59]
    s_cmp_lt_u32 s44, 2
    s_cbranch_scc0 L_sk15
    buffer_load_dwordx4 v229, s[24:27], s51 offen lds
L_sk15:
    v_mfma_f32_16x16x32_bf16 v[60:63], a[100:103], a[12:15], v[60:63]
    ds_read_b64_tr_b16 a[110:111], v223 offset:0
    v_mfma_f32_16x16x32_bf16 v[64:67], a[88:91], a[16:19], v[64:67]
    ds_read_b64_tr_b16 a[112:113], v220 offset:55584
    v_mfma_f32_16x16x32_bf16 v[68:71], a[92:95], a[16:19], v[68:71]
    s_add_u32 s51, s49, 384
    v_mfma_f32_16x16x32_bf16 v[72:75], a[96:99], a[16:19], v[72:75]
    ds_read_b64_tr_b16 a[114:115], v220 offset:57888
    s_add_u32 m0, s48, 0
    v_mfma_f32_16x16x32_bf16 v[76:79], a[100:103], a[16:19], v[76:79]
    buffer_load_dwordx4 v229, s[24:27], s51 offen lds
    v_mfma_f32_16x16x32_bf16 v[80:83], a[88:91], a[20:23], v[80:83]
    ds_read_b64_tr_b16 a[116:117], v220 offset:55392
    v_mfma_f32_16x16x32_bf16 v[84:87], a[92:95], a[20:23], v[84:87]
    v_mfma_f32_16x16x32_bf16 v[88:91], a[96:99], a[20:23], v[88:91]
    ds_read_b64_tr_b16 a[118:119], v220 offset:57696
    s_add_u32 s51, s46, 41344
    v_mfma_f32_16x16x32_bf16 v[92:95], a[100:103], a[20:23], v[92:95]
    ds_read_b128 a[48:51], v217 offset:24576
    s_add_u32 m0, s48, 4096
    v_mfma_f32_16x16x32_bf16 v[96:99], a[88:91], a[24:27], v[96:99]
    buffer_load_dwordx4 v229, s[24:27], s51 offen lds
    v_mfma_f32_16x16x32_bf16 v[100:103], a[92:95], a[24:27], v[100:103]
    ds_read_b128 a[52:55], v217 offset:26624
    v_mfma_f32_16x16x32_bf16 v[104:107], a[96:99], a[24:27], v[104:107]
    s_add_u32 s51, s45, 0xac400
    v_mfma_f32_16x16x32_bf16 v[108:111], a[100:103], a[24:27], v[108:111]
    ds_read_b128 a[56:59], v217 offset:28672
    s_add_u32 m0, s47, 41024
    v_mfma_f32_16x16x32_bf16 v[112:115], a[88:91], a[28:31], v[112:115]
    s_bitcmp1_b32 s44, 0
    s_cbranch_scc0 L_sk16
    buffer_load_dwordx4 v228, s[28:31], s51 offen lds
L_sk16:
    v_mfma_f32_16x16x32_bf16 v[116:119], a[92:95], a[28:31], v[116:119]
    ds_read_b128 a[60:63], v217 offset:30720
    v_mfma_f32_16x16x32_bf16 v[120:123], a[96:99], a[28:31], v[120:123]
    ds_read_b128 a[64:67], v217 offset:32768
    v_mfma_f32_16x16x32_bf16 v[124:127], a[100:103], a[28:31], v[124:127]
    s_add_u32 s62, s45, 737280
    v_mfma_f32_16x16x32_bf16 v[128:131], a[88:91], a[32:35], v[128:131]
    ds_read_b128 a[68:71], v217 offset:34816
    s_add_u32 m0, s50, 36928
    v_mfma_f32_16x16x32_bf16 v[132:135], a[92:95], a[32:35], v[132:135]
    buffer_load_dwordx4 v224, s[28:31], s62 offen offset:0 lds
    v_mfma_f32_16x16x32_bf16 v[136:139], a[96:99], a[32:35], v[136:139]
    ds_read_b128 a[72:75], v217 offset:36864
    v_mfma_f32_16x16x32_bf16 v[140:143], a[100:103], a[32:35], v[140:143]
    v_mfma_f32_16x16x32_bf16 v[144:147], a[88:91], a[36:39], v[144:147]
    ds_read_b128 a[76:79], v217 offset:38912
    v_mfma_f32_16x16x32_bf16 v[148:151], a[92:95], a[36:39], v[148:151]
    ds_read_b128 a[80:83], v217 offset:40960
    v_mfma_f32_16x16x32_bf16 v[152:155], a[96:99], a[36:39], v[152:155]
    buffer_load_dwordx4 v225, s[28:31], s62 offen offset:1024 lds
    v_mfma_f32_16x16x32_bf16 v[156:159], a[100:103], a[36:39], v[156:159]
    ds_read_b128 a[84:87], v217 offset:43008
    v_mfma_f32_16x16x32_bf16 v[160:163], a[88:91], a[40:43], v[160:163]
    v_mfma_f32_16x16x32_bf16 v[164:167], a[92:95], a[40:43], v[164:167]
    v_mfma_f32_16x16x32_bf16 v[168:171], a[96:99], a[40:43], v[168:171]
    buffer_load_dwordx4 v226, s[28:31], s62 offen offset:2048 lds
    v_mfma_f32_16x16x32_bf16 v[172:175], a[100:103], a[40:43], v[172:175]
    s_waitcnt lgkmcnt(6)
    v_mfma_f32_16x16x32_bf16 v[0:3], a[104:107], a[44:47], v[0:3]
    s_cmp_lg_u32 s17, 2
    s_cbranch_scc1 L_t17
    s_mul_i32 s84, s16, 5
    buffer_load_dword v241, v240, s[12:15], s84 offen
L_t17:
    v_mfma_f32_16x16x32_bf16 v[4:7], a[108:111], a[44:47], v[4:7]
    s_lshr_b32 s53, s2, 3
    s_lshr_b32 s54, s2, 6
    s_and_b32 s55, s2, 1
    v_mfma_f32_16x16x32_bf16 v[8:11], a[112:115], a[44:47], v[8:11]
    v_add_u32_e64 v222, v183, v222
    s_lshl_b32 s55, s55, 2
    s_add_u32 s54, s54, s55
    v_mfma_f32_16x16x32_bf16 v[16:19], a[104:107], a[48:51], v[16:19]
    v_add_u32_e64 v223, v183, v223
    s_and_b32 s55, s53, 3
    s_mov_b32 s56, 4
    v_mfma_f32_16x16x32_bf16 v[20:23], a[108:111], a[48:51], v[20:23]
    buffer_load_dwordx4 v227, s[28:31], s62 offen offset:3072 lds
    v_mfma_f32_16x16x32_bf16 v[24:27], a[112:115], a[48:51], v[24:27]
    s_mul_i32 s59, s54, 348160
    s_mul_i32 s10, s44, 61440
    s_add_u32 s10, s10, s59
    v_mfma_f32_16x16x32_bf16 v[28:31], a[116:119], a[48:51], v[28:31]
    s_waitcnt vmcnt(10) lgkmcnt(0)
    s_barrier
    s_add_u32 s10, s10, 102400
    v_mfma_f32_16x16x32_bf16 v[32:35], a[104:107], a[52:55], v[32:35]
    ds_read_b64_tr_b16 a[88:89], v221 offset:0
    s_add_u32 s51, s46, 82304
    v_mfma_f32_16x16x32_bf16 v[36:39], a[108:111], a[52:55], v[36:39]
    ds_read_b64_tr_b16 a[90:91], v221 offset:2304
    s_add_u32 m0, s48, 8192
    v_mfma_f32_16x16x32_bf16 v[40:43], a[112:115], a[52:55], v[40:43]
    buffer_load_dwordx4 v229, s[24:27], s51 offen lds
    v_mfma_f32_16x16x32_bf16 v[44:47], a[116:119], a[52:55], v[44:47]
    ds_read_b128 a[0:3], v218 offset:0
    s_mul_i32 s11, s44, 20480
    v_mfma_f32_16x16x32_bf16 v[48:51], a[104:107], a[56:59], v[48:51]
    s_add_u32 s51, s46, 123264
    s_add_u32 s11, s11, s59
    s_mul_i32 s3, s44, 5120
    v_mfma_f32_16x16x32_bf16 v[52:55], a[108:111], a[56:59], v[52:55]
    ds_read_b64_tr_b16 a[92:93], v222 offset:0
    s_add_u32 m0, s48, 12288
    v_mfma_f32_16x16x32_bf16 v[56:59], a[112:115], a[56:59], v[56:59]
    buffer_load_dwordx4 v229, s[24:27], s51 offen lds
    v_mfma_f32_16x16x32_bf16 v[60:63], a[116:119], a[56:59], v[60:63]
    ds_read_b64_tr_b16 a[94:95], v223 offset:0
    s_add_u32 s3, s3, s59
    v_mfma_f32_16x16x32_bf16 v[64:67], a[104:107], a[60:63], v[64:67]
    ds_read_b64_tr_b16 a[96:97], v220 offset:192
    s_add_u32 s3, s3, 81920
    v_mfma_f32_16x16x32_bf16 v[68:71], a[108:111], a[60:63], v[68:71]
    s_add_u32 s51, s46, 164224
    v_lshlrev_b32 v242, 2, v255
    v_mfma_f32_16x16x32_bf16 v[72:75], a[112:115], a[60:63], v[72:75]
    ds_read_b64_tr_b16 a[98:99], v220 offset:2496
    s_add_u32 m0, s48, 16384
    v_mfma_f32_16x16x32_bf16 v[76:79], a[116:119], a[60:63], v[76:79]
    buffer_load_dwordx4 v229, s[24:27], s51 offen lds
    v_mfma_f32_16x16x32_bf16 v[80:83], a[104:107], a[64:67], v[80:83]
    ds_read_b64_tr_b16 a[100:101], v220 offset:0
    v_cmp_ne_u32 vcc, 0, v255
    v_mfma_f32_16x16x32_bf16 v[84:87], a[108:111], a[64:67], v[84:87]
    v_add_u32 v242, 124, v242
    v_mfma_f32_16x16x32_bf16 v[88:91], a[112:115], a[64:67], v[88:91]
    ds_read_b64_tr_b16 a[102:103], v220 offset:2304
    s_add_u32 s51, s45, 0xca400
    v_mfma_f32_16x16x32_bf16 v[92:95], a[116:119], a[64:67], v[92:95]
    ds_read_b128 a[4:7], v218 offset:2048
    s_add_u32 m0, s47, 59488
    v_mfma_f32_16x16x32_bf16 v[96:99], a[104:107], a[68:71], v[96:99]
    s_bitcmp1_b32 s44, 0
    s_cbranch_scc0 L_sk18
    buffer_load_dwordx4 v228, s[28:31], s51 offen lds
L_sk18:
    v_mfma_f32_16x16x32_bf16 v[100:103], a[108:111], a[68:71], v[100:103]
    ds_read_b128 a[8:11], v218 offset:4096
    s_nop 0
    v_mfma_f32_16x16x32_bf16 v[104:107], a[112:115], a[68:71], v[104:107]
    s_add_u32 s62, s45, 860160
    v_cndmask_b32 v242, 0, v242, vcc
    v_mfma_f32_16x16x32_bf16 v[108:111], a[116:119], a[68:71], v[108:111]
    ds_read_b128 a[12:15], v218 offset:6144
    s_add_u32 m0, s50, 55392
    v_mfma_f32_16x16x32_bf16 v[112:115], a[104:107], a[72:75], v[112:115]
    buffer_load_dwordx4 v224, s[28:31], s62 offen offset:0 lds
    v_mfma_f32_16x16x32_bf16 v[116:119], a[108:111], a[72:75], v[116:119]
    ds_read_b128 a[16:19], v218 offset:8192
    v_mfma_f32_16x16x32_bf16 v[120:123], a[112:115], a[72:75], v[120:123]
    ds_read_b128 a[20:23], v218 offset:10240
    v_mfma_f32_16x16x32_bf16 v[124:127], a[116:119], a[72:75], v[124:127]
    v_mfma_f32_16x16x32_bf16 v[128:131], a[104:107], a[76:79], v[128:131]
    ds_read_b128 a[24:27], v218 offset:12288
    v_mfma_f32_16x16x32_bf16 v[132:135], a[108:111], a[76:79], v[132:135]
    buffer_load_dwordx4 v225, s[28:31], s62 offen offset:1024 lds
    v_mfma_f32_16x16x32_bf16 v[136:139], a[112:115], a[76:79], v[136:139]
    ds_read_b128 a[28:31], v218 offset:14336
    v_mfma_f32_16x16x32_bf16 v[140:143], a[116:119], a[76:79], v[140:143]
    v_mfma_f32_16x16x32_bf16 v[144:147], a[104:107], a[80:83], v[144:147]
    ds_read_b128 a[32:35], v218 offset:16384
    v_mfma_f32_16x16x32_bf16 v[148:151], a[108:111], a[80:83], v[148:151]
    ds_read_b128 a[36:39], v218 offset:18432
    v_mfma_f32_16x16x32_bf16 v[152:155], a[112:115], a[80:83], v[152:155]
    buffer_load_dwordx4 v226, s[28:31], s62 offen offset:2048 lds
    v_mfma_f32_16x16x32_bf16 v[156:159], a[116:119], a[80:83], v[156:159]
    ds_read_b128 a[40:43], v218 offset:20480
    v_mfma_f32_16x16x32_bf16 v[160:163], a[104:107], a[84:87], v[160:163]
    v_mfma_f32_16x16x32_bf16 v[164:167], a[108:111], a[84:87], v[164:167]
    v_mfma_f32_16x16x32_bf16 v[168:171], a[112:115], a[84:87], v[168:171]
    buffer_load_dwordx4 v227, s[28:31], s62 offen offset:3072 lds
    v_mfma_f32_16x16x32_bf16 v[172:175], a[116:119], a[84:87], v[172:175]
    s_waitcnt lgkmcnt(6)
    v_mfma_f32_16x16x32_bf16 v[0:3], a[88:91], a[0:3], v[0:3]
    v_mfma_f32_16x16x32_bf16 v[4:7], a[92:95], a[0:3], v[4:7]
    v_mfma_f32_16x16x32_bf16 v[8:11], a[96:99], a[0:3], v[8:11]
    v_add_u32_e64 v222, v182, v222
    s_add_u32 s51, s46, 205312
    v_mfma_f32_16x16x32_bf16 v[16:19], a[88:91], a[4:7], v[16:19]
    v_add_u32_e64 v223, v182, v223
    s_add_u32 m0, s48, 43008
    v_mfma_f32_16x16x32_bf16 v[20:23], a[92:95], a[4:7], v[20:23]
    s_cmp_lt_u32 s44, 2
    s_cbranch_scc0 L_sk19
    buffer_load_dwordx4 v229, s[24:27], s51 offen lds
L_sk19:
    v_mfma_f32_16x16x32_bf16 v[24:27], a[96:99], a[4:7], v[24:27]
    v_mfma_f32_16x16x32_bf16 v[28:31], a[100:103], a[4:7], v[28:31]
    s_waitcnt vmcnt(13) lgkmcnt(0)
    s_barrier
    v_mfma_f32_16x16x32_bf16 v[32:35], a[88:91], a[8:11], v[32:35]
    ds_read_b64_tr_b16 a[104:105], v221 offset:18464
    s_add_u32 s51, s49, 512
    v_mfma_f32_16x16x32_bf16 v[36:39], a[92:95], a[8:11], v[36:39]
    ds_read_b64_tr_b16 a[106:107], v221 offset:20768
    s_add_u32 m0, s48, 22528
    v_mfma_f32_16x16x32_bf16 v[40:43], a[96:99], a[8:11], v[40:43]
    buffer_load_dwordx4 v229, s[24:27], s51 offen lds
    v_mfma_f32_16x16x32_bf16 v[44:47], a[100:103], a[8:11], v[44:47]
    ds_read_b128 a[44:47], v219 offset:0
    v_mfma_f32_16x16x32_bf16 v[48:51], a[88:91], a[12:15], v[48:51]
    s_add_u32 s51, s46, 41472
    v_mfma_f32_16x16x32_bf16 v[52:55], a[92:95], a[12:15], v[52:55]
    ds_read_b64_tr_b16 a[108:109], v222 offset:0
    s_add_u32 m0, s48, 26624
    v_mfma_f32_16x16x32_bf16 v[56:59], a[96:99], a[12:15], v[56:59]
    buffer_load_dwordx4 v229, s[24:27], s51 offen lds
    v_mfma_f32_16x16x32_bf16 v[60:63], a[100:103], a[12:15], v[60:63]
    ds_read_b64_tr_b16 a[110:111], v223 offset:0
    v_mfma_f32_16x16x32_bf16 v[64:67], a[88:91], a[16:19], v[64:67]
    ds_read_b64_tr_b16 a[112:113], v220 offset:18656
    v_mfma_f32_16x16x32_bf16 v[68:71], a[92:95], a[16:19], v[68:71]
    s_add_u32 s51, s45, 0xe8400
    v_mfma_f32_16x16x32_bf16 v[72:75], a[96:99], a[16:19], v[72:75]
    ds_read_b64_tr_b16 a[114:115], v220 offset:20960
    s_add_u32 m0, s47, 4096
    v_mfma_f32_16x16x32_bf16 v[76:79], a[100:103], a[16:19], v[76:79]
    s_bitcmp1_b32 s44, 0
    s_cbranch_scc0 L_sk20
    buffer_load_dwordx4 v228, s[28:31], s51 offen lds
L_sk20:
    v_mfma_f32_16x16x32_bf16 v[80:83], a[88:91], a[20:23], v[80:83]
    ds_read_b64_tr_b16 a[116:117], v220 offset:18464
    v_mfma_f32_16x16x32_bf16 v[84:87], a[92:95], a[20:23], v[84:87]
    v_mfma_f32_16x16x32_bf16 v[88:91], a[96:99], a[20:23], v[88:91]
    ds_read_b64_tr_b16 a[118:119], v220 offset:20768
    s_add_u32 s62, s45, 983040
    v_mfma_f32_16x16x32_bf16 v[92:95], a[100:103], a[20:23], v[92:95]
    ds_read_b128 a[48:51], v219 offset:2048
    s_add_u32 m0, s50, 0
    v_mfma_f32_16x16x32_bf16 v[96:99], a[88:91], a[24:27], v[96:99]
    buffer_load_dwordx4 v224, s[28:31], s62 offen offset:0 lds
    v_mfma_f32_16x16x32_bf16 v[100:103], a[92:95], a[24:27], v[100:103]
    ds_read_b128 a[52:55], v219 offset:4096
    v_mfma_f32_16x16x32_bf16 v[104:107], a[96:99], a[24:27], v[104:107]
    v_mfma_f32_16x16x32_bf16 v[108:111], a[100:103], a[24:27], v[108:111]
    ds_read_b128 a[56:59], v219 offset:6144
    v_mfma_f32_16x16x32_bf16 v[112:115], a[88:91], a[28:31], v[112:115]
    buffer_load_dwordx4 v225, s[28:31], s62 offen offset:1024 lds
    v_mfma_f32_16x16x32_bf16 v[116:119], a[92:95], a[28:31], v[116:119]
    ds_read_b128 a[60:63], v219 offset:8192
    v_mfma_f32_16x16x32_bf16 v[120:123], a[96:99], a[28:31], v[120:123]
    ds_read_b128 a[64:67], v219 offset:10240
    v_mfma_f32_16x16x32_bf16 v[124:127], a[100:103], a[28:31], v[124:127]
    v_mfma_f32_16x16x32_bf16 v[128:131], a[88:91], a[32:35], v[128:131]
    ds_read_b128 a[68:71], v219 offset:12288
    v_mfma_f32_16x16x32_bf16 v[132:135], a[92:95], a[32:35], v[132:135]
    buffer_load_dwordx4 v226, s[28:31], s62 offen offset:2048 lds
    v_mfma_f32_16x16x32_bf16 v[136:139], a[96:99], a[32:35], v[136:139]
    ds_read_b128 a[72:75], v219 offset:14336
    v_mfma_f32_16x16x32_bf16 v[140:143], a[100:103], a[32:35], v[140:143]
    v_mfma_f32_16x16x32_bf16 v[144:147], a[88:91], a[36:39], v[144:147]
    ds_read_b128 a[76:79], v219 offset:16384
    v_mfma_f32_16x16x32_bf16 v[148:151], a[92:95], a[36:39], v[148:151]
    ds_read_b128 a[80:83], v219 offset:18432
    v_mfma_f32_16x16x32_bf16 v[152:155], a[96:99], a[36:39], v[152:155]
    buffer_load_dwordx4 v227, s[28:31], s62 offen offset:3072 lds
    v_mfma_f32_16x16x32_bf16 v[156:159], a[100:103], a[36:39], v[156:159]
    ds_read_b128 a[84:87], v219 offset:20480
    v_mfma_f32_16x16x32_bf16 v[160:163], a[88:91], a[40:43], v[160:163]
    s_add_u32 s51, s46, 82432
    v_mfma_f32_16x16x32_bf16 v[164:167], a[92:95], a[40:43], v[164:167]
    s_add_u32 m0, s48, 30720
    v_mfma_f32_16x16x32_bf16 v[168:171], a[96:99], a[40:43], v[168:171]
    buffer_load_dwordx4 v229, s[24:27], s51 offen lds
    v_mfma_f32_16x16x32_bf16 v[172:175], a[100:103], a[40:43], v[172:175]
    s_waitcnt lgkmcnt(6)
    v_mfma_f32_16x16x32_bf16 v[0:3], a[104:107], a[44:47], v[0:3]
    s_cmp_lg_u32 s17, 0
    s_cbranch_scc1 L_t21
    s_mul_i32 s84, s16, 6
    buffer_load_dword v241, v240, s[12:15], s84 offen
L_t21:
    v_mfma_f32_16x16x32_bf16 v[4:7], a[108:111], a[44:47], v[4:7]
    v_mfma_f32_16x16x32_bf16 v[8:11], a[112:115], a[44:47], v[8:11]
    v_add_u32 v222, v182, v222
    s_add_u32 s51, s46, 123392
    v_mfma_f32_16x16x32_bf16 v[16:19], a[104:107], a[48:51], v[16:19]
    v_add_u32_e64 v223, v182, v223
    s_add_u32 m0, s48, 34816
    v_mfma_f32_16x16x32_bf16 v[20:23], a[108:111], a[48:51], v[20:23]
    buffer_load_dwordx4 v229, s[24:27], s51 offen lds
    v_mfma_f32_16x16x32_bf16 v[24:27], a[112:115], a[48:51], v[24:27]
    v_mfma_f32_16x16x32_bf16 v[28:31], a[116:119], a[48:51], v[28:31]
    s_waitcnt vmcnt(12) lgkmcnt(0)
    s_barrier
    v_mfma_f32_16x16x32_bf16 v[32:35], a[104:107], a[52:55], v[32:35]
    ds_read_b64_tr_b16 a[88:89], v221 offset:36928
    s_add_u32 s51, s46, 164352
    v_mfma_f32_16x16x32_bf16 v[36:39], a[108:111], a[52:55], v[36:39]
    ds_read_b64_tr_b16 a[90:91], v221 offset:39232
    s_add_u32 m0, s48, 38912
    v_mfma_f32_16x16x32_bf16 v[40:43], a[112:115], a[52:55], v[40:43]
    buffer_load_dwordx4 v229, s[24:27], s51 offen lds
    v_mfma_f32_16x16x32_bf16 v[44:47], a[116:119], a[52:55], v[44:47]
    ds_read_b128 a[0:3], v216 offset:0
    v_mfma_f32_16x16x32_bf16 v[48:51], a[104:107], a[56:59], v[48:51]
    s_add_u32 s51, s45, 0x106400
    v_mfma_f32_16x16x32_bf16 v[52:55], a[108:111], a[56:59], v[52:55]
    ds_read_b64_tr_b16 a[92:93], v222 offset:0
    s_add_u32 m0, s47, 22560
    v_mfma_f32_16x16x32_bf16 v[56:59], a[112:115], a[56:59], v[56:59]
    s_bitcmp1_b32 s44, 0
    s_cbranch_scc0 L_sk22
    buffer_load_dwordx4 v228, s[28:31], s51 offen lds
L_sk22:
    v_mfma_f32_16x16x32_bf16 v[60:63], a[116:119], a[56:59], v[60:63]
    ds_read_b64_tr_b16 a[94:95], v223 offset:0
    v_mfma_f32_16x16x32_bf16 v[64:67], a[104:107], a[60:63], v[64:67]
    ds_read_b64_tr_b16 a[96:97], v220 offset:37120
    v_mfma_f32_16x16x32_bf16 v[68:71], a[108:111], a[60:63], v[68:71]
    s_add_u32 s62, s45, 1105920
    v_mfma_f32_16x16x32_bf16 v[72:75], a[112:115], a[60:63], v[72:75]
    ds_read_b64_tr_b16 a[98:99], v220 offset:39424
    s_add_u32 m0, s50, 18464
    v_mfma_f32_16x16x32_bf16 v[76:79], a[116:119], a[60:63], v[76:79]
    buffer_load_dwordx4 v224, s[28:31], s62 offen offset:0 lds
    v_mfma_f32_16x16x32_bf16 v[80:83], a[104:107], a[64:67], v[80:83]
    ds_read_b64_tr_b16 a[100:101], v220 offset:36928
    v_mfma_f32_16x16x32_bf16 v[84:87], a[108:111], a[64:67], v[84:87]
    v_mfma_f32_16x16x32_bf16 v[88:91], a[112:115], a[64:67], v[88:91]
    ds_read_b64_tr_b16 a[102:103], v220 offset:39232
    v_mfma_f32_16x16x32_bf16 v[92:95], a[116:119], a[64:67], v[92:95]
    ds_read_b128 a[4:7], v216 offset:2048
    v_mfma_f32_16x16x32_bf16 v[96:99], a[104:107], a[68:71], v[96:99]
    buffer_load_dwordx4 v225, s[28:31], s62 offen offset:1024 lds
    v_mfma_f32_16x16x32_bf16 v[100:103], a[108:111], a[68:71], v[100:103]
    ds_read_b128 a[8:11], v216 offset:4096
    v_mfma_f32_16x16x32_bf16 v[104:107], a[112:115], a[68:71], v[104:107]
    v_mfma_f32_16x16x32_bf16 v[108:111], a[116:119], a[68:71], v[108:111]
    ds_read_b128 a[12:15], v216 offset:6144
    v_mfma_f32_16x16x32_bf16 v[112:115], a[104:107], a[72:75], v[112:115]
    buffer_load_dwordx4 v226, s[28:31], s62 offen offset:2048 lds
    v_mfma_f32_16x16x32_bf16 v[116:119], a[108:111], a[72:75], v[116:119]
    ds_read_b128 a[16:19], v216 offset:8192
    v_mfma_f32_16x16x32_bf16 v[120:123], a[112:115], a[72:75], v[120:123]
    ds_read_b128 a[20:23], v216 offset:10240
    v_mfma_f32_16x16x32_bf16 v[124:127], a[116:119], a[72:75], v[124:127]
    v_mfma_f32_16x16x32_bf16 v[128:131], a[104:107], a[76:79], v[128:131]
    ds_read_b128 a[24:27], v216 offset:12288
    v_mfma_f32_16x16x32_bf16 v[132:135], a[108:111], a[76:79], v[132:135]
    buffer_load_dwordx4 v227, s[28:31], s62 offen offset:3072 lds
    v_mfma_f32_16x16x32_bf16 v[136:139], a[112:115], a[76:79], v[136:139]
    ds_read_b128 a[28:31], v216 offset:14336
    v_mfma_f32_16x16x32_bf16 v[140:143], a[116:119], a[76:79], v[140:143]
    v_mfma_f32_16x16x32_bf16 v[144:147], a[104:107], a[80:83], v[144:147]
    ds_read_b128 a[32:35], v216 offset:16384
    s_add_u32 s51, s46, 205440
    v_mfma_f32_16x16x32_bf16 v[148:151], a[108:111], a[80:83], v[148:151]
    ds_read_b128 a[36:39], v216 offset:18432
    s_add_u32 m0, s48, 65536
    v_mfma_f32_16x16x32_bf16 v[152:155], a[112:115], a[80:83], v[152:155]
    s_cmp_lt_u32 s44, 2
    s_cbranch_scc0 L_sk23
    buffer_load_dwordx4 v229, s[24:27], s51 offen lds
L_sk23:
    v_mfma_f32_16x16x32_bf16 v[156:159], a[116:119], a[80:83], v[156:159]
    ds_read_b128 a[40:43], v216 offset:20480
    v_mfma_f32_16x16x32_bf16 v[160:163], a[104:107], a[84:87], v[160:163]
    s_add_u32 s51, s49, 640
    v_mfma_f32_16x16x32_bf16 v[164:167], a[108:111], a[84:87], v[164:167]
    s_add_u32 m0, s48, 45056
    v_mfma_f32_16x16x32_bf16 v[168:171], a[112:115], a[84:87], v[168:171]
    buffer_load_dwordx4 v229, s[24:27], s51 offen lds
    v_mfma_f32_16x16x32_bf16 v[172:175], a[116:119], a[84:87], v[172:175]
    s_waitcnt lgkmcnt(6)
    v_mfma_f32_16x16x32_bf16 v[0:3], a[88:91], a[0:3], v[0:3]
    v_mfma_f32_16x16x32_bf16 v[4:7], a[92:95], a[0:3], v[4:7]
    v_mfma_f32_16x16x32_bf16 v[8:11], a[96:99], a[0:3], v[8:11]
    v_add_u32 v222, v182, v222
    s_add_u32 s51, s46, 41600
    v_mfma_f32_16x16x32_bf16 v[16:19], a[88:91], a[4:7], v[16:19]
    v_add_u32_e64 v223, v182, v223
    s_add_u32 m0, s48, 49152
    v_mfma_f32_16x16x32_bf16 v[20:23], a[92:95], a[4:7], v[20:23]
    buffer_load_dwordx4 v229, s[24:27], s51 offen lds
    v_mfma_f32_16x16x32_bf16 v[24:27], a[96:99], a[4:7], v[24:27]
    v_mfma_f32_16x16x32_bf16 v[28:31], a[100:103], a[4:7], v[28:31]
    s_waitcnt vmcnt(15) lgkmcnt(0)
    s_barrier
    v_mfma_f32_16x16x32_bf16 v[32:35], a[88:91], a[8:11], v[32:35]
    ds_read_b64_tr_b16 a[104:105], v221 offset:55392
    s_add_u32 s51, s45, 0x124400
    v_mfma_f32_16x16x32_bf16 v[36:39], a[92:95], a[8:11], v[36:39]
    ds_read_b64_tr_b16 a[106:107], v221 offset:57696
    s_add_u32 m0, s47, 41024
    v_mfma_f32_16x16x32_bf16 v[40:43], a[96:99], a[8:11], v[40:43]
    s_bitcmp1_b32 s44, 0
    s_cbranch_scc0 L_sk24
    buffer_load_dwordx4 v228, s[28:31], s51 offen lds
L_sk24:
    v_mfma_f32_16x16x32_bf16 v[44:47], a[100:103], a[8:11], v[44:47]
    ds_read_b128 a[44:47], v217 offset:0
    v_mfma_f32_16x16x32_bf16 v[48:51], a[88:91], a[12:15], v[48:51]
    s_add_u32 s62, s45, 1228800
    v_mfma_f32_16x16x32_bf16 v[52:55], a[92:95], a[12:15], v[52:55]
    ds_read_b64_tr_b16 a[108:109], v222 offset:0
    s_add_u32 m0, s50, 36928
    v_mfma_f32_16x16x32_bf16 v[56:59], a[96:99], a[12:15], v[56:59]
    buffer_load_dwordx4 v224, s[28:31], s62 offen offset:0 lds
    v_mfma_f32_16x16x32_bf16 v[60:63], a[100:103], a[12:15], v[60:63]
    ds_read_b64_tr_b16 a[110:111], v223 offset:0
    v_mfma_f32_16x16x32_bf16 v[64:67], a[88:91], a[16:19], v[64:67]
    ds_read_b64_tr_b16 a[112:113], v220 offset:55584
    v_mfma_f32_16x16x32_bf16 v[68:71], a[92:95], a[16:19], v[68:71]
    v_mfma_f32_16x16x32_bf16 v[72:75], a[96:99], a[16:19], v[72:75]
    ds_read_b64_tr_b16 a[114:115], v220 offset:57888
    v_mfma_f32_16x16x32_bf16 v[76:79], a[100:103], a[16:19], v[76:79]
    buffer_load_dwordx4 v225, s[28:31], s62 offen offset:1024 lds
    v_mfma_f32_16x16x32_bf16 v[80:83], a[88:91], a[20:23], v[80:83]
    ds_read_b64_tr_b16 a[116:117], v220 offset:55392
    v_mfma_f32_16x16x32_bf16 v[84:87], a[92:95], a[20:23], v[84:87]
    v_mfma_f32_16x16x32_bf16 v[88:91], a[96:99], a[20:23], v[88:91]
    ds_read_b64_tr_b16 a[118:119], v220 offset:57696
    v_mfma_f32_16x16x32_bf16 v[92:95], a[100:103], a[20:23], v[92:95]
    ds_read_b128 a[48:51], v217 offset:2048
    v_mfma_f32_16x16x32_bf16 v[96:99], a[88:91], a[24:27], v[96:99]
    buffer_load_dwordx4 v226, s[28:31], s62 offen offset:2048 lds
    v_mfma_f32_16x16x32_bf16 v[100:103], a[92:95], a[24:27], v[100:103]
    ds_read_b128 a[52:55], v217 offset:4096
    v_mfma_f32_16x16x32_bf16 v[104:107], a[96:99], a[24:27], v[104:107]
    v_mfma_f32_16x16x32_bf16 v[108:111], a[100:103], a[24:27], v[108:111]
    ds_read_b128 a[56:59], v217 offset:6144
    v_mfma_f32_16x16x32_bf16 v[112:115], a[88:91], a[28:31], v[112:115]
    buffer_load_dwordx4 v227, s[28:31], s62 offen offset:3072 lds
    v_mfma_f32_16x16x32_bf16 v[116:119], a[92:95], a[28:31], v[116:119]
    ds_read_b128 a[60:63], v217 offset:8192
    v_mfma_f32_16x16x32_bf16 v[120:123], a[96:99], a[28:31], v[120:123]
    ds_read_b128 a[64:67], v217 offset:10240
    v_mfma_f32_16x16x32_bf16 v[124:127], a[100:103], a[28:31], v[124:127]
    s_add_u32 s51, s46, 82560
    v_mfma_f32_16x16x32_bf16 v[128:131], a[88:91], a[32:35], v[128:131]
    ds_read_b128 a[68:71], v217 offset:12288
    s_add_u32 m0, s48, 53248
    v_mfma_f32_16x16x32_bf16 v[132:135], a[92:95], a[32:35], v[132:135]
    buffer_load_dwordx4 v229, s[24:27], s51 offen lds
    v_mfma_f32_16x16x32_bf16 v[136:139], a[96:99], a[32:35], v[136:139]
    ds_read_b128 a[72:75], v217 offset:14336
    v_mfma_f32_16x16x32_bf16 v[140:143], a[100:103], a[32:35], v[140:143]
    v_mfma_f32_16x16x32_bf16 v[144:147], a[88:91], a[36:39], v[144:147]
    ds_read_b128 a[76:79], v217 offset:16384
    s_add_u32 s51, s46, 123520
    v_mfma_f32_16x16x32_bf16 v[148:151], a[92:95], a[36:39], v[148:151]
    ds_read_b128 a[80:83], v217 offset:18432
    s_add_u32 m0, s48, 57344
    v_mfma_f32_16x16x32_bf16 v[152:155], a[96:99], a[36:39], v[152:155]
    buffer_load_dwordx4 v229, s[24:27], s51 offen lds
    v_mfma_f32_16x16x32_bf16 v[156:159], a[100:103], a[36:39], v[156:159]
    ds_read_b128 a[84:87], v217 offset:20480
    v_mfma_f32_16x16x32_bf16 v[160:163], a[88:91], a[40:43], v[160:163]
    s_add_u32 s51, s46, 164480
    v_mfma_f32_16x16x32_bf16 v[164:167], a[92:95], a[40:43], v[164:167]
    s_add_u32 m0, s48, 61440
    v_mfma_f32_16x16x32_bf16 v[168:171], a[96:99], a[40:43], v[168:171]
    buffer_load_dwordx4 v229, s[24:27], s51 offen lds
    v_mfma_f32_16x16x32_bf16 v[172:175], a[100:103], a[40:43], v[172:175]
    s_waitcnt lgkmcnt(6)
    v_mfma_f32_16x16x32_bf16 v[0:3], a[104:107], a[44:47], v[0:3]
    s_cmp_lg_u32 s17, 1
    s_cbranch_scc1 L_t25
    s_mul_i32 s84, s16, 7
    buffer_load_dword v241, v240, s[12:15], s84 offen
L_t25:
    v_mfma_f32_16x16x32_bf16 v[4:7], a[108:111], a[44:47], v[4:7]
    v_mfma_f32_16x16x32_bf16 v[8:11], a[112:115], a[44:47], v[8:11]
    v_add_u32_e64 v222, v183, v222
    v_mfma_f32_16x16x32_bf16 v[16:19], a[104:107], a[48:51], v[16:19]
    v_add_u32_e64 v223, v183, v223
    v_mfma_f32_16x16x32_bf16 v[20:23], a[108:111], a[48:51], v[20:23]
    v_mfma_f32_16x16x32_bf16 v[24:27], a[112:115], a[48:51], v[24:27]
    v_mfma_f32_16x16x32_bf16 v[28:31], a[116:119], a[48:51], v[28:31]
    s_waitcnt vmcnt(13) lgkmcnt(0)
    s_barrier
    v_mfma_f32_16x16x32_bf16 v[32:35], a[104:107], a[52:55], v[32:35]
    ds_read_b64_tr_b16 a[88:89], v221 offset:0
    s_add_u32 s51, s45, 0x142400
    v_mfma_f32_16x16x32_bf16 v[36:39], a[108:111], a[52:55], v[36:39]
    ds_read_b64_tr_b16 a[90:91], v221 offset:2304
    s_add_u32 m0, s47, 59488
    v_mfma_f32_16x16x32_bf16 v[40:43], a[112:115], a[52:55], v[40:43]
    s_bitcmp1_b32 s44, 0
    s_cbranch_scc0 L_sk26
    buffer_load_dwordx4 v228, s[28:31], s51 offen lds
L_sk26:
    v_mfma_f32_16x16x32_bf16 v[44:47], a[116:119], a[52:55], v[44:47]
    ds_read_b128 a[0:3], v216 offset:22528
    v_mfma_f32_16x16x32_bf16 v[48:51], a[104:107], a[56:59], v[48:51]
    s_add_u32 s62, s45, 1351680
    v_mfma_f32_16x16x32_bf16 v[52:55], a[108:111], a[56:59], v[52:55]
    ds_read_b64_tr_b16 a[92:93], v222 offset:0
    s_add_u32 m0, s50, 55392
    v_mfma_f32_16x16x32_bf16 v[56:59], a[112:115], a[56:59], v[56:59]
    buffer_load_dwordx4 v224, s[28:31], s62 offen offset:0 lds
    v_mfma_f32_16x16x32_bf16 v[60:63], a[116:119], a[56:59], v[60:63]
    ds_read_b64_tr_b16 a[94:95], v223 offset:0
    v_mfma_f32_16x16x32_bf16 v[64:67], a[104:107], a[60:63], v[64:67]
    ds_read_b64_tr_b16 a[96:97], v220 offset:192
    v_mfma_f32_16x16x32_bf16 v[68:71], a[108:111], a[60:63], v[68:71]
    v_mfma_f32_16x16x32_bf16 v[72:75], a[112:115], a[60:63], v[72:75]
    ds_read_b64_tr_b16 a[98:99], v220 offset:2496
    v_mfma_f32_16x16x32_bf16 v[76:79], a[116:119], a[60:63], v[76:79]
    buffer_load_dwordx4 v225, s[28:31], s62 offen offset:1024 lds
    v_mfma_f32_16x16x32_bf16 v[80:83], a[104:107], a[64:67], v[80:83]
    ds_read_b64_tr_b16 a[100:101], v220 offset:0
    v_mfma_f32_16x16x32_bf16 v[84:87], a[108:111], a[64:67], v[84:87]
    v_mfma_f32_16x16x32_bf16 v[88:91], a[112:115], a[64:67], v[88:91]
    ds_read_b64_tr_b16 a[102:103], v220 offset:2304
    v_mfma_f32_16x16x32_bf16 v[92:95], a[116:119], a[64:67], v[92:95]
    ds_read_b128 a[4:7], v216 offset:24576
    v_mfma_f32_16x16x32_bf16 v[96:99], a[104:107], a[68:71], v[96:99]
    buffer_load_dwordx4 v226, s[28:31], s62 offen offset:2048 lds
    v_mfma_f32_16x16x32_bf16 v[100:103], a[108:111], a[68:71], v[100:103]
    ds_read_b128 a[8:11], v216 offset:26624
    v_mfma_f32_16x16x32_bf16 v[104:107], a[112:115], a[68:71], v[104:107]
    v_mfma_f32_16x16x32_bf16 v[108:111], a[116:119], a[68:71], v[108:111]
    ds_read_b128 a[12:15], v216 offset:28672
    v_mfma_f32_16x16x32_bf16 v[112:115], a[104:107], a[72:75], v[112:115]
    buffer_load_dwordx4 v227, s[28:31], s62 offen offset:3072 lds
    v_mfma_f32_16x16x32_bf16 v[116:119], a[108:111], a[72:75], v[116:119]
    ds_read_b128 a[16:19], v216 offset:30720
    v_mfma_f32_16x16x32_bf16 v[120:123], a[112:115], a[72:75], v[120:123]
    ds_read_b128 a[20:23], v216 offset:32768
    v_mfma_f32_16x16x32_bf16 v[124:127], a[116:119], a[72:75], v[124:127]
    s_add_u32 s51, s46, 205568
    v_mfma_f32_16x16x32_bf16 v[128:131], a[104:107], a[76:79], v[128:131]
    ds_read_b128 a[24:27], v216 offset:34816
    s_add_u32 m0, s48, 20480
    v_mfma_f32_16x16x32_bf16 v[132:135], a[108:111], a[76:79], v[132:135]
    s_cmp_lt_u32 s44, 2
    s_cbranch_scc0 L_sk27
    buffer_load_dwordx4 v229, s[24:27], s51 offen lds
L_sk27:
    v_mfma_f32_16x16x32_bf16 v[136:139], a[112:115], a[76:79], v[136:139]
    ds_read_b128 a[28:31], v216 offset:36864
    v_mfma_f32_16x16x32_bf16 v[140:143], a[116:119], a[76:79], v[140:143]
    v_mfma_f32_16x16x32_bf16 v[144:147], a[104:107], a[80:83], v[144:147]
    ds_read_b128 a[32:35], v216 offset:38912
    s_add_u32 s51, s49, 768
    v_mfma_f32_16x16x32_bf16 v[148:151], a[108:111], a[80:83], v[148:151]
    ds_read_b128 a[36:39], v216 offset:40960
    s_add_u32 m0, s48, 0
    v_mfma_f32_16x16x32_bf16 v[152:155], a[112:115], a[80:83], v[152:155]
    buffer_load_dwordx4 v229, s[24:27], s51 offen lds
    v_mfma_f32_16x16x32_bf16 v[156:159], a[116:119], a[80:83], v[156:159]
    ds_read_b128 a[40:43], v216 offset:43008
    v_mfma_f32_16x16x32_bf16 v[160:163], a[104:107], a[84:87], v[160:163]
    s_add_u32 s51, s46, 41728
    v_mfma_f32_16x16x32_bf16 v[164:167], a[108:111], a[84:87], v[164:167]
    s_add_u32 m0, s48, 4096
    v_mfma_f32_16x16x32_bf16 v[168:171], a[112:115], a[84:87], v[168:171]
    buffer_load_dwordx4 v229, s[24:27], s51 offen lds
    v_mfma_f32_16x16x32_bf16 v[172:175], a[116:119], a[84:87], v[172:175]
    s_waitcnt lgkmcnt(6)
    v_mfma_f32_16x16x32_bf16 v[0:3], a[88:91], a[0:3], v[0:3]
    v_mfma_f32_16x16x32_bf16 v[4:7], a[92:95], a[0:3], v[4:7]
    v_mfma_f32_16x16x32_bf16 v[8:11], a[96:99], a[0:3], v[8:11]
    v_add_u32_e64 v222, v182, v222
    v_mfma_f32_16x16x32_bf16 v[16:19], a[88:91], a[4:7], v[16:19]
    v_add_u32_e64 v223, v182, v223
    v_mfma_f32_16x16x32_bf16 v[20:23], a[92:95], a[4:7], v[20:23]
    v_mfma_f32_16x16x32_bf16 v[24:27], a[96:99], a[4:7], v[24:27]
    v_mfma_f32_16x16x32_bf16 v[28:31], a[100:103], a[4:7], v[28:31]
    s_waitcnt vmcnt(15) lgkmcnt(0)
    s_barrier
    v_mfma_f32_16x16x32_bf16 v[32:35], a[88:91], a[8:11], v[32:35]
    ds_read_b64_tr_b16 a[104:105], v221 offset:18464
    s_add_u32 s51, s45, 0x160400
    v_mfma_f32_16x16x32_bf16 v[36:39], a[92:95], a[8:11], v[36:39]
    ds_read_b64_tr_b16 a[106:107], v221 offset:20768
    s_add_u32 m0, s47, 4096
    v_mfma_f32_16x16x32_bf16 v[40:43], a[96:99], a[8:11], v[40:43]
    s_bitcmp1_b32 s44, 0
    s_cbranch_scc0 L_sk28
    buffer_load_dwordx4 v228, s[28:31], s51 offen lds
L_sk28:
    v_mfma_f32_16x16x32_bf16 v[44:47], a[100:103], a[8:11], v[44:47]
    ds_read_b128 a[44:47], v217 offset:22528
    v_mfma_f32_16x16x32_bf16 v[48:51], a[88:91], a[12:15], v[48:51]
    s_add_u32 s62, s45, 1474560
    v_mfma_f32_16x16x32_bf16 v[52:55], a[92:95], a[12:15], v[52:55]
    ds_read_b64_tr_b16 a[108:109], v222 offset:0
    s_add_u32 m0, s50, 0
    v_mfma_f32_16x16x32_bf16 v[56:59], a[96:99], a[12:15], v[56:59]
    buffer_load_dwordx4 v224, s[28:31], s62 offen offset:0 lds
    v_mfma_f32_16x16x32_bf16 v[60:63], a[100:103], a[12:15], v[60:63]
    ds_read_b64_tr_b16 a[110:111], v223 offset:0
    v_mfma_f32_16x16x32_bf16 v[64:67], a[88:91], a[16:19], v[64:67]
    ds_read_b64_tr_b16 a[112:113], v220 offset:18656
    v_mfma_f32_16x16x32_bf16 v[68:71], a[92:95], a[16:19], v[68:71]
    v_mfma_f32_16x16x32_bf16 v[72:75], a[96:99], a[16:19], v[72:75]
    ds_read_b64_tr_b16 a[114:115], v220 offset:20960
    v_mfma_f32_16x16x32_bf16 v[76:79], a[100:103], a[16:19], v[76:79]
    buffer_load_dwordx4 v225, s[28:31], s62 offen offset:1024 lds
    v_mfma_f32_16x16x32_bf16 v[80:83], a[88:91], a[20:23], v[80:83]
    ds_read_b64_tr_b16 a[116:117], v220 offset:18464
    v_mfma_f32_16x16x32_bf16 v[84:87], a[92:95], a[20:23], v[84:87]
    v_mfma_f32_16x16x32_bf16 v[88:91], a[96:99], a[20:23], v[88:91]
    ds_read_b64_tr_b16 a[118:119], v220 offset:20768
    v_mfma_f32_16x16x32_bf16 v[92:95], a[100:103], a[20:23], v[92:95]
    ds_read_b128 a[48:51], v217 offset:24576
    v_mfma_f32_16x16x32_bf16 v[96:99], a[88:91], a[24:27], v[96:99]
    buffer_load_dwordx4 v226, s[28:31], s62 offen offset:2048 lds
    v_mfma_f32_16x16x32_bf16 v[100:103], a[92:95], a[24:27], v[100:103]
    ds_read_b128 a[52:55], v217 offset:26624
    v_mfma_f32_16x16x32_bf16 v[104:107], a[96:99], a[24:27], v[104:107]
    v_mfma_f32_16x16x32_bf16 v[108:111], a[100:103], a[24:27], v[108:111]
    ds_read_b128 a[56:59], v217 offset:28672
    v_mfma_f32_16x16x32_bf16 v[112:115], a[88:91], a[28:31], v[112:115]
    buffer_load_dwordx4 v227, s[28:31], s62 offen offset:3072 lds
    v_mfma_f32_16x16x32_bf16 v[116:119], a[92:95], a[28:31], v[116:119]
    ds_read_b128 a[60:63], v217 offset:30720
    v_mfma_f32_16x16x32_bf16 v[120:123], a[96:99], a[28:31], v[120:123]
    ds_read_b128 a[64:67], v217 offset:32768
    v_mfma_f32_16x16x32_bf16 v[124:127], a[100:103], a[28:31], v[124:127]
    s_add_u32 s51, s46, 82688
    v_mfma_f32_16x16x32_bf16 v[128:131], a[88:91], a[32:35], v[128:131]
    ds_read_b128 a[68:71], v217 offset:34816
    s_add_u32 m0, s48, 8192
    v_mfma_f32_16x16x32_bf16 v[132:135], a[92:95], a[32:35], v[132:135]
    buffer_load_dwordx4 v229, s[24:27], s51 offen lds
    v_mfma_f32_16x16x32_bf16 v[136:139], a[96:99], a[32:35], v[136:139]
    ds_read_b128 a[72:75], v217 offset:36864
    v_mfma_f32_16x16x32_bf16 v[140:143], a[100:103], a[32:35], v[140:143]
    v_mfma_f32_16x16x32_bf16 v[144:147], a[88:91], a[36:39], v[144:147]
    ds_read_b128 a[76:79], v217 offset:38912
    s_add_u32 s51, s46, 123648
    v_mfma_f32_16x16x32_bf16 v[148:151], a[92:95], a[36:39], v[148:151]
    ds_read_b128 a[80:83], v217 offset:40960
    s_add_u32 m0, s48, 12288
    v_mfma_f32_16x16x32_bf16 v[152:155], a[96:99], a[36:39], v[152:155]
    buffer_load_dwordx4 v229, s[24:27], s51 offen lds
    v_mfma_f32_16x16x32_bf16 v[156:159], a[100:103], a[36:39], v[156:159]
    ds_read_b128 a[84:87], v217 offset:43008
    v_mfma_f32_16x16x32_bf16 v[160:163], a[88:91], a[40:43], v[160:163]
    s_add_u32 s51, s46, 164608
    v_mfma_f32_16x16x32_bf16 v[164:167], a[92:95], a[40:43], v[164:167]
    s_add_u32 m0, s48, 16384
    v_mfma_f32_16x16x32_bf16 v[168:171], a[96:99], a[40:43], v[168:171]
    buffer_load_dwordx4 v229, s[24:27], s51 offen lds
    v_mfma_f32_16x16x32_bf16 v[172:175], a[100:103], a[40:43], v[172:175]
    s_waitcnt lgkmcnt(6)
    v_mfma_f32_16x16x32_bf16 v[0:3], a[104:107], a[44:47], v[0:3]
    s_cmp_lg_u32 s17, 2
    s_cbranch_scc1 L_t29
    s_mul_i32 s84, s16, 8
    buffer_load_dword v241, v240, s[12:15], s84 offen
L_t29:
    v_mfma_f32_16x16x32_bf16 v[4:7], a[108:111], a[44:47], v[4:7]
    v_mfma_f32_16x16x32_bf16 v[8:11], a[112:115], a[44:47], v[8:11]
    v_add_u32 v222, v182, v222
    v_mfma_f32_16x16x32_bf16 v[16:19], a[104:107], a[48:51], v[16:19]
    v_add_u32_e64 v223, v182, v223
    v_mfma_f32_16x16x32_bf16 v[20:23], a[108:111], a[48:51], v[20:23]
    v_mfma_f32_16x16x32_bf16 v[24:27], a[112:115], a[48:51], v[24:27]
    v_mfma_f32_16x16x32_bf16 v[28:31], a[116:119], a[48:51], v[28:31]
    s_waitcnt vmcnt(13) lgkmcnt(0)
    s_barrier
    v_mfma_f32_16x16x32_bf16 v[32:35], a[104:107], a[52:55], v[32:35]
    ds_read_b64_tr_b16 a[88:89], v221 offset:36928
    s_add_u32 s51, s45, 0x17e400
    v_mfma_f32_16x16x32_bf16 v[36:39], a[108:111], a[52:55], v[36:39]
    ds_read_b64_tr_b16 a[90:91], v221 offset:39232
    s_add_u32 m0, s47, 22560
    v_mfma_f32_16x16x32_bf16 v[40:43], a[112:115], a[52:55], v[40:43]
    s_bitcmp1_b32 s44, 0
    s_cbranch_scc0 L_sk30
    buffer_load_dwordx4 v228, s[28:31], s51 offen lds
L_sk30:
    v_mfma_f32_16x16x32_bf16 v[44:47], a[116:119], a[52:55], v[44:47]
    ds_read_b128 a[0:3], v218 offset:0
    v_mfma_f32_16x16x32_bf16 v[48:51], a[104:107], a[56:59], v[48:51]
    s_add_u32 s62, s45, 1597440
    v_mfma_f32_16x16x32_bf16 v[52:55], a[108:111], a[56:59], v[52:55]
    ds_read_b64_tr_b16 a[92:93], v222 offset:0
    s_add_u32 m0, s50, 18464
    v_mfma_f32_16x16x32_bf16 v[56:59], a[112:115], a[56:59], v[56:59]
    buffer_load_dwordx4 v224, s[28:31], s62 offen offset:0 lds
    v_mfma_f32_16x16x32_bf16 v[60:63], a[116:119], a[56:59], v[60:63]
    ds_read_b64_tr_b16 a[94:95], v223 offset:0
    v_mfma_f32_16x16x32_bf16 v[64:67], a[104:107], a[60:63], v[64:67]
    ds_read_b64_tr_b16 a[96:97], v220 offset:37120
    v_mfma_f32_16x16x32_bf16 v[68:71], a[108:111], a[60:63], v[68:71]
    v_mfma_f32_16x16x32_bf16 v[72:75], a[112:115], a[60:63], v[72:75]
    ds_read_b64_tr_b16 a[98:99], v220 offset:39424
    v_mfma_f32_16x16x32_bf16 v[76:79], a[116:119], a[60:63], v[76:79]
    buffer_load_dwordx4 v225, s[28:31], s62 offen offset:1024 lds
    v_mfma_f32_16x16x32_bf16 v[80:83], a[104:107], a[64:67], v[80:83]
    ds_read_b64_tr_b16 a[100:101], v220 offset:36928
    v_mfma_f32_16x16x32_bf16 v[84:87], a[108:111], a[64:67], v[84:87]
    v_mfma_f32_16x16x32_bf16 v[88:91], a[112:115], a[64:67], v[88:91]
    ds_read_b64_tr_b16 a[102:103], v220 offset:39232
    v_mfma_f32_16x16x32_bf16 v[92:95], a[116:119], a[64:67], v[92:95]
    ds_read_b128 a[4:7], v218 offset:2048
    v_mfma_f32_16x16x32_bf16 v[96:99], a[104:107], a[68:71], v[96:99]
    buffer_load_dwordx4 v226, s[28:31], s62 offen offset:2048 lds
    v_mfma_f32_16x16x32_bf16 v[100:103], a[108:111], a[68:71], v[100:103]
    ds_read_b128 a[8:11], v218 offset:4096
    v_mfma_f32_16x16x32_bf16 v[104:107], a[112:115], a[68:71], v[104:107]
    v_mfma_f32_16x16x32_bf16 v[108:111], a[116:119], a[68:71], v[108:111]
    ds_read_b128 a[12:15], v218 offset:6144
    v_mfma_f32_16x16x32_bf16 v[112:115], a[104:107], a[72:75], v[112:115]
    buffer_load_dwordx4 v227, s[28:31], s62 offen offset:3072 lds
    v_mfma_f32_16x16x32_bf16 v[116:119], a[108:111], a[72:75], v[116:119]
    ds_read_b128 a[16:19], v218 offset:8192
    v_mfma_f32_16x16x32_bf16 v[120:123], a[112:115], a[72:75], v[120:123]
    ds_read_b128 a[20:23], v218 offset:10240
    v_mfma_f32_16x16x32_bf16 v[124:127], a[116:119], a[72:75], v[124:127]
    s_add_u32 s51, s46, 205696
    v_mfma_f32_16x16x32_bf16 v[128:131], a[104:107], a[76:79], v[128:131]
    ds_read_b128 a[24:27], v218 offset:12288
    s_add_u32 m0, s48, 43008
    v_mfma_f32_16x16x32_bf16 v[132:135], a[108:111], a[76:79], v[132:135]
    s_cmp_lt_u32 s44, 2
    s_cbranch_scc0 L_sk31
    buffer_load_dwordx4 v229, s[24:27], s51 offen lds
L_sk31:
    v_mfma_f32_16x16x32_bf16 v[136:139], a[112:115], a[76:79], v[136:139]
    ds_read_b128 a[28:31], v218 offset:14336
    v_mfma_f32_16x16x32_bf16 v[140:143], a[116:119], a[76:79], v[140:143]
    v_mfma_f32_16x16x32_bf16 v[144:147], a[104:107], a[80:83], v[144:147]
    ds_read_b128 a[32:35], v218 offset:16384
    s_add_u32 s51, s49, 896
    v_mfma_f32_16x16x32_bf16 v[148:151], a[108:111], a[80:83], v[148:151]
    ds_read_b128 a[36:39], v218 offset:18432
    s_add_u32 m0, s48, 22528
    v_mfma_f32_16x16x32_bf16 v[152:155], a[112:115], a[80:83], v[152:155]
    buffer_load_dwordx4 v229, s[24:27], s51 offen lds
    v_mfma_f32_16x16x32_bf16 v[156:159], a[116:119], a[80:83], v[156:159]
    ds_read_b128 a[40:43], v218 offset:20480
    v_mfma_f32_16x16x32_bf16 v[160:163], a[104:107], a[84:87], v[160:163]
    s_add_u32 s51, s46, 41856
    v_mfma_f32_16x16x32_bf16 v[164:167], a[108:111], a[84:87], v[164:167]
    s_add_u32 m0, s48, 26624
    v_mfma_f32_16x16x32_bf16 v[168:171], a[112:115], a[84:87], v[168:171]
    buffer_load_dwordx4 v229, s[24:27], s51 offen lds
    v_mfma_f32_16x16x32_bf16 v[172:175], a[116:119], a[84:87], v[172:175]
    s_waitcnt lgkmcnt(6)
    v_mfma_f32_16x16x32_bf16 v[0:3], a[88:91], a[0:3], v[0:3]
    v_mfma_f32_16x16x32_bf16 v[4:7], a[92:95], a[0:3], v[4:7]
    v_mfma_f32_16x16x32_bf16 v[8:11], a[96:99], a[0:3], v[8:11]
    v_add_u32 v222, v182, v222
    v_mfma_f32_16x16x32_bf16 v[16:19], a[88:91], a[4:7], v[16:19]
    v_add_u32_e64 v223, v182, v223
    v_mfma_f32_16x16x32_bf16 v[20:23], a[92:95], a[4:7], v[20:23]
    v_mfma_f32_16x16x32_bf16 v[24:27], a[96:99], a[4:7], v[24:27]
    v_mfma_f32_16x16x32_bf16 v[28:31], a[100:103], a[4:7], v[28:31]
    s_waitcnt vmcnt(15) lgkmcnt(0)
    s_barrier
    v_mfma_f32_16x16x32_bf16 v[32:35], a[88:91], a[8:11], v[32:35]
    ds_read_b64_tr_b16 a[104:105], v221 offset:55392
    s_add_u32 s51, s45, 0x19c400
    v_mfma_f32_16x16x32_bf16 v[36:39], a[92:95], a[8:11], v[36:39]
    ds_read_b64_tr_b16 a[106:107], v221 offset:57696
    s_add_u32 m0, s47, 41024
    v_mfma_f32_16x16x32_bf16 v[40:43], a[96:99], a[8:11], v[40:43]
    s_bitcmp1_b32 s44, 0
    s_cbranch_scc0 L_sk32
    buffer_load_dwordx4 v228, s[28:31], s51 offen lds
L_sk32:
    v_mfma_f32_16x16x32_bf16 v[44:47], a[100:103], a[8:11], v[44:47]
    ds_read_b128 a[44:47], v219 offset:0
    v_mfma_f32_16x16x32_bf16 v[48:51], a[88:91], a[12:15], v[48:51]
    s_add_u32 s62, s45, 1720320
    v_mfma_f32_16x16x32_bf16 v[52:55], a[92:95], a[12:15], v[52:55]
    ds_read_b64_tr_b16 a[108:109], v222 offset:0
    s_add_u32 m0, s50, 36928
    v_mfma_f32_16x16x32_bf16 v[56:59], a[96:99], a[12:15], v[56:59]
    buffer_load_dwordx4 v224, s[28:31], s62 offen offset:0 lds
    v_mfma_f32_16x16x32_bf16 v[60:63], a[100:103], a[12:15], v[60:63]
    ds_read_b64_tr_b16 a[110:111], v223 offset:0
    v_mfma_f32_16x16x32_bf16 v[64:67], a[88:91], a[16:19], v[64:67]
    ds_read_b64_tr_b16 a[112:113], v220 offset:55584
    v_mfma_f32_16x16x32_bf16 v[68:71], a[92:95], a[16:19], v[68:71]
    v_mfma_f32_16x16x32_bf16 v[72:75], a[96:99], a[16:19], v[72:75]
    ds_read_b64_tr_b16 a[114:115], v220 offset:57888
    v_mfma_f32_16x16x32_bf16 v[76:79], a[100:103], a[16:19], v[76:79]
    buffer_load_dwordx4 v225, s[28:31], s62 offen offset:1024 lds
    v_mfma_f32_16x16x32_bf16 v[80:83], a[88:91], a[20:23], v[80:83]
    ds_read_b64_tr_b16 a[116:117], v220 offset:55392
    v_mfma_f32_16x16x32_bf16 v[84:87], a[92:95], a[20:23], v[84:87]
    v_mfma_f32_16x16x32_bf16 v[88:91], a[96:99], a[20:23], v[88:91]
    ds_read_b64_tr_b16 a[118:119], v220 offset:57696
    v_mfma_f32_16x16x32_bf16 v[92:95], a[100:103], a[20:23], v[92:95]
    ds_read_b128 a[48:51], v219 offset:2048
    v_mfma_f32_16x16x32_bf16 v[96:99], a[88:91], a[24:27], v[96:99]
    buffer_load_dwordx4 v226, s[28:31], s62 offen offset:2048 lds
    v_mfma_f32_16x16x32_bf16 v[100:103], a[92:95], a[24:27], v[100:103]
    ds_read_b128 a[52:55], v219 offset:4096
    v_mfma_f32_16x16x32_bf16 v[104:107], a[96:99], a[24:27], v[104:107]
    v_mfma_f32_16x16x32_bf16 v[108:111], a[100:103], a[24:27], v[108:111]
    ds_read_b128 a[56:59], v219 offset:6144
    v_mfma_f32_16x16x32_bf16 v[112:115], a[88:91], a[28:31], v[112:115]
    buffer_load_dwordx4 v227, s[28:31], s62 offen offset:3072 lds
    v_mfma_f32_16x16x32_bf16 v[116:119], a[92:95], a[28:31], v[116:119]
    ds_read_b128 a[60:63], v219 offset:8192
    v_mfma_f32_16x16x32_bf16 v[120:123], a[96:99], a[28:31], v[120:123]
    ds_read_b128 a[64:67], v219 offset:10240
    v_mfma_f32_16x16x32_bf16 v[124:127], a[100:103], a[28:31], v[124:127]
    s_add_u32 s51, s46, 82816
    v_mfma_f32_16x16x32_bf16 v[128:131], a[88:91], a[32:35], v[128:131]
    ds_read_b128 a[68:71], v219 offset:12288
    s_add_u32 m0, s48, 30720
    v_mfma_f32_16x16x32_bf16 v[132:135], a[92:95], a[32:35], v[132:135]
    buffer_load_dwordx4 v229, s[24:27], s51 offen lds
    v_mfma_f32_16x16x32_bf16 v[136:139], a[96:99], a[32:35], v[136:139]
    ds_read_b128 a[72:75], v219 offset:14336
    v_mfma_f32_16x16x32_bf16 v[140:143], a[100:103], a[32:35], v[140:143]
    v_mfma_f32_16x16x32_bf16 v[144:147], a[88:91], a[36:39], v[144:147]
    ds_read_b128 a[76:79], v219 offset:16384
    s_add_u32 s51, s46, 123776
    v_mfma_f32_16x16x32_bf16 v[148:151], a[92:95], a[36:39], v[148:151]
    ds_read_b128 a[80:83], v219 offset:18432
    s_add_u32 m0, s48, 34816
    v_mfma_f32_16x16x32_bf16 v[152:155], a[96:99], a[36:39], v[152:155]
    buffer_load_dwordx4 v229, s[24:27], s51 offen lds
    v_mfma_f32_16x16x32_bf16 v[156:159], a[100:103], a[36:39], v[156:159]
    ds_read_b128 a[84:87], v219 offset:20480
    v_mfma_f32_16x16x32_bf16 v[160:163], a[88:91], a[40:43], v[160:163]
    s_add_u32 s51, s46, 164736
    v_mfma_f32_16x16x32_bf16 v[164:167], a[92:95], a[40:43], v[164:167]
    s_add_u32 m0, s48, 38912
    v_mfma_f32_16x16x32_bf16 v[168:171], a[96:99], a[40:43], v[168:171]
    buffer_load_dwordx4 v229, s[24:27], s51 offen lds
    v_mfma_f32_16x16x32_bf16 v[172:175], a[100:103], a[40:43], v[172:175]
    s_waitcnt lgkmcnt(6)
    v_mfma_f32_16x16x32_bf16 v[0:3], a[104:107], a[44:47], v[0:3]
    s_cmp_lg_u32 s17, 0
    s_cbranch_scc1 L_t33
    s_mul_i32 s84, s16, 9
    buffer_load_dword v241, v240, s[12:15], s84 offen
L_t33:
    v_mfma_f32_16x16x32_bf16 v[4:7], a[108:111], a[44:47], v[4:7]
    buffer_load_dword v243, v242, s[72:75], 0 offen sc1
    v_mfma_f32_16x16x32_bf16 v[8:11], a[112:115], a[44:47], v[8:11]
    v_add_u32_e64 v222, v183, v222
    v_mfma_f32_16x16x32_bf16 v[16:19], a[104:107], a[48:51], v[16:19]
    v_add_u32_e64 v223, v183, v223
    v_mfma_f32_16x16x32_bf16 v[20:23], a[108:111], a[48:51], v[20:23]
    v_mfma_f32_16x16x32_bf16 v[24:27], a[112:115], a[48:51], v[24:27]
    v_mfma_f32_16x16x32_bf16 v[28:31], a[116:119], a[48:51], v[28:31]
    s_waitcnt vmcnt(14) lgkmcnt(0)
    s_barrier
    v_mfma_f32_16x16x32_bf16 v[32:35], a[104:107], a[52:55], v[32:35]
    ds_read_b64_tr_b16 a[88:89], v221 offset:0
    s_add_u32 s51, s45, 0x1ba400
    v_mfma_f32_16x16x32_bf16 v[36:39], a[108:111], a[52:55], v[36:39]
    ds_read_b64_tr_b16 a[90:91], v221 offset:2304
    s_add_u32 m0, s47, 59488
    v_mfma_f32_16x16x32_bf16 v[40:43], a[112:115], a[52:55], v[40:43]
    s_bitcmp1_b32 s44, 0
    s_cbranch_scc0 L_sk34
    buffer_load_dwordx4 v228, s[28:31], s51 offen lds
L_sk34:
    v_mfma_f32_16x16x32_bf16 v[44:47], a[116:119], a[52:55], v[44:47]
    ds_read_b128 a[0:3], v216 offset:0
    v_mfma_f32_16x16x32_bf16 v[48:51], a[104:107], a[56:59], v[48:51]
    s_add_u32 s62, s45, 1843200
    v_mfma_f32_16x16x32_bf16 v[52:55], a[108:111], a[56:59], v[52:55]
    ds_read_b64_tr_b16 a[92:93], v222 offset:0
    s_add_u32 m0, s50, 55392
    v_mfma_f32_16x16x32_bf16 v[56:59], a[112:115], a[56:59], v[56:59]
    buffer_load_dwordx4 v224, s[28:31], s62 offen offset:0 lds
    v_mfma_f32_16x16x32_bf16 v[60:63], a[116:119], a[56:59], v[60:63]
    ds_read_b64_tr_b16 a[94:95], v223 offset:0
    v_mfma_f32_16x16x32_bf16 v[64:67], a[104:107], a[60:63], v[64:67]
    ds_read_b64_tr_b16 a[96:97], v220 offset:192
    v_mfma_f32_16x16x32_bf16 v[68:71], a[108:111], a[60:63], v[68:71]
    v_mfma_f32_16x16x32_bf16 v[72:75], a[112:115], a[60:63], v[72:75]
    ds_read_b64_tr_b16 a[98:99], v220 offset:2496
    v_mfma_f32_16x16x32_bf16 v[76:79], a[116:119], a[60:63], v[76:79]
    buffer_load_dwordx4 v225, s[28:31], s62 offen offset:1024 lds
    v_mfma_f32_16x16x32_bf16 v[80:83], a[104:107], a[64:67], v[80:83]
    ds_read_b64_tr_b16 a[100:101], v220 offset:0
    v_mfma_f32_16x16x32_bf16 v[84:87], a[108:111], a[64:67], v[84:87]
    v_mfma_f32_16x16x32_bf16 v[88:91], a[112:115], a[64:67], v[88:91]
    ds_read_b64_tr_b16 a[102:103], v220 offset:2304
    v_mfma_f32_16x16x32_bf16 v[92:95], a[116:119], a[64:67], v[92:95]
    ds_read_b128 a[4:7], v216 offset:2048
    v_mfma_f32_16x16x32_bf16 v[96:99], a[104:107], a[68:71], v[96:99]
    buffer_load_dwordx4 v226, s[28:31], s62 offen offset:2048 lds
    v_mfma_f32_16x16x32_bf16 v[100:103], a[108:111], a[68:71], v[100:103]
    ds_read_b128 a[8:11], v216 offset:4096
    v_mfma_f32_16x16x32_bf16 v[104:107], a[112:115], a[68:71], v[104:107]
    v_mfma_f32_16x16x32_bf16 v[108:111], a[116:119], a[68:71], v[108:111]
    ds_read_b128 a[12:15], v216 offset:6144
    v_mfma_f32_16x16x32_bf16 v[112:115], a[104:107], a[72:75], v[112:115]
    buffer_load_dwordx4 v227, s[28:31], s62 offen offset:3072 lds
    v_mfma_f32_16x16x32_bf16 v[116:119], a[108:111], a[72:75], v[116:119]
    ds_read_b128 a[16:19], v216 offset:8192
    v_mfma_f32_16x16x32_bf16 v[120:123], a[112:115], a[72:75], v[120:123]
    ds_read_b128 a[20:23], v216 offset:10240
    v_mfma_f32_16x16x32_bf16 v[124:127], a[116:119], a[72:75], v[124:127]
    s_add_u32 s51, s46, 205824
    v_mfma_f32_16x16x32_bf16 v[128:131], a[104:107], a[76:79], v[128:131]
    ds_read_b128 a[24:27], v216 offset:12288
    s_add_u32 m0, s48, 65536
    v_mfma_f32_16x16x32_bf16 v[132:135], a[108:111], a[76:79], v[132:135]
    s_cmp_lt_u32 s44, 2
    s_cbranch_scc0 L_sk35
    buffer_load_dwordx4 v229, s[24:27], s51 offen lds
L_sk35:
    v_mfma_f32_16x16x32_bf16 v[136:139], a[112:115], a[76:79], v[136:139]
    ds_read_b128 a[28:31], v216 offset:14336
    v_mfma_f32_16x16x32_bf16 v[140:143], a[116:119], a[76:79], v[140:143]
    v_mfma_f32_16x16x32_bf16 v[144:147], a[104:107], a[80:83], v[144:147]
    ds_read_b128 a[32:35], v216 offset:16384
    s_add_u32 s51, s49, 1024
    v_mfma_f32_16x16x32_bf16 v[148:151], a[108:111], a[80:83], v[148:151]
    ds_read_b128 a[36:39], v216 offset:18432
    s_add_u32 m0, s48, 45056
    v_mfma_f32_16x16x32_bf16 v[152:155], a[112:115], a[80:83], v[152:155]
    buffer_load_dwordx4 v229, s[24:27], s51 offen lds
    v_mfma_f32_16x16x32_bf16 v[156:159], a[116:119], a[80:83], v[156:159]
    ds_read_b128 a[40:43], v216 offset:20480
    v_mfma_f32_16x16x32_bf16 v[160:163], a[104:107], a[84:87], v[160:163]
    s_add_u32 s51, s46, 41984
    v_mfma_f32_16x16x32_bf16 v[164:167], a[108:111], a[84:87], v[164:167]
    s_add_u32 m0, s48, 49152
    v_mfma_f32_16x16x32_bf16 v[168:171], a[112:115], a[84:87], v[168:171]
    buffer_load_dwordx4 v229, s[24:27], s51 offen lds
    v_mfma_f32_16x16x32_bf16 v[172:175], a[116:119], a[84:87], v[172:175]
    s_waitcnt lgkmcnt(6)
    v_mfma_f32_16x16x32_bf16 v[0:3], a[88:91], a[0:3], v[0:3]
    v_mfma_f32_16x16x32_bf16 v[4:7], a[92:95], a[0:3], v[4:7]
    v_mfma_f32_16x16x32_bf16 v[8:11], a[96:99], a[0:3], v[8:11]
    v_add_u32 v222, v182, v222
    v_mfma_f32_16x16x32_bf16 v[16:19], a[88:91], a[4:7], v[16:19]
    v_add_u32_e64 v223, v182, v223
    v_mfma_f32_16x16x32_bf16 v[20:23], a[92:95], a[4:7], v[20:23]
    v_mfma_f32_16x16x32_bf16 v[24:27], a[96:99], a[4:7], v[24:27]
    v_mfma_f32_16x16x32_bf16 v[28:31], a[100:103], a[4:7], v[28:31]
    s_waitcnt vmcnt(16) lgkmcnt(0)
    s_barrier
    v_mfma_f32_16x16x32_bf16 v[32:35], a[88:91], a[8:11], v[32:35]
    ds_read_b64_tr_b16 a[104:105], v221 offset:18464
    s_add_u32 s51, s45, 0x1d8400
    v_mfma_f32_16x16x32_bf16 v[36:39], a[92:95], a[8:11], v[36:39]
    ds_read_b64_tr_b16 a[106:107], v221 offset:20768
    s_add_u32 m0, s47, 4096
    v_mfma_f32_16x16x32_bf16 v[40:43], a[96:99], a[8:11], v[40:43]
    s_bitcmp1_b32 s44, 0
    s_cbranch_scc0 L_sk36
    buffer_load_dwordx4 v228, s[28:31], s51 offen lds
L_sk36:
    v_mfma_f32_16x16x32_bf16 v[44:47], a[100:103], a[8:11], v[44:47]
    ds_read_b128 a[44:47], v217 offset:0
    v_mfma_f32_16x16x32_bf16 v[48:51], a[88:91], a[12:15], v[48:51]
    s_add_u32 s62, s45, 1966080
    v_mfma_f32_16x16x32_bf16 v[52:55], a[92:95], a[12:15], v[52:55]
    ds_read_b64_tr_b16 a[108:109], v222 offset:0
    s_add_u32 m0, s50, 0
    v_mfma_f32_16x16x32_bf16 v[56:59], a[96:99], a[12:15], v[56:59]
    buffer_load_dwordx4 v224, s[28:31], s62 offen offset:0 lds
    v_mfma_f32_16x16x32_bf16 v[60:63], a[100:103], a[12:15], v[60:63]
    ds_read_b64_tr_b16 a[110:111], v223 offset:0
    v_mfma_f32_16x16x32_bf16 v[64:67], a[88:91], a[16:19], v[64:67]
    ds_read_b64_tr_b16 a[112:113], v220 offset:18656
    v_mfma_f32_16x16x32_bf16 v[68:71], a[92:95], a[16:19], v[68:71]
    v_mfma_f32_16x16x32_bf16 v[72:75], a[96:99], a[16:19], v[72:75]
    ds_read_b64_tr_b16 a[114:115], v220 offset:20960
    v_mfma_f32_16x16x32_bf16 v[76:79], a[100:103], a[16:19], v[76:79]
    buffer_load_dwordx4 v225, s[28:31], s62 offen offset:1024 lds
    v_mfma_f32_16x16x32_bf16 v[80:83], a[88:91], a[20:23], v[80:83]
    ds_read_b64_tr_b16 a[116:117], v220 offset:18464
    v_mfma_f32_16x16x32_bf16 v[84:87], a[92:95], a[20:23], v[84:87]
    v_mfma_f32_16x16x32_bf16 v[88:91], a[96:99], a[20:23], v[88:91]
    ds_read_b64_tr_b16 a[118:119], v220 offset:20768
    v_mfma_f32_16x16x32_bf16 v[92:95], a[100:103], a[20:23], v[92:95]
    ds_read_b128 a[48:51], v217 offset:2048
    v_mfma_f32_16x16x32_bf16 v[96:99], a[88:91], a[24:27], v[96:99]
    buffer_load_dwordx4 v226, s[28:31], s62 offen offset:2048 lds
    v_mfma_f32_16x16x32_bf16 v[100:103], a[92:95], a[24:27], v[100:103]
    ds_read_b128 a[52:55], v217 offset:4096
    v_mfma_f32_16x16x32_bf16 v[104:107], a[96:99], a[24:27], v[104:107]
    v_mfma_f32_16x16x32_bf16 v[108:111], a[100:103], a[24:27], v[108:111]
    ds_read_b128 a[56:59], v217 offset:6144
    v_mfma_f32_16x16x32_bf16 v[112:115], a[88:91], a[28:31], v[112:115]
    buffer_load_dwordx4 v227, s[28:31], s62 offen offset:3072 lds
    v_mfma_f32_16x16x32_bf16 v[116:119], a[92:95], a[28:31], v[116:119]
    ds_read_b128 a[60:63], v217 offset:8192
    v_mfma_f32_16x16x32_bf16 v[120:123], a[96:99], a[28:31], v[120:123]
    ds_read_b128 a[64:67], v217 offset:10240
    v_mfma_f32_16x16x32_bf16 v[124:127], a[100:103], a[28:31], v[124:127]
    s_add_u32 s51, s46, 82944
    v_mfma_f32_16x16x32_bf16 v[128:131], a[88:91], a[32:35], v[128:131]
    ds_read_b128 a[68:71], v217 offset:12288
    s_add_u32 m0, s48, 53248
    v_mfma_f32_16x16x32_bf16 v[132:135], a[92:95], a[32:35], v[132:135]
    buffer_load_dwordx4 v229, s[24:27], s51 offen lds
    v_mfma_f32_16x16x32_bf16 v[136:139], a[96:99], a[32:35], v[136:139]
    ds_read_b128 a[72:75], v217 offset:14336
    v_mfma_f32_16x16x32_bf16 v[140:143], a[100:103], a[32:35], v[140:143]
    v_mfma_f32_16x16x32_bf16 v[144:147], a[88:91], a[36:39], v[144:147]
    ds_read_b128 a[76:79], v217 offset:16384
    s_add_u32 s51, s46, 123904
    v_mfma_f32_16x16x32_bf16 v[148:151], a[92:95], a[36:39], v[148:151]
    ds_read_b128 a[80:83], v217 offset:18432
    s_add_u32 m0, s48, 57344
    v_mfma_f32_16x16x32_bf16 v[152:155], a[96:99], a[36:39], v[152:155]
    buffer_load_dwordx4 v229, s[24:27], s51 offen lds
    v_mfma_f32_16x16x32_bf16 v[156:159], a[100:103], a[36:39], v[156:159]
    ds_read_b128 a[84:87], v217 offset:20480
    v_mfma_f32_16x16x32_bf16 v[160:163], a[88:91], a[40:43], v[160:163]
    s_add_u32 s51, s46, 164864
    v_mfma_f32_16x16x32_bf16 v[164:167], a[92:95], a[40:43], v[164:167]
    s_add_u32 m0, s48, 61440
    v_mfma_f32_16x16x32_bf16 v[168:171], a[96:99], a[40:43], v[168:171]
    buffer_load_dwordx4 v229, s[24:27], s51 offen lds
    v_mfma_f32_16x16x32_bf16 v[172:175], a[100:103], a[40:43], v[172:175]
    s_waitcnt lgkmcnt(6)
    v_mfma_f32_16x16x32_bf16 v[0:3], a[104:107], a[44:47], v[0:3]
    s_waitcnt vmcnt(13)
    v_cmp_le_u32_e64 vcc, 20, v243
    s_nop 0
    s_andn2_b32 s84, 0x2, vcc_lo
    s_cbranch_scc1 L_retry37
L_ok37:
    v_mfma_f32_16x16x32_bf16 v[4:7], a[108:111], a[44:47], v[4:7]
    s_add_u32 s63, s10, 0
    buffer_load_dwordx4 a[120:123], v239, s[40:43], s63 offen offset:0 sc1
    v_mfma_f32_16x16x32_bf16 v[8:11], a[112:115], a[44:47], v[8:11]
    v_add_u32 v222, v182, v222
    v_mfma_f32_16x16x32_bf16 v[16:19], a[104:107], a[48:51], v[16:19]
    v_add_u32_e64 v223, v182, v223
    v_mfma_f32_16x16x32_bf16 v[20:23], a[108:111], a[48:51], v[20:23]
    v_mfma_f32_16x16x32_bf16 v[24:27], a[112:115], a[48:51], v[24:27]
    v_mfma_f32_16x16x32_bf16 v[28:31], a[116:119], a[48:51], v[28:31]
    s_waitcnt lgkmcnt(0)
    s_barrier
    v_mfma_f32_16x16x32_bf16 v[32:35], a[104:107], a[52:55], v[32:35]
    ds_read_b64_tr_b16 a[88:89], v221 offset:36928
    s_add_u32 s51, s45, 0x1f6400
    v_mfma_f32_16x16x32_bf16 v[36:39], a[108:111], a[52:55], v[36:39]
    ds_read_b64_tr_b16 a[90:91], v221 offset:39232
    s_add_u32 m0, s47, 22560
    v_mfma_f32_16x16x32_bf16 v[40:43], a[112:115], a[52:55], v[40:43]
    s_bitcmp1_b32 s44, 0
    s_cbranch_scc0 L_sk38
    buffer_load_dwordx4 v228, s[28:31], s51 offen lds
L_sk38:
    v_mfma_f32_16x16x32_bf16 v[44:47], a[116:119], a[52:55], v[44:47]
    ds_read_b128 a[0:3], v216 offset:22528
    v_mfma_f32_16x16x32_bf16 v[48:51], a[104:107], a[56:59], v[48:51]
    s_add_u32 s62, s45, 2088960
    v_mfma_f32_16x16x32_bf16 v[52:55], a[108:111], a[56:59], v[52:55]
    ds_read_b64_tr_b16 a[92:93], v222 offset:0
    s_add_u32 m0, s50, 18464
    v_mfma_f32_16x16x32_bf16 v[56:59], a[112:115], a[56:59], v[56:59]
    buffer_load_dwordx4 v224, s[28:31], s62 offen offset:0 lds
    v_mfma_f32_16x16x32_bf16 v[60:63], a[116:119], a[56:59], v[60:63]
    ds_read_b64_tr_b16 a[94:95], v223 offset:0
    v_mfma_f32_16x16x32_bf16 v[64:67], a[104:107], a[60:63], v[64:67]
    ds_read_b64_tr_b16 a[96:97], v220 offset:37120
    v_mfma_f32_16x16x32_bf16 v[68:71], a[108:111], a[60:63], v[68:71]
    buffer_load_dwordx4 a[124:127], v239, s[40:43], s63 offen offset:1024 sc1
    v_mfma_f32_16x16x32_bf16 v[72:75], a[112:115], a[60:63], v[72:75]
    ds_read_b64_tr_b16 a[98:99], v220 offset:39424
    v_mfma_f32_16x16x32_bf16 v[76:79], a[116:119], a[60:63], v[76:79]
    buffer_load_dwordx4 v225, s[28:31], s62 offen offset:1024 lds
    v_mfma_f32_16x16x32_bf16 v[80:83], a[104:107], a[64:67], v[80:83]
    ds_read_b64_tr_b16 a[100:101], v220 offset:36928
    v_mfma_f32_16x16x32_bf16 v[84:87], a[108:111], a[64:67], v[84:87]
    v_mfma_f32_16x16x32_bf16 v[88:91], a[112:115], a[64:67], v[88:91]
    ds_read_b64_tr_b16 a[102:103], v220 offset:39232
    v_mfma_f32_16x16x32_bf16 v[92:95], a[116:119], a[64:67], v[92:95]
    ds_read_b128 a[4:7], v216 offset:24576
    v_mfma_f32_16x16x32_bf16 v[96:99], a[104:107], a[68:71], v[96:99]
    buffer_load_dwordx4 v226, s[28:31], s62 offen offset:2048 lds
    v_mfma_f32_16x16x32_bf16 v[100:103], a[108:111], a[68:71], v[100:103]
    ds_read_b128 a[8:11], v216 offset:26624
    v_mfma_f32_16x16x32_bf16 v[104:107], a[112:115], a[68:71], v[104:107]
    buffer_load_dwordx4 a[128:131], v239, s[40:43], s63 offen offset:2048 sc1
    v_mfma_f32_16x16x32_bf16 v[108:111], a[116:119], a[68:71], v[108:111]
    ds_read_b128 a[12:15], v216 offset:28672
    v_mfma_f32_16x16x32_bf16 v[112:115], a[104:107], a[72:75], v[112:115]
    buffer_load_dwordx4 v227, s[28:31], s62 offen offset:3072 lds
    v_mfma_f32_16x16x32_bf16 v[116:119], a[108:111], a[72:75], v[116:119]
    ds_read_b128 a[16:19], v216 offset:30720
    v_mfma_f32_16x16x32_bf16 v[120:123], a[112:115], a[72:75], v[120:123]
    ds_read_b128 a[20:23], v216 offset:32768
    v_mfma_f32_16x16x32_bf16 v[124:127], a[116:119], a[72:75], v[124:127]
    s_add_u32 s51, s46, 205952
    v_mfma_f32_16x16x32_bf16 v[128:131], a[104:107], a[76:79], v[128:131]
    ds_read_b128 a[24:27], v216 offset:34816
    s_add_u32 m0, s48, 20480
    v_mfma_f32_16x16x32_bf16 v[132:135], a[108:111], a[76:79], v[132:135]
    s_cmp_lt_u32 s44, 2
    s_cbranch_scc0 L_sk39
    buffer_load_dwordx4 v229, s[24:27], s51 offen lds
L_sk39:
    v_mfma_f32_16x16x32_bf16 v[136:139], a[112:115], a[76:79], v[136:139]
    ds_read_b128 a[28:31], v216 offset:36864
    v_mfma_f32_16x16x32_bf16 v[140:143], a[116:119], a[76:79], v[140:143]
    buffer_load_dwordx4 a[132:135], v239, s[40:43], s63 offen offset:3072 sc1
    v_mfma_f32_16x16x32_bf16 v[144:147], a[104:107], a[80:83], v[144:147]
    ds_read_b128 a[32:35], v216 offset:38912
    s_add_u32 s51, s49, 1152
    v_mfma_f32_16x16x32_bf16 v[148:151], a[108:111], a[80:83], v[148:151]
    ds_read_b128 a[36:39], v216 offset:40960
    s_add_u32 m0, s48, 0
    v_mfma_f32_16x16x32_bf16 v[152:155], a[112:115], a[80:83], v[152:155]
    buffer_load_dwordx4 v229, s[24:27], s51 offen lds
    v_mfma_f32_16x16x32_bf16 v[156:159], a[116:119], a[80:83], v[156:159]
    ds_read_b128 a[40:43], v216 offset:43008
    v_mfma_f32_16x16x32_bf16 v[160:163], a[104:107], a[84:87], v[160:163]
    s_add_u32 s51, s46, 42112
    v_mfma_f32_16x16x32_bf16 v[164:167], a[108:111], a[84:87], v[164:167]
    s_add_u32 m0, s48, 4096
    v_mfma_f32_16x16x32_bf16 v[168:171], a[112:115], a[84:87], v[168:171]
    buffer_load_dwordx4 v229, s[24:27], s51 offen lds
    v_mfma_f32_16x16x32_bf16 v[172:175], a[116:119], a[84:87], v[172:175]
    s_waitcnt lgkmcnt(6)
    v_mfma_f32_16x16x32_bf16 v[0:3], a[88:91], a[0:3], v[0:3]
    s_add_u32 s63, s10, 4096
    buffer_load_dwordx4 a[136:139], v239, s[40:43], s63 offen offset:0 sc1
    v_mfma_f32_16x16x32_bf16 v[4:7], a[92:95], a[0:3], v[4:7]
    v_mfma_f32_16x16x32_bf16 v[8:11], a[96:99], a[0:3], v[8:11]
    v_add_u32_e64 v222, v182, v222
    v_mfma_f32_16x16x32_bf16 v[16:19], a[88:91], a[4:7], v[16:19]
    v_add_u32_e64 v223, v182, v223
    v_mfma_f32_16x16x32_bf16 v[20:23], a[92:95], a[4:7], v[20:23]
    v_mfma_f32_16x16x32_bf16 v[24:27], a[96:99], a[4:7], v[24:27]
    v_mfma_f32_16x16x32_bf16 v[28:31], a[100:103], a[4:7], v[28:31]
    s_waitcnt vmcnt(20) lgkmcnt(0)
    s_barrier
    v_mfma_f32_16x16x32_bf16 v[32:35], a[88:91], a[8:11], v[32:35]
    ds_read_b64_tr_b16 a[104:105], v221 offset:55392
    s_add_u32 s51, s45, 0x214400
    v_mfma_f32_16x16x32_bf16 v[36:39], a[92:95], a[8:11], v[36:39]
    ds_read_b64_tr_b16 a[106:107], v221 offset:57696
    s_add_u32 m0, s47, 41024
    v_mfma_f32_16x16x32_bf16 v[40:43], a[96:99], a[8:11], v[40:43]
    s_bitcmp1_b32 s44, 0
    s_cbranch_scc0 L_sk40
    buffer_load_dwordx4 v228, s[28:31], s51 offen lds
L_sk40:
    v_mfma_f32_16x16x32_bf16 v[44:47], a[100:103], a[8:11], v[44:47]
    ds_read_b128 a[44:47], v217 offset:22528
    v_mfma_f32_16x16x32_bf16 v[48:51], a[88:91], a[12:15], v[48:51]
    s_add_u32 s62, s45, 2211840
    v_mfma_f32_16x16x32_bf16 v[52:55], a[92:95], a[12:15], v[52:55]
    ds_read_b64_tr_b16 a[108:109], v222 offset:0
    s_add_u32 m0, s50, 36928
    v_mfma_f32_16x16x32_bf16 v[56:59], a[96:99], a[12:15], v[56:59]
    buffer_load_dwordx4 v224, s[28:31], s62 offen offset:0 lds
    v_mfma_f32_16x16x32_bf16 v[60:63], a[100:103], a[12:15], v[60:63]
    ds_read_b64_tr_b16 a[110:111], v223 offset:0
    v_mfma_f32_16x16x32_bf16 v[64:67], a[88:91], a[16:19], v[64:67]
    ds_read_b64_tr_b16 a[112:113], v220 offset:55584
    v_mfma_f32_16x16x32_bf16 v[68:71], a[92:95], a[16:19], v[68:71]
    buffer_load_dwordx4 a[140:143], v239, s[40:43], s63 offen offset:1024 sc1
    v_mfma_f32_16x16x32_bf16 v[72:75], a[96:99], a[16:19], v[72:75]
    ds_read_b64_tr_b16 a[114:115], v220 offset:57888
    v_mfma_f32_16x16x32_bf16 v[76:79], a[100:103], a[16:19], v[76:79]
    buffer_load_dwordx4 v225, s[28:31], s62 offen offset:1024 lds
    v_mfma_f32_16x16x32_bf16 v[80:83], a[88:91], a[20:23], v[80:83]
    ds_read_b64_tr_b16 a[116:117], v220 offset:55392
    v_mfma_f32_16x16x32_bf16 v[84:87], a[92:95], a[20:23], v[84:87]
    v_mfma_f32_16x16x32_bf16 v[88:91], a[96:99], a[20:23], v[88:91]
    ds_read_b64_tr_b16 a[118:119], v220 offset:57696
    v_mfma_f32_16x16x32_bf16 v[92:95], a[100:103], a[20:23], v[92:95]
    ds_read_b128 a[48:51], v217 offset:24576
    v_mfma_f32_16x16x32_bf16 v[96:99], a[88:91], a[24:27], v[96:99]
    buffer_load_dwordx4 v226, s[28:31], s62 offen offset:2048 lds
    v_mfma_f32_16x16x32_bf16 v[100:103], a[92:95], a[24:27], v[100:103]
    ds_read_b128 a[52:55], v217 offset:26624
    v_mfma_f32_16x16x32_bf16 v[104:107], a[96:99], a[24:27], v[104:107]
    buffer_load_dwordx4 a[144:147], v239, s[40:43], s63 offen offset:2048 sc1
    v_mfma_f32_16x16x32_bf16 v[108:111], a[100:103], a[24:27], v[108:111]
    ds_read_b128 a[56:59], v217 offset:28672
    v_mfma_f32_16x16x32_bf16 v[112:115], a[88:91], a[28:31], v[112:115]
    buffer_load_dwordx4 v227, s[28:31], s62 offen offset:3072 lds
    v_mfma_f32_16x16x32_bf16 v[116:119], a[92:95], a[28:31], v[116:119]
    ds_read_b128 a[60:63], v217 offset:30720
    v_mfma_f32_16x16x32_bf16 v[120:123], a[96:99], a[28:31], v[120:123]
    ds_read_b128 a[64:67], v217 offset:32768
    v_mfma_f32_16x16x32_bf16 v[124:127], a[100:103], a[28:31], v[124:127]
    s_add_u32 s51, s46, 83072
    v_mfma_f32_16x16x32_bf16 v[128:131], a[88:91], a[32:35], v[128:131]
    ds_read_b128 a[68:71], v217 offset:34816
    s_add_u32 m0, s48, 8192
    v_mfma_f32_16x16x32_bf16 v[132:135], a[92:95], a[32:35], v[132:135]
    buffer_load_dwordx4 v229, s[24:27], s51 offen lds
    v_mfma_f32_16x16x32_bf16 v[136:139], a[96:99], a[32:35], v[136:139]
    ds_read_b128 a[72:75], v217 offset:36864
    v_mfma_f32_16x16x32_bf16 v[140:143], a[100:103], a[32:35], v[140:143]
    buffer_load_dwordx4 a[148:151], v239, s[40:43], s63 offen offset:3072 sc1
    v_mfma_f32_16x16x32_bf16 v[144:147], a[88:91], a[36:39], v[144:147]
    ds_read_b128 a[76:79], v217 offset:38912
    s_add_u32 s51, s46, 124032
    v_mfma_f32_16x16x32_bf16 v[148:151], a[92:95], a[36:39], v[148:151]
    ds_read_b128 a[80:83], v217 offset:40960
    s_add_u32 m0, s48, 12288
    v_mfma_f32_16x16x32_bf16 v[152:155], a[96:99], a[36:39], v[152:155]
    buffer_load_dwordx4 v229, s[24:27], s51 offen lds
    v_mfma_f32_16x16x32_bf16 v[156:159], a[100:103], a[36:39], v[156:159]
    ds_read_b128 a[84:87], v217 offset:43008
    v_mfma_f32_16x16x32_bf16 v[160:163], a[88:91], a[40:43], v[160:163]
    s_add_u32 s51, s46, 164992
    v_mfma_f32_16x16x32_bf16 v[164:167], a[92:95], a[40:43], v[164:167]
    s_add_u32 m0, s48, 16384
    v_mfma_f32_16x16x32_bf16 v[168:171], a[96:99], a[40:43], v[168:171]
    buffer_load_dwordx4 v229, s[24:27], s51 offen lds
    v_mfma_f32_16x16x32_bf16 v[172:175], a[100:103], a[40:43], v[172:175]
    s_waitcnt lgkmcnt(6)
    v_mfma_f32_16x16x32_bf16 v[0:3], a[104:107], a[44:47], v[0:3]
    s_add_u32 s63, s10, 8192
    buffer_load_dwordx4 a[152:155], v239, s[40:43], s63 offen offset:0 sc1
    v_mfma_f32_16x16x32_bf16 v[4:7], a[108:111], a[44:47], v[4:7]
    v_mfma_f32_16x16x32_bf16 v[8:11], a[112:115], a[44:47], v[8:11]
    v_add_u32 v222, v183, v222
    v_mfma_f32_16x16x32_bf16 v[16:19], a[104:107], a[48:51], v[16:19]
    v_add_u32_e64 v223, v183, v223
    v_mfma_f32_16x16x32_bf16 v[20:23], a[108:111], a[48:51], v[20:23]
    v_mfma_f32_16x16x32_bf16 v[24:27], a[112:115], a[48:51], v[24:27]
    v_mfma_f32_16x16x32_bf16 v[28:31], a[116:119], a[48:51], v[28:31]
    s_waitcnt vmcnt(22) lgkmcnt(0)
    s_barrier
    v_mfma_f32_16x16x32_bf16 v[32:35], a[104:107], a[52:55], v[32:35]
    ds_read_b64_tr_b16 a[88:89], v221 offset:0
    s_add_u32 s51, s45, 0x232400
    v_mfma_f32_16x16x32_bf16 v[36:39], a[108:111], a[52:55], v[36:39]
    ds_read_b64_tr_b16 a[90:91], v221 offset:2304
    s_add_u32 m0, s47, 59488
    v_mfma_f32_16x16x32_bf16 v[40:43], a[112:115], a[52:55], v[40:43]
    s_bitcmp1_b32 s44, 0
    s_cbranch_scc0 L_sk41
    buffer_load_dwordx4 v228, s[28:31], s51 offen lds
L_sk41:
    v_mfma_f32_16x16x32_bf16 v[44:47], a[116:119], a[52:55], v[44:47]
    ds_read_b128 a[0:3], v218 offset:0
    v_mfma_f32_16x16x32_bf16 v[48:51], a[104:107], a[56:59], v[48:51]
    s_add_u32 s62, s45, 2334720
    v_mfma_f32_16x16x32_bf16 v[52:55], a[108:111], a[56:59], v[52:55]
    ds_read_b64_tr_b16 a[92:93], v222 offset:0
    s_add_u32 m0, s50, 55392
    v_mfma_f32_16x16x32_bf16 v[56:59], a[112:115], a[56:59], v[56:59]
    buffer_load_dwordx4 v224, s[28:31], s62 offen offset:0 lds
    v_mfma_f32_16x16x32_bf16 v[60:63], a[116:119], a[56:59], v[60:63]
    ds_read_b64_tr_b16 a[94:95], v223 offset:0
    v_mfma_f32_16x16x32_bf16 v[64:67], a[104:107], a[60:63], v[64:67]
    ds_read_b64_tr_b16 a[96:97], v220 offset:192
    v_mfma_f32_16x16x32_bf16 v[68:71], a[108:111], a[60:63], v[68:71]
    buffer_load_dwordx4 a[156:159], v239, s[40:43], s63 offen offset:1024 sc1
    v_mfma_f32_16x16x32_bf16 v[72:75], a[112:115], a[60:63], v[72:75]
    ds_read_b64_tr_b16 a[98:99], v220 offset:2496
    v_mfma_f32_16x16x32_bf16 v[76:79], a[116:119], a[60:63], v[76:79]
    buffer_load_dwordx4 v225, s[28:31], s62 offen offset:1024 lds
    v_mfma_f32_16x16x32_bf16 v[80:83], a[104:107], a[64:67], v[80:83]
    ds_read_b64_tr_b16 a[100:101], v220 offset:0
    v_mfma_f32_16x16x32_bf16 v[84:87], a[108:111], a[64:67], v[84:87]
    v_mfma_f32_16x16x32_bf16 v[88:91], a[112:115], a[64:67], v[88:91]
    ds_read_b64_tr_b16 a[102:103], v220 offset:2304
    v_mfma_f32_16x16x32_bf16 v[92:95], a[116:119], a[64:67], v[92:95]
    ds_read_b128 a[4:7], v218 offset:2048
    v_mfma_f32_16x16x32_bf16 v[96:99], a[104:107], a[68:71], v[96:99]
    buffer_load_dwordx4 v226, s[28:31], s62 offen offset:2048 lds
    v_mfma_f32_16x16x32_bf16 v[100:103], a[108:111], a[68:71], v[100:103]
    ds_read_b128 a[8:11], v218 offset:4096
    v_mfma_f32_16x16x32_bf16 v[104:107], a[112:115], a[68:71], v[104:107]
    buffer_load_dwordx4 a[160:163], v239, s[40:43], s63 offen offset:2048 sc1
    v_mfma_f32_16x16x32_bf16 v[108:111], a[116:119], a[68:71], v[108:111]
    ds_read_b128 a[12:15], v218 offset:6144
    v_mfma_f32_16x16x32_bf16 v[112:115], a[104:107], a[72:75], v[112:115]
    buffer_load_dwordx4 v227, s[28:31], s62 offen offset:3072 lds
    v_mfma_f32_16x16x32_bf16 v[116:119], a[108:111], a[72:75], v[116:119]
    ds_read_b128 a[16:19], v218 offset:8192
    v_mfma_f32_16x16x32_bf16 v[120:123], a[112:115], a[72:75], v[120:123]
    ds_read_b128 a[20:23], v218 offset:10240
    v_mfma_f32_16x16x32_bf16 v[124:127], a[116:119], a[72:75], v[124:127]
    v_mfma_f32_16x16x32_bf16 v[128:131], a[104:107], a[76:79], v[128:131]
    ds_read_b128 a[24:27], v218 offset:12288
    v_mfma_f32_16x16x32_bf16 v[132:135], a[108:111], a[76:79], v[132:135]
    s_mov_b32 s24, 0xaaaaaaaa
    s_mov_b32 s25, 0xaaaaaaaa
    s_mov_b32 s26, 0xf0000
    v_mfma_f32_16x16x32_bf16 v[136:139], a[112:115], a[76:79], v[136:139]
    ds_read_b128 a[28:31], v218 offset:14336
    s_mov_b32 s27, 0xfff00ff
    v_mfma_f32_16x16x32_bf16 v[140:143], a[116:119], a[76:79], v[140:143]
    buffer_load_dwordx4 a[164:167], v239, s[40:43], s63 offen offset:3072 sc1
    v_mfma_f32_16x16x32_bf16 v[144:147], a[104:107], a[80:83], v[144:147]
    ds_read_b128 a[32:35], v218 offset:16384
    s_mov_b32 s28, 0x3f0003
    v_mfma_f32_16x16x32_bf16 v[148:151], a[108:111], a[80:83], v[148:151]
    ds_read_b128 a[36:39], v218 offset:18432
    s_mov_b32 s29, 0x3fff03ff
    v_mfma_f32_16x16x32_bf16 v[152:155], a[112:115], a[80:83], v[152:155]
    s_mov_b32 s30, 0xffff
    s_mov_b32 s31, 0x0
    v_mfma_f32_16x16x32_bf16 v[156:159], a[116:119], a[80:83], v[156:159]
    ds_read_b128 a[40:43], v218 offset:20480
    v_mfma_f32_16x16x32_bf16 v[160:163], a[104:107], a[84:87], v[160:163]
    s_cmp_eq_u32 s81, 0
    s_cselect_b64 s[36:37], s[26:27], 0
    s_cselect_b64 s[38:39], s[28:29], 0
    v_mfma_f32_16x16x32_bf16 v[164:167], a[108:111], a[84:87], v[164:167]
    v_mov_b32 v228, 0x0c0c0c0c
    v_mov_b32 v254, 0xc0c0100
    v_mfma_f32_16x16x32_bf16 v[168:171], a[112:115], a[84:87], v[168:171]
    v_mov_b32 v253, 0x1000c0c
    v_cndmask_b32 v254, v254, v253, s[24:25]
    v_mfma_f32_16x16x32_bf16 v[172:175], a[116:119], a[84:87], v[172:175]
    s_waitcnt lgkmcnt(6)
    v_cndmask_b32 v224, v228, v254, s[26:27]
    v_cndmask_b32 v226, v254, v228, s[26:27]
    v_mfma_f32_16x16x32_bf16 v[0:3], a[88:91], a[0:3], v[0:3]
    s_add_u32 s63, s10, 12288
    buffer_load_dwordx4 a[168:171], v239, s[40:43], s63 offen offset:0 sc1
    v_mfma_f32_16x16x32_bf16 v[4:7], a[92:95], a[0:3], v[4:7]
    buffer_load_dword v243, v242, s[72:75], 0 offen sc1
    v_mfma_f32_16x16x32_bf16 v[8:11], a[96:99], a[0:3], v[8:11]
    v_add_u32 v222, v182, v222
    v_mov_b32 v254, 0xc0c0302
    v_mfma_f32_16x16x32_bf16 v[16:19], a[88:91], a[4:7], v[16:19]
    v_add_u32_e64 v223, v182, v223
    v_mov_b32 v253, 0x3020c0c
    v_mfma_f32_16x16x32_bf16 v[20:23], a[92:95], a[4:7], v[20:23]
    v_cndmask_b32 v254, v254, v253, s[24:25]
    v_cndmask_b32 v225, v228, v254, s[28:29]
    v_mfma_f32_16x16x32_bf16 v[24:27], a[96:99], a[4:7], v[24:27]
    buffer_load_dwordx4 a[172:175], v239, s[40:43], s63 offen offset:1024 sc1
    v_mfma_f32_16x16x32_bf16 v[28:31], a[100:103], a[4:7], v[28:31]
    s_waitcnt vmcnt(25) lgkmcnt(0)
    s_barrier
    v_cndmask_b32 v227, v254, v228, s[28:29]
    v_mfma_f32_16x16x32_bf16 v[32:35], a[88:91], a[8:11], v[32:35]
    ds_read_b64_tr_b16 a[104:105], v221 offset:18464
    v_mov_b32 v228, 0xf149f2ca
    v_mfma_f32_16x16x32_bf16 v[36:39], a[92:95], a[8:11], v[36:39]
    ds_read_b64_tr_b16 a[106:107], v221 offset:20768
    s_mul_i32 s52, s44, 11264
    v_mfma_f32_16x16x32_bf16 v[40:43], a[96:99], a[8:11], v[40:43]
    v_and_b32 v254, 15, v255
    v_lshlrev_b32 v254, 6, v254
    v_mfma_f32_16x16x32_bf16 v[44:47], a[100:103], a[8:11], v[44:47]
    ds_read_b128 a[44:47], v219 offset:0
    v_lshrrev_b32_e64 v253, 4, v255
    v_mfma_f32_16x16x32_bf16 v[48:51], a[88:91], a[12:15], v[48:51]
    buffer_load_dwordx4 a[176:179], v239, s[40:43], s63 offen offset:2048 sc1
    v_mfma_f32_16x16x32_bf16 v[52:55], a[92:95], a[12:15], v[52:55]
    ds_read_b64_tr_b16 a[108:109], v222 offset:0
    v_lshlrev_b32_e64 v253, 4, v253
    v_mfma_f32_16x16x32_bf16 v[56:59], a[96:99], a[12:15], v[56:59]
    v_add3_u32 v229, v254, v253, s52
    v_lshrrev_b32_e64 v254, 2, v255
    v_mfma_f32_16x16x32_bf16 v[60:63], a[100:103], a[12:15], v[60:63]
    ds_read_b64_tr_b16 a[110:111], v223 offset:0
    v_lshlrev_b32_e64 v254, 6, v254
    v_mfma_f32_16x16x32_bf16 v[64:67], a[88:91], a[16:19], v[64:67]
    ds_read_b64_tr_b16 a[112:113], v220 offset:18656
    v_add_u32_e64 v254, s52, v254
    v_mfma_f32_16x16x32_bf16 v[68:71], a[92:95], a[16:19], v[68:71]
    buffer_load_dwordx4 a[180:183], v239, s[40:43], s63 offen offset:3072 sc1
    v_mfma_f32_16x16x32_bf16 v[72:75], a[96:99], a[16:19], v[72:75]
    ds_read_b64_tr_b16 a[114:115], v220 offset:20960
    v_add_u32_e64 v232, 40, v254
    v_mfma_f32_16x16x32_bf16 v[76:79], a[100:103], a[16:19], v[76:79]
    v_and_b32_e64 v253, 3, v255
    v_cmp_eq_u32 s[8:9], 0, v253
    v_mfma_f32_16x16x32_bf16 v[80:83], a[88:91], a[20:23], v[80:83]
    ds_read_b64_tr_b16 a[116:117], v220 offset:18464
    v_lshlrev_b32_e64 v253, 4, v253
    v_mfma_f32_16x16x32_bf16 v[84:87], a[92:95], a[20:23], v[84:87]
    s_nop 0
    v_cndmask_b32 v253, v253, 24, s[8:9]
    v_add_u32 v231, v254, v253
    v_mfma_f32_16x16x32_bf16 v[88:91], a[96:99], a[20:23], v[88:91]
    ds_read_b64_tr_b16 a[118:119], v220 offset:20768
    v_lshrrev_b32_e64 v254, 5, v255
    v_mfma_f32_16x16x32_bf16 v[92:95], a[100:103], a[20:23], v[92:95]
    ds_read_b128 a[48:51], v219 offset:2048
    v_mul_u32_u24 v254, 69632, v254
    v_mfma_f32_16x16x32_bf16 v[96:99], a[88:91], a[24:27], v[96:99]
    s_add_u32 s63, s10, 16384
    buffer_load_dwordx4 a[184:187], v239, s[40:43], s63 offen offset:0 sc1
    v_mfma_f32_16x16x32_bf16 v[100:103], a[92:95], a[24:27], v[100:103]
    ds_read_b128 a[52:55], v219 offset:4096
    v_and_b32_e64 v253, 31, v255
    v_mfma_f32_16x16x32_bf16 v[104:107], a[96:99], a[24:27], v[104:107]
    v_lshl_add_u32 v233, v253, 4, v254
    v_lshlrev_b32_e64 v234, 3, v255
    v_mfma_f32_16x16x32_bf16 v[108:111], a[100:103], a[24:27], v[108:111]
    ds_read_b128 a[56:59], v219 offset:6144
    v_mov_b32_e64 v253, 0x40000000
    v_mfma_f32_16x16x32_bf16 v[112:115], a[88:91], a[28:31], v[112:115]
    v_cndmask_b32 v234, v253, v234, s[30:31]
    s_mul_i32 s59, s81, 696320
    s_lshl_b32 s52, s80, 11
    v_mfma_f32_16x16x32_bf16 v[116:119], a[92:95], a[28:31], v[116:119]
    ds_read_b128 a[60:63], v219 offset:8192
    s_lshl_b32 s61, s44, 9
    v_mfma_f32_16x16x32_bf16 v[120:123], a[96:99], a[28:31], v[120:123]
    ds_read_b128 a[64:67], v219 offset:10240
    s_add_u32 s16, s59, s52
    v_mfma_f32_16x16x32_bf16 v[124:127], a[100:103], a[28:31], v[124:127]
    buffer_load_dwordx4 a[188:191], v239, s[40:43], s63 offen offset:1024 sc1
    v_mfma_f32_16x16x32_bf16 v[128:131], a[88:91], a[32:35], v[128:131]
    ds_read_b128 a[68:71], v219 offset:12288
    s_add_u32 s16, s16, s61
    v_mfma_f32_16x16x32_bf16 v[132:135], a[92:95], a[32:35], v[132:135]
    s_lshl_b32 s52, s80, 2
    s_add_u32 s52, s52, s44
    s_lshl_b32 s52, s52, 7
    v_mfma_f32_16x16x32_bf16 v[136:139], a[96:99], a[32:35], v[136:139]
    ds_read_b128 a[72:75], v219 offset:14336
    s_add_u32 s17, s59, s52
    v_mfma_f32_16x16x32_bf16 v[140:143], a[100:103], a[32:35], v[140:143]
    s_add_u32 s17, s17, 16384
    s_mov_b32 s19, 0x3ea52b5c
    s_mul_i32 s59, s81, 160
    v_mfma_f32_16x16x32_bf16 v[144:147], a[88:91], a[36:39], v[144:147]
    ds_read_b128 a[76:79], v219 offset:16384
    s_sub_u32 s60, 2048, s59
    v_mfma_f32_16x16x32_bf16 v[148:151], a[92:95], a[36:39], v[148:151]
    ds_read_b128 a[80:83], v219 offset:18432
    s_min_u32 s60, s60, 160
    v_mfma_f32_16x16x32_bf16 v[152:155], a[96:99], a[36:39], v[152:155]
    buffer_load_dwordx4 a[192:195], v239, s[40:43], s63 offen offset:2048 sc1
    v_mfma_f32_16x16x32_bf16 v[156:159], a[100:103], a[36:39], v[156:159]
    ds_read_b128 a[84:87], v219 offset:20480
    s_sub_u32 s60, s60, 128
    v_mfma_f32_16x16x32_bf16 v[160:163], a[88:91], a[40:43], v[160:163]
    v_cmp_gt_u32 s[8:9], s60, v255
    v_lshlrev_b32 v235, 2, v255
    s_lshl_b32 s59, s59, 2
    v_mfma_f32_16x16x32_bf16 v[164:167], a[92:95], a[40:43], v[164:167]
    v_cndmask_b32 v236, v253, v235, s[8:9]
    s_lshr_b32 s61, s80, 1
    s_lshl_b32 s61, s61, 13
    v_mfma_f32_16x16x32_bf16 v[168:171], a[96:99], a[40:43], v[168:171]
    s_add_u32 s59, s59, s61
    s_and_b32 s61, s80, 1
    s_or_b32 s61, s61, s44
    v_mfma_f32_16x16x32_bf16 v[172:175], a[100:103], a[40:43], v[172:175]
    buffer_load_dwordx4 a[196:199], v239, s[40:43], s63 offen offset:3072 sc1
    s_waitcnt lgkmcnt(6)
    v_mfma_f32_16x16x32_bf16 v[0:3], a[104:107], a[44:47], v[0:3]
    s_cmp_eq_u32 s61, 0
    s_cselect_b32 s9, s59, 0x3f000000
    s_mov_b32 s8, 0x3fb8aa3b
    v_mfma_f32_16x16x32_bf16 v[4:7], a[108:111], a[44:47], v[4:7]
    v_mfma_f32_16x16x32_bf16 v[8:11], a[112:115], a[44:47], v[8:11]
    v_add_u32_e64 v222, v182, v222
    v_mfma_f32_16x16x32_bf16 v[16:19], a[104:107], a[48:51], v[16:19]
    v_add_u32_e64 v223, v182, v223
    v_mfma_f32_16x16x32_bf16 v[20:23], a[108:111], a[48:51], v[20:23]
    s_add_u32 s63, s10, 20480
    buffer_load_dwordx4 a[200:203], v239, s[40:43], s63 offen offset:0 sc1
    v_mfma_f32_16x16x32_bf16 v[24:27], a[112:115], a[48:51], v[24:27]
    v_mfma_f32_16x16x32_bf16 v[28:31], a[116:119], a[48:51], v[28:31]
    s_waitcnt vmcnt(18) lgkmcnt(0)
    s_barrier
    v_mfma_f32_16x16x32_bf16 v[32:35], a[104:107], a[52:55], v[32:35]
    ds_read_b64_tr_b16 a[88:89], v221 offset:36928
    v_mfma_f32_16x16x32_bf16 v[36:39], a[108:111], a[52:55], v[36:39]
    ds_read_b64_tr_b16 a[90:91], v221 offset:39232
    v_mfma_f32_16x16x32_bf16 v[40:43], a[112:115], a[52:55], v[40:43]
    buffer_load_dwordx4 a[204:207], v239, s[40:43], s63 offen offset:1024 sc1
    v_mfma_f32_16x16x32_bf16 v[44:47], a[116:119], a[52:55], v[44:47]
    ds_read_b128 a[0:3], v216 offset:0
    v_mfma_f32_16x16x32_bf16 v[48:51], a[104:107], a[56:59], v[48:51]
    v_mfma_f32_16x16x32_bf16 v[52:55], a[108:111], a[56:59], v[52:55]
    ds_read_b64_tr_b16 a[92:93], v222 offset:0
    v_mfma_f32_16x16x32_bf16 v[56:59], a[112:115], a[56:59], v[56:59]
    v_mfma_f32_16x16x32_bf16 v[60:63], a[116:119], a[56:59], v[60:63]
    ds_read_b64_tr_b16 a[94:95], v223 offset:0
    v_mfma_f32_16x16x32_bf16 v[64:67], a[104:107], a[60:63], v[64:67]
    ds_read_b64_tr_b16 a[96:97], v220 offset:37120
    v_mfma_f32_16x16x32_bf16 v[68:71], a[108:111], a[60:63], v[68:71]
    buffer_load_dwordx4 a[208:211], v239, s[40:43], s63 offen offset:2048 sc1
    v_mfma_f32_16x16x32_bf16 v[72:75], a[112:115], a[60:63], v[72:75]
    ds_read_b64_tr_b16 a[98:99], v220 offset:39424
    v_mfma_f32_16x16x32_bf16 v[76:79], a[116:119], a[60:63], v[76:79]
    v_mfma_f32_16x16x32_bf16 v[80:83], a[104:107], a[64:67], v[80:83]
    ds_read_b64_tr_b16 a[100:101], v220 offset:36928
    v_mfma_f32_16x16x32_bf16 v[84:87], a[108:111], a[64:67], v[84:87]
    v_mfma_f32_16x16x32_bf16 v[88:91], a[112:115], a[64:67], v[88:91]
    ds_read_b64_tr_b16 a[102:103], v220 offset:39232
    v_mfma_f32_16x16x32_bf16 v[92:95], a[116:119], a[64:67], v[92:95]
    ds_read_b128 a[4:7], v216 offset:2048
    v_mfma_f32_16x16x32_bf16 v[96:99], a[104:107], a[68:71], v[96:99]
    buffer_load_dwordx4 a[212:215], v239, s[40:43], s63 offen offset:3072 sc1
    v_mfma_f32_16x16x32_bf16 v[100:103], a[108:111], a[68:71], v[100:103]
    ds_read_b128 a[8:11], v216 offset:4096
    v_mfma_f32_16x16x32_bf16 v[104:107], a[112:115], a[68:71], v[104:107]
    v_mfma_f32_16x16x32_bf16 v[108:111], a[116:119], a[68:71], v[108:111]
    ds_read_b128 a[12:15], v216 offset:6144
    v_mfma_f32_16x16x32_bf16 v[112:115], a[104:107], a[72:75], v[112:115]
    v_mfma_f32_16x16x32_bf16 v[116:119], a[108:111], a[72:75], v[116:119]
    ds_read_b128 a[16:19], v216 offset:8192
    v_mfma_f32_16x16x32_bf16 v[120:123], a[112:115], a[72:75], v[120:123]
    ds_read_b128 a[20:23], v216 offset:10240
    v_mfma_f32_16x16x32_bf16 v[124:127], a[116:119], a[72:75], v[124:127]
    s_add_u32 s63, s10, 24576
    buffer_load_dwordx4 a[216:219], v239, s[40:43], s63 offen offset:0 sc1
    s_waitcnt vmcnt(12)
    v_cmp_le_u32_e64 vcc, 20, v243
    s_nop 0
    s_andn2_b32 s84, 0x4, vcc_lo
    s_cbranch_scc1 L_retry42
L_ok42:
    v_mfma_f32_16x16x32_bf16 v[128:131], a[104:107], a[76:79], v[128:131]
    ds_read_b128 a[24:27], v216 offset:12288
    s_and_b32 s57, s2, 6
    v_mfma_f32_16x16x32_bf16 v[132:135], a[108:111], a[76:79], v[132:135]
    s_lshl_b32 s57, s57, 2
    s_bfe_u32 s58, s2, 0x10005
    s_lshl_b32 s58, s58, 2
    v_mfma_f32_16x16x32_bf16 v[136:139], a[112:115], a[76:79], v[136:139]
    ds_read_b128 a[28:31], v216 offset:14336
    s_add_u32 s57, s57, s58
    v_mfma_f32_16x16x32_bf16 v[140:143], a[116:119], a[76:79], v[140:143]
    s_and_b32 s58, s55, 3
    s_add_u32 s58, s58, s57
    s_mul_i32 s59, s58, 43
    v_mfma_f32_16x16x32_bf16 v[144:147], a[104:107], a[80:83], v[144:147]
    ds_read_b128 a[32:35], v216 offset:16384
    s_lshr_b32 s59, s59, 7
    v_mfma_f32_16x16x32_bf16 v[148:151], a[108:111], a[80:83], v[148:151]
    ds_read_b128 a[36:39], v216 offset:18432
    s_bfe_u32 s60, s55, 0x20002
    v_mfma_f32_16x16x32_bf16 v[152:155], a[112:115], a[80:83], v[152:155]
    buffer_load_dwordx4 a[220:223], v239, s[40:43], s63 offen offset:1024 sc1
    v_mfma_f32_16x16x32_bf16 v[156:159], a[116:119], a[80:83], v[156:159]
    ds_read_b128 a[40:43], v216 offset:20480
    s_mul_i32 s45, s59, 6144
    v_mfma_f32_16x16x32_bf16 v[160:163], a[104:107], a[84:87], v[160:163]
    s_lshl_b32 s53, s60, 7
    s_add_u32 s45, s45, s53
    v_mfma_f32_16x16x32_bf16 v[164:167], a[108:111], a[84:87], v[164:167]
    s_cmp_lt_u32 s58, 30
    s_cselect_b32 s53, 3, 2
    s_mul_i32 s60, s60, s53
    v_mfma_f32_16x16x32_bf16 v[168:171], a[112:115], a[84:87], v[168:171]
    s_mul_i32 s4, s59, 9
    s_add_u32 s4, s4, s58
    s_add_u32 s4, s4, s60
    v_mfma_f32_16x16x32_bf16 v[172:175], a[116:119], a[84:87], v[172:175]
    buffer_load_dwordx4 a[224:227], v239, s[40:43], s63 offen offset:2048 sc1
    s_waitcnt lgkmcnt(6)
    v_mfma_f32_16x16x32_bf16 v[0:3], a[88:91], a[0:3], v[0:3]
    s_add_u32 s55, s55, s56
    s_and_b32 s58, s55, 3
    s_add_u32 s58, s58, s57
    v_mfma_f32_16x16x32_bf16 v[4:7], a[92:95], a[0:3], v[4:7]
    s_mul_i32 s59, s58, 43
    s_lshr_b32 s59, s59, 7
    s_bfe_u32 s60, s55, 0x20002
    v_mfma_f32_16x16x32_bf16 v[8:11], a[96:99], a[0:3], v[8:11]
    v_add_u32_e64 v222, v182, v222
    s_mul_i32 s46, s59, 6144
    s_lshl_b32 s53, s60, 7
    v_mfma_f32_16x16x32_bf16 v[16:19], a[88:91], a[4:7], v[16:19]
    v_add_u32_e64 v223, v182, v223
    s_add_u32 s46, s46, s53
    v_mfma_f32_16x16x32_bf16 v[20:23], a[92:95], a[4:7], v[20:23]
    buffer_load_dwordx4 a[228:231], v239, s[40:43], s63 offen offset:3072 sc1
    v_mfma_f32_16x16x32_bf16 v[24:27], a[96:99], a[4:7], v[24:27]
    s_cmp_lt_u32 s58, 30
    s_cselect_b32 s53, 3, 2
    s_mul_i32 s60, s60, s53
    v_mfma_f32_16x16x32_bf16 v[28:31], a[100:103], a[4:7], v[28:31]
    s_waitcnt lgkmcnt(0)
    s_barrier
    s_mul_i32 s5, s59, 9
    v_mfma_f32_16x16x32_bf16 v[32:35], a[88:91], a[8:11], v[32:35]
    ds_read_b64_tr_b16 a[104:105], v221 offset:55392
    s_add_u32 s5, s5, s58
    v_mfma_f32_16x16x32_bf16 v[36:39], a[92:95], a[8:11], v[36:39]
    ds_read_b64_tr_b16 a[106:107], v221 offset:57696
    s_add_u32 s5, s5, s60
    v_mfma_f32_16x16x32_bf16 v[40:43], a[96:99], a[8:11], v[40:43]
    s_add_u32 s63, s10, 28672
    buffer_load_dwordx4 a[232:235], v239, s[40:43], s63 offen offset:0 sc1
    v_mfma_f32_16x16x32_bf16 v[44:47], a[100:103], a[8:11], v[44:47]
    ds_read_b128 a[44:47], v217 offset:0
    s_mul_i32 s12, s44, 12288
    v_mfma_f32_16x16x32_bf16 v[48:51], a[88:91], a[12:15], v[48:51]
    s_add_u32 s12, s12, 20480
    s_mul_i32 s59, s44, 3
    v_add_u32 v242, s59, v255
    v_mfma_f32_16x16x32_bf16 v[52:55], a[92:95], a[12:15], v[52:55]
    ds_read_b64_tr_b16 a[108:109], v222 offset:0
    v_lshlrev_b32_e64 v242, 9, v242
    v_mfma_f32_16x16x32_bf16 v[56:59], a[96:99], a[12:15], v[56:59]
    s_mov_b32 vcc_lo, 7
    s_mov_b32 vcc_hi, 0
    v_mov_b32_e64 v243, 0x40000000
    v_mfma_f32_16x16x32_bf16 v[60:63], a[100:103], a[12:15], v[60:63]
    ds_read_b64_tr_b16 a[110:111], v223 offset:0
    v_cndmask_b32 v242, v243, v242, vcc
    v_mfma_f32_16x16x32_bf16 v[64:67], a[88:91], a[16:19], v[64:67]
    ds_read_b64_tr_b16 a[112:113], v220 offset:55584
    v_mfma_f32_16x16x32_bf16 v[68:71], a[92:95], a[16:19], v[68:71]
    buffer_load_dwordx4 a[236:239], v239, s[40:43], s63 offen offset:1024 sc1
    v_mfma_f32_16x16x32_bf16 v[72:75], a[96:99], a[16:19], v[72:75]
    ds_read_b64_tr_b16 a[114:115], v220 offset:57888
    v_mfma_f32_16x16x32_bf16 v[76:79], a[100:103], a[16:19], v[76:79]
    v_mfma_f32_16x16x32_bf16 v[80:83], a[88:91], a[20:23], v[80:83]
    ds_read_b64_tr_b16 a[116:117], v220 offset:55392
    v_mfma_f32_16x16x32_bf16 v[84:87], a[92:95], a[20:23], v[84:87]
    v_mfma_f32_16x16x32_bf16 v[88:91], a[96:99], a[20:23], v[88:91]
    ds_read_b64_tr_b16 a[118:119], v220 offset:57696
    v_mfma_f32_16x16x32_bf16 v[92:95], a[100:103], a[20:23], v[92:95]
    ds_read_b128 a[48:51], v217 offset:2048
    v_mfma_f32_16x16x32_bf16 v[96:99], a[88:91], a[24:27], v[96:99]
    buffer_load_dwordx4 a[240:243], v239, s[40:43], s63 offen offset:2048 sc1
    v_mfma_f32_16x16x32_bf16 v[100:103], a[92:95], a[24:27], v[100:103]
    ds_read_b128 a[52:55], v217 offset:4096
    v_mfma_f32_16x16x32_bf16 v[104:107], a[96:99], a[24:27], v[104:107]
    v_mfma_f32_16x16x32_bf16 v[108:111], a[100:103], a[24:27], v[108:111]
    ds_read_b128 a[56:59], v217 offset:6144
    v_mfma_f32_16x16x32_bf16 v[112:115], a[88:91], a[28:31], v[112:115]
    v_mfma_f32_16x16x32_bf16 v[116:119], a[92:95], a[28:31], v[116:119]
    ds_read_b128 a[60:63], v217 offset:8192
    v_mfma_f32_16x16x32_bf16 v[120:123], a[96:99], a[28:31], v[120:123]
    ds_read_b128 a[64:67], v217 offset:10240
    v_mfma_f32_16x16x32_bf16 v[124:127], a[100:103], a[28:31], v[124:127]
    buffer_load_dwordx4 a[244:247], v239, s[40:43], s63 offen offset:3072 sc1
    v_mfma_f32_16x16x32_bf16 v[128:131], a[88:91], a[32:35], v[128:131]
    ds_read_b128 a[68:71], v217 offset:12288
    v_mfma_f32_16x16x32_bf16 v[132:135], a[92:95], a[32:35], v[132:135]
    v_mfma_f32_16x16x32_bf16 v[136:139], a[96:99], a[32:35], v[136:139]
    ds_read_b128 a[72:75], v217 offset:14336
    v_mfma_f32_16x16x32_bf16 v[140:143], a[100:103], a[32:35], v[140:143]
    v_mfma_f32_16x16x32_bf16 v[144:147], a[88:91], a[36:39], v[144:147]
    ds_read_b128 a[76:79], v217 offset:16384
    v_mfma_f32_16x16x32_bf16 v[148:151], a[92:95], a[36:39], v[148:151]
    ds_read_b128 a[80:83], v217 offset:18432
    v_mfma_f32_16x16x32_bf16 v[152:155], a[96:99], a[36:39], v[152:155]
    s_add_u32 s63, s10, 32768
    buffer_load_dwordx4 a[248:251], v239, s[40:43], s63 offen offset:0 sc1
    v_mfma_f32_16x16x32_bf16 v[156:159], a[100:103], a[36:39], v[156:159]
    ds_read_b128 a[84:87], v217 offset:20480
    v_mfma_f32_16x16x32_bf16 v[160:163], a[88:91], a[40:43], v[160:163]
    v_mfma_f32_16x16x32_bf16 v[164:167], a[92:95], a[40:43], v[164:167]
    v_mfma_f32_16x16x32_bf16 v[168:171], a[96:99], a[40:43], v[168:171]
    v_mfma_f32_16x16x32_bf16 v[172:175], a[100:103], a[40:43], v[172:175]
    buffer_load_dwordx4 a[252:255], v239, s[40:43], s63 offen offset:1024 sc1
    s_waitcnt lgkmcnt(6)
    v_mfma_f32_16x16x32_bf16 v[0:3], a[104:107], a[44:47], v[0:3]
    v_mfma_f32_16x16x32_bf16 v[4:7], a[108:111], a[44:47], v[4:7]
    v_mfma_f32_16x16x32_bf16 v[8:11], a[112:115], a[44:47], v[8:11]
    v_mfma_f32_16x16x32_bf16 v[16:19], a[104:107], a[48:51], v[16:19]
    v_mfma_f32_16x16x32_bf16 v[20:23], a[108:111], a[48:51], v[20:23]
    v_mfma_f32_16x16x32_bf16 v[24:27], a[112:115], a[48:51], v[24:27]
    v_cvt_pk_bf16_f32 v0, v0, v1
    v_cvt_pk_bf16_f32 v1, v2, v3
    v_mfma_f32_16x16x32_bf16 v[28:31], a[116:119], a[48:51], v[28:31]
    v_cvt_pk_bf16_f32 v2, v4, v5
    v_cvt_pk_bf16_f32 v3, v6, v7
    v_mfma_f32_16x16x32_bf16 v[32:35], a[104:107], a[52:55], v[32:35]
    v_cvt_pk_bf16_f32 v4, v8, v9
    v_cvt_pk_bf16_f32 v5, v10, v11
    v_mfma_f32_16x16x32_bf16 v[36:39], a[108:111], a[52:55], v[36:39]
    ds_write_b128 v229, v[0:3] offset:0
    v_mfma_f32_16x16x32_bf16 v[40:43], a[112:115], a[52:55], v[40:43]
    v_mov_b32_e64 v176, v20
    v_cvt_pk_bf16_f32 v16, v16, v17
    v_mfma_f32_16x16x32_bf16 v[44:47], a[116:119], a[52:55], v[44:47]
    v_cvt_pk_bf16_f32 v17, v18, v19
    v_cvt_pk_bf16_f32 v18, v20, v21
    v_mfma_f32_16x16x32_bf16 v[48:51], a[104:107], a[56:59], v[48:51]
    v_cvt_pk_bf16_f32 v19, v22, v23
    v_cvt_pk_bf16_f32 v20, v24, v25
    v_mfma_f32_16x16x32_bf16 v[52:55], a[108:111], a[56:59], v[52:55]
    v_cvt_pk_bf16_f32 v21, v26, v27
    v_mfma_f32_16x16x32_bf16 v[56:59], a[112:115], a[56:59], v[56:59]
    ds_write_b128 v229, v[16:19] offset:1024
    v_mfma_f32_16x16x32_bf16 v[60:63], a[116:119], a[56:59], v[60:63]
    v_cndmask_b32 v22, 0, v16, s[30:31]
    v_cndmask_b32 v23, 0, v17, s[30:31]
    v_mfma_f32_16x16x32_bf16 v[64:67], a[104:107], a[60:63], v[64:67]
    v_cvt_pk_bf16_f32 v24, v28, v29
    v_cvt_pk_bf16_f32 v25, v30, v31
    v_mfma_f32_16x16x32_bf16 v[68:71], a[108:111], a[60:63], v[68:71]
    v_mov_b32_e64 v180, v36
    v_cvt_pk_bf16_f32 v32, v32, v33
    v_mfma_f32_16x16x32_bf16 v[72:75], a[112:115], a[60:63], v[72:75]
    v_cvt_pk_bf16_f32 v33, v34, v35
    v_cvt_pk_bf16_f32 v34, v36, v37
    v_mfma_f32_16x16x32_bf16 v[76:79], a[116:119], a[60:63], v[76:79]
    s_waitcnt lgkmcnt(2)
    v_cvt_pk_bf16_f32 v35, v38, v39
    v_cvt_pk_bf16_f32 v36, v40, v41
    v_mfma_f32_16x16x32_bf16 v[80:83], a[104:107], a[64:67], v[80:83]
    v_cvt_pk_bf16_f32 v37, v42, v43
    v_mfma_f32_16x16x32_bf16 v[84:87], a[108:111], a[64:67], v[84:87]
    ds_write_b128 v229, v[32:35] offset:2048
    v_mfma_f32_16x16x32_bf16 v[88:91], a[112:115], a[64:67], v[88:91]
    v_cndmask_b32 v38, 0, v32, s[30:31]
    v_cndmask_b32 v39, 0, v33, s[30:31]
    v_mfma_f32_16x16x32_bf16 v[92:95], a[116:119], a[64:67], v[92:95]
    v_cvt_pk_bf16_f32 v40, v44, v45
    v_cvt_pk_bf16_f32 v41, v46, v47
    v_mfma_f32_16x16x32_bf16 v[96:99], a[104:107], a[68:71], v[96:99]
    v_mov_b32 v184, v52
    v_cvt_pk_bf16_f32 v48, v48, v49
    v_mfma_f32_16x16x32_bf16 v[100:103], a[108:111], a[68:71], v[100:103]
    v_cvt_pk_bf16_f32 v49, v50, v51
    v_cvt_pk_bf16_f32 v50, v52, v53
    v_mfma_f32_16x16x32_bf16 v[104:107], a[112:115], a[68:71], v[104:107]
    v_cvt_pk_bf16_f32 v51, v54, v55
    v_cvt_pk_bf16_f32 v52, v56, v57
    v_mfma_f32_16x16x32_bf16 v[108:111], a[116:119], a[68:71], v[108:111]
    v_cvt_pk_bf16_f32 v53, v58, v59
    v_mfma_f32_16x16x32_bf16 v[112:115], a[104:107], a[72:75], v[112:115]
    ds_write_b128 v229, v[48:51] offset:3072
    v_mfma_f32_16x16x32_bf16 v[116:119], a[108:111], a[72:75], v[116:119]
    v_cndmask_b32 v54, 0, v48, s[30:31]
    v_cndmask_b32 v55, 0, v49, s[30:31]
    v_mfma_f32_16x16x32_bf16 v[120:123], a[112:115], a[72:75], v[120:123]
    v_cvt_pk_bf16_f32 v56, v60, v61
    v_cvt_pk_bf16_f32 v57, v62, v63
    v_mfma_f32_16x16x32_bf16 v[124:127], a[116:119], a[72:75], v[124:127]
    v_mov_b32_e64 v188, v68
    v_cvt_pk_bf16_f32 v64, v64, v65
    v_mfma_f32_16x16x32_bf16 v[128:131], a[104:107], a[76:79], v[128:131]
    v_cvt_pk_bf16_f32 v65, v66, v67
    v_cvt_pk_bf16_f32 v66, v68, v69
    v_mfma_f32_16x16x32_bf16 v[132:135], a[108:111], a[76:79], v[132:135]
    v_cvt_pk_bf16_f32 v67, v70, v71
    v_cvt_pk_bf16_f32 v68, v72, v73
    v_mfma_f32_16x16x32_bf16 v[136:139], a[112:115], a[76:79], v[136:139]
    v_cvt_pk_bf16_f32 v69, v74, v75
    v_mfma_f32_16x16x32_bf16 v[140:143], a[116:119], a[76:79], v[140:143]
    ds_write_b128 v229, v[64:67] offset:4096
    v_mfma_f32_16x16x32_bf16 v[144:147], a[104:107], a[80:83], v[144:147]
    v_cndmask_b32 v70, 0, v64, s[30:31]
    v_cndmask_b32 v71, 0, v65, s[30:31]
    v_mfma_f32_16x16x32_bf16 v[148:151], a[108:111], a[80:83], v[148:151]
    v_cvt_pk_bf16_f32 v72, v76, v77
    v_cvt_pk_bf16_f32 v73, v78, v79
    v_mfma_f32_16x16x32_bf16 v[152:155], a[112:115], a[80:83], v[152:155]
    v_mov_b32_e64 v192, v84
    v_cvt_pk_bf16_f32 v80, v80, v81
    v_mfma_f32_16x16x32_bf16 v[156:159], a[116:119], a[80:83], v[156:159]
    v_cvt_pk_bf16_f32 v81, v82, v83
    v_cvt_pk_bf16_f32 v82, v84, v85
    v_mfma_f32_16x16x32_bf16 v[160:163], a[104:107], a[84:87], v[160:163]
    v_cvt_pk_bf16_f32 v83, v86, v87
    v_cvt_pk_bf16_f32 v84, v88, v89
    v_mfma_f32_16x16x32_bf16 v[164:167], a[108:111], a[84:87], v[164:167]
    v_cvt_pk_bf16_f32 v85, v90, v91
    v_mfma_f32_16x16x32_bf16 v[168:171], a[112:115], a[84:87], v[168:171]
    ds_write_b128 v229, v[80:83] offset:5120
    v_mfma_f32_16x16x32_bf16 v[172:175], a[116:119], a[84:87], v[172:175]
    v_cndmask_b32 v86, 0, v80, s[30:31]
    v_cndmask_b32 v87, 0, v81, s[30:31]
    s_nop 3
    v_cvt_pk_bf16_f32 v88, v92, v93
    v_cvt_pk_bf16_f32 v89, v94, v95
    v_mov_b32 v196, v100
    v_cvt_pk_bf16_f32 v96, v96, v97
    v_cvt_pk_bf16_f32 v97, v98, v99
    v_cvt_pk_bf16_f32 v98, v100, v101
    v_cvt_pk_bf16_f32 v99, v102, v103
    v_cvt_pk_bf16_f32 v100, v104, v105
    v_cvt_pk_bf16_f32 v101, v106, v107
    ds_write_b128 v229, v[96:99] offset:6144
    v_cndmask_b32 v102, 0, v96, s[30:31]
    v_cndmask_b32 v103, 0, v97, s[30:31]
    v_cvt_pk_bf16_f32 v104, v108, v109
    v_cvt_pk_bf16_f32 v105, v110, v111
    v_mov_b32_e64 v200, v116
    v_cvt_pk_bf16_f32 v112, v112, v113
    v_cvt_pk_bf16_f32 v113, v114, v115
    v_cvt_pk_bf16_f32 v114, v116, v117
    v_cvt_pk_bf16_f32 v115, v118, v119
    v_cvt_pk_bf16_f32 v116, v120, v121
    v_cvt_pk_bf16_f32 v117, v122, v123
    ds_write_b128 v229, v[112:115] offset:7168
    s_lshl_b32 s81, s44, 10
    s_add_u32 s81, s81, 101632
    v_cndmask_b32 v118, 0, v112, s[30:31]
    v_cndmask_b32 v119, 0, v113, s[30:31]
    v_cvt_pk_bf16_f32 v120, v124, v125
    v_cvt_pk_bf16_f32 v121, v126, v127
    v_mov_b32 v204, v132
    v_cvt_pk_bf16_f32 v128, v128, v129
    v_cvt_pk_bf16_f32 v129, v130, v131
    v_cvt_pk_bf16_f32 v130, v132, v133
    v_cvt_pk_bf16_f32 v131, v134, v135
    v_cvt_pk_bf16_f32 v132, v136, v137
    v_cvt_pk_bf16_f32 v133, v138, v139
    ds_write_b128 v229, v[128:131] offset:8192
    v_cndmask_b32 v134, 0, v128, s[30:31]
    v_cndmask_b32 v135, 0, v129, s[30:31]
    v_cvt_pk_bf16_f32 v136, v140, v141
    v_cvt_pk_bf16_f32 v137, v142, v143
    v_mov_b32_e64 v208, v148
    v_cvt_pk_bf16_f32 v144, v144, v145
    v_cvt_pk_bf16_f32 v145, v146, v147
    v_cvt_pk_bf16_f32 v146, v148, v149
    v_cvt_pk_bf16_f32 v147, v150, v151
    v_cvt_pk_bf16_f32 v148, v152, v153
    v_cvt_pk_bf16_f32 v149, v154, v155
    ds_write_b128 v229, v[144:147] offset:9216
    buffer_load_dwordx4 a[92:95], v239, s[40:43], s63 offen offset:2048 sc1
    v_cndmask_b32 v150, 0, v144, s[30:31]
    v_cndmask_b32 v151, 0, v145, s[30:31]
    v_cvt_pk_bf16_f32 v152, v156, v157
    v_cvt_pk_bf16_f32 v153, v158, v159
    v_mov_b32_e64 v212, v164
    v_cvt_pk_bf16_f32 v160, v160, v161
    v_cvt_pk_bf16_f32 v161, v162, v163
    v_cvt_pk_bf16_f32 v162, v164, v165
    v_cvt_pk_bf16_f32 v163, v166, v167
    v_cvt_pk_bf16_f32 v164, v168, v169
    v_cvt_pk_bf16_f32 v165, v170, v171
    ds_write_b128 v229, v[160:163] offset:10240
    v_cndmask_b32 v166, 0, v160, s[30:31]
    v_cndmask_b32 v167, 0, v161, s[30:31]
    v_cvt_pk_bf16_f32 v168, v172, v173
    v_cvt_pk_bf16_f32 v169, v174, v175
    v_permlane16_swap_b32 v176, v180
    v_permlane16_swap_b32 v184, v188
    s_nop 1
    v_permlane32_swap_b32 v180, v188
    buffer_load_dwordx4 a[96:99], v239, s[40:43], s63 offen offset:3072 sc1
    v_mov_b32 v240, v188
    v_permlane16_swap_b32 v192, v196
    v_permlane16_swap_b32 v200, v204
    s_nop 1
    v_permlane32_swap_b32 v196, v204
    v_mov_b32 v241, v204
    v_permlane16_swap_b32 v208, v212
    v_mov_b32 v238, v212
    s_nop 1
    v_permlane32_swap_b32 v212, v238
    ds_read_b64_tr_b16 a[0:1], v231 offset:0
    ds_read_b64_tr_b16 a[22:23], v232 offset:0
    ds_read_b64_tr_b16 a[2:3], v231 offset:1024
    ds_read_b64_tr_b16 a[24:25], v232 offset:1024
    v_mfma_f32_16x16x32_bf16 v[28:31], v[2:5], v[22:25], 0
    v_mfma_f32_16x16x32_bf16 v[176:179], v[18:21], v[22:25], 0
    s_add_u32 s63, s10, 36864
    buffer_load_dwordx4 a[100:103], v239, s[40:43], s63 offen offset:0 sc1
    ds_read_b64_tr_b16 a[4:5], v231 offset:2048
    ds_read_b64_tr_b16 a[26:27], v232 offset:2048
    v_mfma_f32_16x16x32_bf16 v[44:47], v[18:21], v[38:41], 0
    v_mfma_f32_16x16x32_bf16 v[180:183], v[34:37], v[38:41], 0
    ds_read_b64_tr_b16 a[6:7], v231 offset:3072
    ds_read_b64_tr_b16 a[28:29], v232 offset:3072
    v_mfma_f32_16x16x32_bf16 v[60:63], v[34:37], v[54:57], 0
    v_mfma_f32_16x16x32_bf16 v[184:187], v[50:53], v[54:57], 0
    ds_read_b64_tr_b16 a[8:9], v231 offset:4096
    ds_read_b64_tr_b16 a[30:31], v232 offset:4096
    v_mfma_f32_16x16x32_bf16 v[76:79], v[50:53], v[70:73], 0
    v_mfma_f32_16x16x32_bf16 v[188:191], v[66:69], v[70:73], 0
    ds_read_b64_tr_b16 a[10:11], v231 offset:5120
    ds_read_b64_tr_b16 a[32:33], v232 offset:5120
    v_mfma_f32_16x16x32_bf16 v[92:95], v[66:69], v[86:89], 0
    buffer_load_dwordx4 a[104:107], v239, s[40:43], s63 offen offset:1024 sc1
    v_mfma_f32_16x16x32_bf16 v[192:195], v[82:85], v[86:89], 0
    ds_read_b64_tr_b16 a[12:13], v231 offset:6144
    ds_read_b64_tr_b16 a[34:35], v232 offset:6144
    v_mfma_f32_16x16x32_bf16 v[108:111], v[82:85], v[102:105], 0
    v_mfma_f32_16x16x32_bf16 v[196:199], v[98:101], v[102:105], 0
    ds_read_b64_tr_b16 a[14:15], v231 offset:7168
    ds_read_b64_tr_b16 a[36:37], v232 offset:7168
    v_mfma_f32_16x16x32_bf16 v[124:127], v[98:101], v[118:121], 0
    v_mfma_f32_16x16x32_bf16 v[200:203], v[114:117], v[118:121], 0
    ds_read_b64_tr_b16 a[16:17], v231 offset:8192
    ds_read_b64_tr_b16 a[38:39], v232 offset:8192
    v_mfma_f32_16x16x32_bf16 v[140:143], v[114:117], v[134:137], 0
    v_mfma_f32_16x16x32_bf16 v[204:207], v[130:133], v[134:137], 0
    ds_read_b64_tr_b16 a[18:19], v231 offset:9216
    ds_read_b64_tr_b16 a[40:41], v232 offset:9216
    buffer_load_dwordx4 a[108:111], v239, s[40:43], s63 offen offset:2048 sc1
    v_mfma_f32_16x16x32_bf16 v[156:159], v[130:133], v[150:153], 0
    v_mfma_f32_16x16x32_bf16 v[208:211], v[146:149], v[150:153], 0
    ds_read_b64_tr_b16 a[20:21], v231 offset:10240
    ds_read_b64_tr_b16 a[42:43], v232 offset:10240
    v_mfma_f32_16x16x32_bf16 v[172:175], v[146:149], v[166:169], 0
    v_mfma_f32_16x16x32_bf16 v[212:215], v[162:165], v[166:169], 0
    v_mul_f32 v240, s8, v240
    v_mul_f32 v241, s8, v241
    v_mul_f32 v238, s8, v238
    v_exp_f32 v251, v240
    v_exp_f32 v237, v241
    v_exp_f32 v254, v238
    v_exp_f32 v240, -v240
    v_exp_f32 v241, -v241
    v_exp_f32 v238, -v238
    buffer_load_dwordx4 a[112:115], v239, s[40:43], s63 offen offset:3072 sc1
    v_add_f32 v251, 1.0, v251
    v_add_f32 v237, 1.0, v237
    v_add_f32 v254, 1.0, v254
    v_add_f32 v240, 1.0, v240
    v_add_f32 v241, 1.0, v241
    v_add_f32 v238, 1.0, v238
    v_rcp_f32 v251, v251
    v_rcp_f32 v237, v237
    v_rcp_f32_e64 v254, v254
    v_cndmask_b32 v28, v28, v29, s[24:25]
    v_cndmask_b32 v44, v44, v45, s[24:25]
    v_cndmask_b32 v60, v60, v61, s[24:25]
    v_cndmask_b32 v76, v76, v77, s[24:25]
    v_cndmask_b32 v92, v92, v93, s[24:25]
    v_cndmask_b32 v108, v108, v109, s[24:25]
    v_cndmask_b32 v124, v124, v125, s[24:25]
    v_cndmask_b32 v140, v140, v141, s[24:25]
    v_cndmask_b32 v156, v156, v157, s[24:25]
    v_cndmask_b32 v172, v172, v173, s[24:25]
    buffer_store_dword v251, v235, s[64:67], s9 offen offset:0 sc1
    buffer_store_dword v237, v235, s[64:67], s9 offen offset:256 sc1
    s_add_u32 s63, s10, 40960
    buffer_load_dwordx4 a[116:119], v239, s[40:43], s63 offen offset:0 sc1
    buffer_store_dword v254, v236, s[64:67], s9 offen offset:512 sc1
    v_cndmask_b32 v30, v30, v31, s[24:25]
    v_cndmask_b32 v46, v46, v47, s[24:25]
    v_cndmask_b32 v62, v62, v63, s[24:25]
    v_cndmask_b32 v78, v78, v79, s[24:25]
    v_cndmask_b32 v94, v94, v95, s[24:25]
    v_cndmask_b32 v110, v110, v111, s[24:25]
    v_cndmask_b32 v126, v126, v127, s[24:25]
    v_cndmask_b32 v142, v142, v143, s[24:25]
    v_cndmask_b32 v158, v158, v159, s[24:25]
    v_cndmask_b32 v174, v174, v175, s[24:25]
    v_cndmask_b32 v176, v176, v177, s[24:25]
    v_cndmask_b32 v180, v180, v181, s[24:25]
    v_cndmask_b32 v184, v184, v185, s[24:25]
    v_cndmask_b32 v188, v188, v189, s[24:25]
    v_cndmask_b32 v192, v192, v193, s[24:25]
    v_cndmask_b32 v196, v196, v197, s[24:25]
    v_cndmask_b32 v200, v200, v201, s[24:25]
    v_cndmask_b32 v204, v204, v205, s[24:25]
    v_cndmask_b32 v208, v208, v209, s[24:25]
    v_cndmask_b32 v212, v212, v213, s[24:25]
    v_cndmask_b32 v178, v178, v179, s[24:25]
    v_cndmask_b32 v182, v182, v183, s[24:25]
    v_cndmask_b32 v186, v186, v187, s[24:25]
    s_add_u32 m0, s81, 0
    s_add_u32 s61, s10, 47104
    buffer_load_dwordx4 v239, s[40:43], s61 offen sc1 lds
    v_cndmask_b32 v190, v190, v191, s[24:25]
    v_cndmask_b32 v194, v194, v195, s[24:25]
    v_cndmask_b32 v198, v198, v199, s[24:25]
    v_cndmask_b32 v202, v202, v203, s[24:25]
    v_cndmask_b32 v206, v206, v207, s[24:25]
    v_cndmask_b32 v210, v210, v211, s[24:25]
    v_cndmask_b32 v214, v214, v215, s[24:25]
    v_cndmask_b32 v26, v176, v28, s[26:27]
    v_cndmask_b32 v42, v180, v44, s[26:27]
    v_cndmask_b32 v58, v184, v60, s[26:27]
    v_cndmask_b32 v74, v188, v76, s[26:27]
    v_cndmask_b32 v90, v192, v92, s[26:27]
    v_cndmask_b32 v106, v196, v108, s[26:27]
    v_cndmask_b32 v122, v200, v124, s[26:27]
    v_cndmask_b32 v138, v204, v140, s[26:27]
    v_cndmask_b32 v154, v208, v156, s[26:27]
    v_cndmask_b32 v170, v212, v172, s[26:27]
    v_cndmask_b32 v27, v178, v30, s[28:29]
    v_cndmask_b32 v43, v182, v46, s[28:29]
    v_cndmask_b32 v59, v186, v62, s[28:29]
    v_cndmask_b32 v75, v190, v78, s[28:29]
    v_cndmask_b32 v91, v194, v94, s[28:29]
    v_cndmask_b32 v107, v198, v110, s[28:29]
    v_cndmask_b32 v123, v202, v126, s[28:29]
    v_cndmask_b32 v139, v206, v142, s[28:29]
    v_cndmask_b32 v155, v210, v158, s[28:29]
    s_add_u32 m0, s81, 4096
    s_add_u32 s61, s10, 48128
    buffer_load_dwordx4 v239, s[40:43], s61 offen sc1 lds
    v_cndmask_b32 v171, v214, v174, s[28:29]
    v_cndmask_b32 v26, v26, v228, s[36:37]
    v_cndmask_b32 v27, v27, v228, s[38:39]
    s_nop 0
    v_permlane32_swap_b32 v154, v6
    v_permlane32_swap_b32 v155, v7
    v_permlane32_swap_b32 v90, v122
    v_permlane32_swap_b32 v91, v123
    v_permlane32_swap_b32 v26, v58
    v_permlane32_swap_b32 v27, v59
    v_permlane32_swap_b32 v170, v8
    v_permlane32_swap_b32 v171, v9
    v_permlane32_swap_b32 v106, v138
    v_permlane32_swap_b32 v107, v139
    v_permlane32_swap_b32 v42, v74
    s_add_u32 m0, s81, 8192
    s_add_u32 s61, s10, 49152
    buffer_load_dwordx4 v239, s[40:43], s61 offen sc1 lds
    v_permlane32_swap_b32 v43, v75
    v_permlane16_swap_b32 v154, v170
    v_permlane16_swap_b32 v155, v171
    v_permlane16_swap_b32 v90, v106
    v_permlane16_swap_b32 v91, v107
    v_permlane16_swap_b32 v26, v42
    v_permlane16_swap_b32 v27, v43
    v_permlane16_swap_b32 v6, v8
    v_permlane16_swap_b32 v7, v9
    v_permlane16_swap_b32 v122, v138
    v_permlane16_swap_b32 v123, v139
    v_permlane16_swap_b32 v58, v74
    v_permlane16_swap_b32 v59, v75
    s_add_u32 m0, s81, 12288
    s_add_u32 s61, s10, 50176
    buffer_load_dwordx4 v239, s[40:43], s61 offen sc1 lds
    v_max3_f32 v28, v26, v27, v42
    v_max3_f32 v92, v90, v91, v106
    v_max3_f32 v156, v154, v155, v170
    v_max3_f32 v29, v43, v58, v59
    v_max3_f32 v93, v107, v122, v123
    v_max3_f32 v157, v171, v6, v7
    v_max3_f32 v28, v28, v74, v75
    v_max3_f32 v92, v92, v138, v139
    v_max3_f32 v156, v156, v8, v9
    v_max_f32 v28, v28, v29
    v_max_f32 v92, v92, v93
    v_max_f32 v156, v156, v157
    v_mul_f32 v28, s19, v28
    v_mul_f32 v92, s19, v92
    v_mul_f32 v156, s19, v156
    v_fma_f32 v26, v26, s19, -v28
    v_fma_f32 v90, v90, s19, -v92
    v_fma_f32 v154, v154, s19, -v156
    v_fma_f32 v27, v27, s19, -v28
    v_fma_f32 v91, v91, s19, -v92
    v_fma_f32 v155, v155, s19, -v156
    v_fma_f32 v42, v42, s19, -v28
    v_fma_f32 v106, v106, s19, -v92
    v_fma_f32 v170, v170, s19, -v156
    v_fma_f32 v43, v43, s19, -v28
    v_fma_f32 v107, v107, s19, -v92
    s_add_u32 m0, s81, 16384
    s_add_u32 s61, s10, 51200
    buffer_load_dwordx4 v239, s[40:43], s61 offen sc1 lds
    v_fma_f32 v171, v171, s19, -v156
    v_fma_f32 v58, v58, s19, -v28
    v_fma_f32 v122, v122, s19, -v92
    v_fma_f32 v6, v6, s19, -v156
    v_fma_f32 v59, v59, s19, -v28
    v_fma_f32 v123, v123, s19, -v92
    v_fma_f32 v7, v7, s19, -v156
    v_fma_f32 v74, v74, s19, -v28
    v_fma_f32 v138, v138, s19, -v92
    v_fma_f32 v8, v8, s19, -v156
    v_fma_f32 v75, v75, s19, -v28
    v_fma_f32 v139, v139, s19, -v92
    v_fma_f32 v9, v9, s19, -v156
    v_exp_f32 v26, v26
    v_exp_f32 v90, v90
    v_exp_f32 v154, v154
    v_exp_f32 v27, v27
    v_exp_f32 v91, v91
    v_exp_f32 v155, v155
    v_exp_f32_e64 v42, v42
    s_add_u32 m0, s81, 20480
    s_add_u32 s61, s10, 52224
    buffer_load_dwordx4 v239, s[40:43], s61 offen sc1 lds
    v_exp_f32 v106, v106
    v_exp_f32 v170, v170
    v_exp_f32 v43, v43
    v_exp_f32 v107, v107
    v_exp_f32 v171, v171
    v_exp_f32 v58, v58
    v_exp_f32 v122, v122
    v_exp_f32 v6, v6
    v_exp_f32 v59, v59
    v_exp_f32 v123, v123
    v_exp_f32 v7, v7
    v_exp_f32 v74, v74
    v_exp_f32_e64 v138, v138
    s_add_u32 m0, s81, 24576
    s_add_u32 s61, s10, 53248
    buffer_load_dwordx4 v239, s[40:43], s61 offen sc1 lds
    v_exp_f32 v8, v8
    v_exp_f32 v75, v75
    v_exp_f32 v139, v139
    v_exp_f32 v9, v9
    v_pk_add_f32 v[28:29], v[26:27], v[42:43]
    v_pk_add_f32 v[92:93], v[90:91], v[106:107]
    v_pk_add_f32 v[156:157], v[154:155], v[170:171]
    v_pk_add_f32 v[30:31], v[58:59], v[74:75]
    v_pk_add_f32 v[94:95], v[122:123], v[138:139]
    v_pk_add_f32 v[158:159], v[6:7], v[8:9]
    v_pk_add_f32 v[28:29], v[28:29], v[30:31]
    v_pk_add_f32 v[92:93], v[92:93], v[94:95]
    v_pk_add_f32 v[156:157], v[156:157], v[158:159]
    v_add_f32 v28, v28, v29
    v_add_f32 v92, v92, v93
    v_add_f32 v156, v156, v157
    v_mul_f32 v28, v28, v240
    v_mul_f32 v92, v92, v241
    v_mul_f32 v156, v156, v238
    v_rcp_f32 v28, v28
    v_rcp_f32 v92, v92
    buffer_load_dword v243, v242, s[68:71], s45 offen sc1
    v_rcp_f32_e64 v156, v156
    v_pk_mul_f32 v[26:27], v[26:27], v[28:29] op_sel_hi:[1,0]
    v_pk_mul_f32 v[90:91], v[90:91], v[92:93] op_sel_hi:[1,0]
    v_pk_mul_f32 v[154:155], v[154:155], v[156:157] op_sel_hi:[1,0]
    v_pk_mul_f32 v[42:43], v[42:43], v[28:29] op_sel_hi:[1,0]
    v_pk_mul_f32 v[106:107], v[106:107], v[92:93] op_sel_hi:[1,0]
    v_pk_mul_f32 v[170:171], v[170:171], v[156:157] op_sel_hi:[1,0]
    v_pk_mul_f32 v[58:59], v[58:59], v[28:29] op_sel_hi:[1,0]
    v_pk_mul_f32 v[122:123], v[122:123], v[92:93] op_sel_hi:[1,0]
    v_pk_mul_f32 v[6:7], v[6:7], v[156:157] op_sel_hi:[1,0]
    v_pk_mul_f32 v[74:75], v[74:75], v[28:29] op_sel_hi:[1,0]
    v_pk_mul_f32 v[138:139], v[138:139], v[92:93] op_sel_hi:[1,0]
    v_pk_mul_f32 v[8:9], v[8:9], v[156:157] op_sel_hi:[1,0]
    v_cvt_pk_bf16_f32 v26, v26, v27
    v_cvt_pk_bf16_f32 v90, v90, v91
    v_cvt_pk_bf16_f32 v154, v154, v155
    v_cvt_pk_bf16_f32 v42, v42, v43
    v_cvt_pk_bf16_f32 v106, v106, v107
    v_cvt_pk_bf16_f32 v170, v170, v171
    v_cvt_pk_bf16_f32 v58, v58, v59
    v_cvt_pk_bf16_f32 v122, v122, v123
    v_cvt_pk_bf16_f32 v6, v6, v7
    v_cvt_pk_bf16_f32 v74, v74, v75
    v_cvt_pk_bf16_f32 v138, v138, v139
    v_cvt_pk_bf16_f32 v8, v8, v9
    s_add_u32 m0, s81, 28672
    s_add_u32 s61, s10, 54272
    buffer_load_dwordx4 v239, s[40:43], s61 offen sc1 lds
    v_permlane16_swap_b32 v26, v42
    v_permlane16_swap_b32 v90, v106
    v_permlane16_swap_b32 v154, v170
    v_permlane16_swap_b32 v58, v74
    v_permlane16_swap_b32 v122, v138
    v_permlane16_swap_b32 v6, v8
    v_permlane32_swap_b32 v26, v58
    v_permlane32_swap_b32 v90, v122
    v_permlane32_swap_b32 v154, v6
    v_permlane32_swap_b32 v42, v74
    v_permlane32_swap_b32 v106, v138
    v_permlane32_swap_b32 v170, v8
    s_waitcnt lgkmcnt(0)
    v_perm_b32 v176, v26, v26, v224
    s_add_u32 m0, s81, 32768
    s_add_u32 s61, s10, 55296
    buffer_load_dwordx4 v239, s[40:43], s61 offen sc1 lds
    v_perm_b32 v177, v26, v26, v225
    v_perm_b32 v178, v26, v26, v226
    v_perm_b32 v179, v26, v26, v227
    v_perm_b32 v180, v42, v42, v224
    v_perm_b32 v181, v42, v42, v225
    v_perm_b32 v182, v42, v42, v226
    v_perm_b32 v183, v42, v42, v227
    v_mfma_f32_16x16x32_bf16 v[28:31], a[0:3], v[176:179], 0
    v_mfma_f32_16x16x32_bf16 v[22:25], a[22:25], v[176:179], 0
    v_perm_b32 v184, v58, v58, v224
    v_perm_b32 v185, v58, v58, v225
    v_perm_b32 v186, v58, v58, v226
    v_perm_b32 v187, v58, v58, v227
    v_mfma_f32_16x16x32_bf16 v[44:47], a[2:5], v[180:183], 0
    v_mfma_f32_16x16x32_bf16 v[38:41], a[24:27], v[180:183], 0
    v_perm_b32 v188, v74, v74, v224
    v_perm_b32 v189, v74, v74, v225
    v_perm_b32 v190, v74, v74, v226
    v_perm_b32 v191, v74, v74, v227
    v_mfma_f32_16x16x32_bf16 v[60:63], a[4:7], v[184:187], 0
    v_mfma_f32_16x16x32_bf16 v[54:57], a[26:29], v[184:187], 0
    s_add_u32 m0, s81, 36864
    s_add_u32 s61, s10, 56320
    buffer_load_dwordx4 v239, s[40:43], s61 offen sc1 lds
    v_cvt_pk_bf16_f32 v16, v28, v29
    v_cvt_pk_bf16_f32 v17, v30, v31
    v_cvt_pk_bf16_f32 v26, v22, v23
    v_cvt_pk_bf16_f32 v27, v24, v25
    s_add_u32 s61, s17, 0
    buffer_store_dwordx2 v[26:27], v234, s[32:35], s61 offen sc1
    v_perm_b32 v192, v90, v90, v224
    v_perm_b32 v193, v90, v90, v225
    v_perm_b32 v194, v90, v90, v226
    v_perm_b32 v195, v90, v90, v227
    v_mfma_f32_16x16x32_bf16 v[76:79], a[6:9], v[188:191], 0
    v_mfma_f32_16x16x32_bf16 v[70:73], a[28:31], v[188:191], 0
    v_cvt_pk_bf16_f32 v18, v44, v45
    v_cvt_pk_bf16_f32 v19, v46, v47
    v_cvt_pk_bf16_f32 v42, v38, v39
    v_cvt_pk_bf16_f32 v43, v40, v41
    s_add_u32 s61, s17, 69632
    buffer_store_dwordx2 v[42:43], v234, s[32:35], s61 offen sc1
    v_permlane32_swap_b32 v16, v18
    s_add_u32 m0, s81, 40960
    s_add_u32 s61, s10, 57344
    buffer_load_dwordx4 v239, s[40:43], s61 offen sc1 lds
    v_permlane32_swap_b32 v17, v19
    s_add_u32 s61, s16, 0
    buffer_store_dwordx4 v[16:19], v233, s[32:35], s61 offen sc1
    v_perm_b32 v196, v106, v106, v224
    v_perm_b32 v197, v106, v106, v225
    v_perm_b32 v198, v106, v106, v226
    v_perm_b32 v199, v106, v106, v227
    v_mfma_f32_16x16x32_bf16 v[92:95], a[8:11], v[192:195], 0
    v_mfma_f32_16x16x32_bf16 v[86:89], a[30:33], v[192:195], 0
    v_cvt_pk_bf16_f32 v48, v60, v61
    v_cvt_pk_bf16_f32 v49, v62, v63
    v_cvt_pk_bf16_f32 v58, v54, v55
    v_cvt_pk_bf16_f32 v59, v56, v57
    s_add_u32 s61, s17, 139264
    buffer_store_dwordx2 v[58:59], v234, s[32:35], s61 offen sc1
    v_perm_b32 v200, v122, v122, v224
    v_perm_b32 v201, v122, v122, v225
    v_perm_b32 v202, v122, v122, v226
    v_perm_b32 v203, v122, v122, v227
    s_add_u32 m0, s81, 45056
    s_add_u32 s61, s10, 58368
    buffer_load_dwordx4 v239, s[40:43], s61 offen sc1 lds
    v_mfma_f32_16x16x32_bf16 v[108:111], a[10:13], v[196:199], 0
    v_mfma_f32_16x16x32_bf16 v[102:105], a[32:35], v[196:199], 0
    v_cvt_pk_bf16_f32 v50, v76, v77
    v_cvt_pk_bf16_f32 v51, v78, v79
    v_cvt_pk_bf16_f32 v74, v70, v71
    v_cvt_pk_bf16_f32 v75, v72, v73
    s_add_u32 s61, s17, 208896
    buffer_store_dwordx2 v[74:75], v234, s[32:35], s61 offen sc1
    v_permlane32_swap_b32 v48, v50
    v_permlane32_swap_b32 v49, v51
    s_add_u32 s61, s16, 139264
    buffer_store_dwordx4 v[48:51], v233, s[32:35], s61 offen sc1
    v_perm_b32 v204, v138, v138, v224
    v_perm_b32 v205, v138, v138, v225
    v_perm_b32 v206, v138, v138, v226
    v_perm_b32 v207, v138, v138, v227
    v_mfma_f32_16x16x32_bf16 v[124:127], a[12:15], v[200:203], 0
    s_add_u32 m0, s81, 49152
    s_add_u32 s61, s10, 59392
    buffer_load_dwordx4 v239, s[40:43], s61 offen sc1 lds
    v_mfma_f32_16x16x32_bf16 v[118:121], a[34:37], v[200:203], 0
    v_cvt_pk_bf16_f32 v80, v92, v93
    v_cvt_pk_bf16_f32 v81, v94, v95
    v_cvt_pk_bf16_f32 v90, v86, v87
    v_cvt_pk_bf16_f32 v91, v88, v89
    s_add_u32 s61, s17, 278528
    buffer_store_dwordx2 v[90:91], v234, s[32:35], s61 offen sc1
    v_perm_b32 v208, v154, v154, v224
    v_perm_b32 v209, v154, v154, v225
    v_perm_b32 v210, v154, v154, v226
    v_perm_b32 v211, v154, v154, v227
    v_mfma_f32_16x16x32_bf16 v[140:143], a[14:17], v[204:207], 0
    v_mfma_f32_16x16x32_bf16 v[134:137], a[36:39], v[204:207], 0
    v_cvt_pk_bf16_f32 v82, v108, v109
    v_cvt_pk_bf16_f32 v83, v110, v111
    v_cvt_pk_bf16_f32 v106, v102, v103
    v_cvt_pk_bf16_f32 v107, v104, v105
    s_add_u32 s61, s17, 348160
    buffer_store_dwordx2 v[106:107], v234, s[32:35], s61 offen sc1
    s_add_u32 m0, s81, 53248
    s_add_u32 s61, s10, 60416
    buffer_load_dwordx4 v239, s[40:43], s61 offen sc1 lds
    v_permlane32_swap_b32 v80, v82
    v_permlane32_swap_b32 v81, v83
    s_add_u32 s61, s16, 278528
    buffer_store_dwordx4 v[80:83], v233, s[32:35], s61 offen sc1
    v_perm_b32 v212, v170, v170, v224
    v_perm_b32 v213, v170, v170, v225
    v_perm_b32 v214, v170, v170, v226
    v_perm_b32 v215, v170, v170, v227
    v_mfma_f32_16x16x32_bf16 v[156:159], a[16:19], v[208:211], 0
    v_mfma_f32_16x16x32_bf16 v[150:153], a[38:41], v[208:211], 0
    v_cvt_pk_bf16_f32 v112, v124, v125
    v_cvt_pk_bf16_f32 v113, v126, v127
    v_cvt_pk_bf16_f32 v122, v118, v119
    v_cvt_pk_bf16_f32 v123, v120, v121
    s_add_u32 s61, s17, 417792
    buffer_store_dwordx2 v[122:123], v234, s[32:35], s61 offen sc1
    v_mfma_f32_16x16x32_bf16 v[172:175], a[18:21], v[212:215], 0
    s_waitcnt vmcnt(17)
    v_cmp_le_u32 vcc, 1, v243
    s_nop 0
    s_andn2_b32 s84, 0x7, vcc_lo
    s_cbranch_scc1 L_retry43
L_ok43:
    s_mul_i32 s51, s4, 69632
    s_add_u32 s62, s51, s12
    buffer_load_dwordx4 a[44:47], v239, s[32:35], s62 offen offset:0 sc1
    v_mfma_f32_16x16x32_bf16 v[166:169], a[40:43], v[212:215], 0
    s_nop 5
    v_cvt_pk_bf16_f32 v114, v140, v141
    v_cvt_pk_bf16_f32 v115, v142, v143
    v_cvt_pk_bf16_f32 v138, v134, v135
    v_cvt_pk_bf16_f32 v139, v136, v137
    s_add_u32 s61, s17, 487424
    buffer_store_dwordx2 v[138:139], v234, s[32:35], s61 offen sc1
    v_permlane32_swap_b32 v112, v114
    v_permlane32_swap_b32 v113, v115
    s_add_u32 s61, s16, 417792
    buffer_store_dwordx4 v[112:115], v233, s[32:35], s61 offen sc1
    s_nop 5
    buffer_load_dwordx4 a[48:51], v239, s[32:35], s62 offen offset:1024 sc1
    v_cvt_pk_bf16_f32 v144, v156, v157
    v_cvt_pk_bf16_f32 v145, v158, v159
    v_cvt_pk_bf16_f32 v154, v150, v151
    v_cvt_pk_bf16_f32 v155, v152, v153
    s_add_u32 s61, s17, 557056
    buffer_store_dwordx2 v[154:155], v234, s[32:35], s61 offen sc1
    s_nop 5
    v_cvt_pk_bf16_f32 v146, v172, v173
    v_cvt_pk_bf16_f32 v147, v174, v175
    v_cvt_pk_bf16_f32 v170, v166, v167
    v_cvt_pk_bf16_f32 v171, v168, v169
    s_add_u32 s61, s17, 626688
    buffer_store_dwordx2 v[170:171], v234, s[32:35], s61 offen sc1
    v_permlane32_swap_b32 v144, v146
    v_permlane32_swap_b32 v145, v147
    buffer_load_dwordx4 a[52:55], v239, s[32:35], s62 offen offset:2048 sc1
    s_add_u32 s61, s16, 557056
    buffer_store_dwordx4 v[144:147], v233, s[32:35], s61 offen sc1
    v_add_u32_e64 v240, s81, v239
    v_mov_b32 v241, 163584
    s_lshl_b32 s19, 1, s44
    v_subrev_u32 v250, 0, v240
    s_add_u32 s55, s55, s56
    s_and_b32 s58, s55, 3
    s_add_u32 s58, s58, s57
    s_mul_i32 s59, s58, 43
    s_lshr_b32 s59, s59, 7
    s_bfe_u32 s60, s55, 0x20002
    s_mul_i32 s47, s59, 6144
    s_lshl_b32 s53, s60, 7
    s_add_u32 s47, s47, s53
    s_cmp_lt_u32 s58, 30
    s_cselect_b32 s53, 3, 2
    s_mul_i32 s60, s60, s53
    s_mul_i32 s6, s59, 9
    s_add_u32 s6, s6, s58
    s_add_u32 s6, s6, s60
    v_mov_b32_e64 v243, 0
    s_nop 0
    buffer_load_dword v243, v242, s[68:71], s46 offen sc1
    buffer_load_dwordx4 a[56:59], v239, s[32:35], s62 offen offset:3072 sc1
    s_add_u32 s62, s62, 4096
    buffer_load_dwordx4 a[60:63], v239, s[32:35], s62 offen offset:0 sc1
    buffer_load_dwordx4 a[64:67], v239, s[32:35], s62 offen offset:1024 sc1
    buffer_load_dwordx4 a[68:71], v239, s[32:35], s62 offen offset:2048 sc1
    buffer_load_dwordx4 a[72:75], v239, s[32:35], s62 offen offset:3072 sc1
    s_add_u32 s62, s62, 4096
    buffer_load_dwordx4 a[76:79], v239, s[32:35], s62 offen offset:0 sc1
    buffer_load_dwordx4 a[0:3], v239, s[40:43], s63 offen offset:1024 sc1
    buffer_load_dwordx4 a[4:7], v239, s[40:43], s63 offen offset:2048 sc1
    buffer_load_dwordx4 a[8:11], v239, s[40:43], s63 offen offset:3072 sc1
    s_add_u32 s63, s10, 45056
    buffer_load_dwordx4 a[12:15], v239, s[40:43], s63 offen offset:0 sc1
    buffer_load_dwordx4 a[80:83], v239, s[32:35], s62 offen offset:1024 sc1
    buffer_load_dwordx4 a[16:19], v239, s[40:43], s63 offen offset:1024 sc1
    s_waitcnt vmcnt(20)
    v_mfma_f32_16x16x32_bf16 v[132:135], a[120:123], a[44:47], 0
    s_add_u32 s55, s55, s56
    s_and_b32 s58, s55, 3
    s_add_u32 s58, s58, s57
    v_mfma_f32_16x16x32_bf16 v[136:139], a[124:127], a[44:47], 0
    s_mul_i32 s59, s58, 43
    s_lshr_b32 s59, s59, 7
    s_bfe_u32 s60, s55, 0x20002
    v_mfma_f32_16x16x32_bf16 v[140:143], a[128:131], a[44:47], 0
    s_mul_i32 s48, s59, 6144
    s_lshl_b32 s53, s60, 7
    s_add_u32 s48, s48, s53
    v_mfma_f32_16x16x32_bf16 v[144:147], a[132:135], a[44:47], 0
    s_cmp_lt_u32 s58, 30
    s_cselect_b32 s53, 3, 2
    s_mul_i32 s60, s60, s53
    v_mfma_f32_16x16x32_bf16 v[148:151], a[136:139], a[44:47], 0
    s_waitcnt vmcnt(17)
    s_mul_i32 s7, s59, 9
    s_add_u32 s7, s7, s58
    v_mfma_f32_16x16x32_bf16 v[132:135], a[140:143], a[48:51], v[132:135]
    s_add_u32 s7, s7, s60
    v_lshlrev_b32 v248, 7, v255
    s_mul_i32 s59, s4, 205
    v_mfma_f32_16x16x32_bf16 v[136:139], a[144:147], a[48:51], v[136:139]
    s_lshr_b32 s59, s59, 11
    s_lshl_b32 s59, s59, 10
    s_lshl_b32 s60, s44, 8
    v_mfma_f32_16x16x32_bf16 v[140:143], a[148:151], a[48:51], v[140:143]
    s_add_u32 s59, s59, s60
    s_add_u32 s59, s59, 67584
    v_add_u32_e64 v245, s59, v248
    v_mfma_f32_16x16x32_bf16 v[144:147], a[152:155], a[48:51], v[144:147]
    s_mul_i32 s59, s5, 205
    s_lshr_b32 s59, s59, 11
    s_lshl_b32 s59, s59, 10
    v_mfma_f32_16x16x32_bf16 v[148:151], a[156:159], a[48:51], v[148:151]
    s_waitcnt vmcnt(14)
    s_lshl_b32 s60, s44, 8
    s_add_u32 s59, s59, s60
    v_mfma_f32_16x16x32_bf16 v[132:135], a[160:163], a[52:55], v[132:135]
    s_add_u32 s59, s59, 67328
    v_cmp_le_u32 s[8:9], 2, v255
    v_add_u32 v246, s59, v248
    v_mfma_f32_16x16x32_bf16 v[136:139], a[164:167], a[52:55], v[136:139]
    s_nop 0
    v_cndmask_b32 v245, v245, v246, s[8:9]
    s_mul_i32 s59, s6, 205
    v_mfma_f32_16x16x32_bf16 v[140:143], a[168:171], a[52:55], v[140:143]
    s_lshr_b32 s59, s59, 11
    s_lshl_b32 s59, s59, 10
    s_lshl_b32 s60, s44, 8
    v_mfma_f32_16x16x32_bf16 v[144:147], a[172:175], a[52:55], v[144:147]
    s_add_u32 s59, s59, s60
    s_add_u32 s59, s59, 67072
    v_cmp_le_u32 s[8:9], 4, v255
    v_mfma_f32_16x16x32_bf16 v[148:151], a[176:179], a[52:55], v[148:151]
    s_waitcnt vmcnt(11)
    v_add_u32 v246, s59, v248
    s_nop 0
    v_mfma_f32_16x16x32_bf16 v[132:135], a[180:183], a[56:59], v[132:135]
    buffer_load_dwordx4 a[84:87], v239, s[32:35], s62 offen offset:2048 sc1
    v_mfma_f32_16x16x32_bf16 v[136:139], a[184:187], a[56:59], v[136:139]
    v_cndmask_b32 v245, v245, v246, s[8:9]
    s_mul_i32 s59, s7, 205
    s_lshr_b32 s59, s59, 11
    s_mov_b64 exec, 1
    v_mov_b32_e64 v253, s19
    ds_or_rtn_b32 v253, v241, v253 offset:0
    s_mov_b64 exec, -1
    v_mfma_f32_16x16x32_bf16 v[140:143], a[188:191], a[56:59], v[140:143]
    s_lshl_b32 s59, s59, 10
    s_lshl_b32 s60, s44, 8
    s_add_u32 s59, s59, s60
    v_mfma_f32_16x16x32_bf16 v[144:147], a[192:195], a[56:59], v[144:147]
    s_add_u32 s59, s59, 66816
    v_cmp_le_u32 s[8:9], 6, v255
    v_add_u32_e64 v246, s59, v248
    v_mfma_f32_16x16x32_bf16 v[148:151], a[196:199], a[56:59], v[148:151]
    s_waitcnt vmcnt(11)
    s_nop 0
    v_cndmask_b32 v245, v245, v246, s[8:9]
    v_mfma_f32_16x16x32_bf16 v[132:135], a[200:203], a[60:63], v[132:135]
    buffer_load_dwordx4 a[88:91], v239, s[32:35], s62 offen offset:3072 sc1
    v_mfma_f32_16x16x32_bf16 v[136:139], a[204:207], a[60:63], v[136:139]
    v_cmp_le_u32_e64 vcc, 1, v243
    v_cmp_le_u32 s[8:9], 8, v255
    v_mfma_f32_16x16x32_bf16 v[140:143], a[208:211], a[60:63], v[140:143]
    s_andn2_b32 s84, 0x7, vcc_lo
    s_cbranch_scc1 L_retry44
L_ok44:
    v_mov_b32 v246, 0x40000000
    s_waitcnt lgkmcnt(0)
    v_readfirstlane_b32 s84, v253
    v_mov_b32_e64 v253, 1
    s_or_b32 s84, s84, s19
    s_cmp_lg_u32 s84, 15
    s_cbranch_scc1 L_pb45
    buffer_store_dword v253, v252, s[68:71], s18 offen offset:0 sc1
    L_pb45:
    v_mfma_f32_16x16x32_bf16 v[144:147], a[212:215], a[60:63], v[144:147]
    s_mul_i32 s51, s5, 69632
    ds_read_b128 a[20:23], v240 offset:0
    v_mfma_f32_16x16x32_bf16 v[148:151], a[216:219], a[60:63], v[148:151]
    s_waitcnt vmcnt(11)
    s_add_u32 s62, s51, s12
    s_nop 0
    v_mfma_f32_16x16x32_bf16 v[132:135], a[220:223], a[64:67], v[132:135]
    buffer_load_dwordx4 a[44:47], v239, s[32:35], s62 offen offset:0 sc1
    v_mfma_f32_16x16x32_bf16 v[136:139], a[224:227], a[64:67], v[136:139]
    ds_read_b128 a[24:27], v240 offset:4096
    v_cndmask_b32 v245, v245, v246, s[8:9]
    v_mfma_f32_16x16x32_bf16 v[140:143], a[228:231], a[64:67], v[140:143]
    ds_read_b128 a[28:31], v240 offset:8192
    v_mov_b32 v246, 0
    v_mfma_f32_16x16x32_bf16 v[144:147], a[232:235], a[64:67], v[144:147]
    ds_read_b128 a[32:35], v240 offset:12288
    s_lshl_b32 s13, s44, 12
    v_mfma_f32_16x16x32_bf16 v[148:151], a[236:239], a[64:67], v[148:151]
    s_waitcnt vmcnt(11)
    ds_read_b128 a[36:39], v240 offset:16384
    v_mfma_f32_16x16x32_bf16 v[132:135], a[240:243], a[68:71], v[132:135]
    s_add_u32 s63, s11, 0
    buffer_load_dwordx4 v[32:35], v239, s[40:43], s63 offen offset:0 sc1
    v_mfma_f32_16x16x32_bf16 v[136:139], a[244:247], a[68:71], v[136:139]
    ds_read_b128 a[40:43], v240 offset:20480
    s_lshl_b32 s14, s44, 10
    v_mfma_f32_16x16x32_bf16 v[140:143], a[248:251], a[68:71], v[140:143]
    ds_read_b128 v[0:3], v240 offset:24576
    s_add_u32 s14, s14, 16384
    v_mfma_f32_16x16x32_bf16 v[144:147], a[252:255], a[68:71], v[144:147]
    ds_read_b128 v[4:7], v240 offset:28672
    v_lshrrev_b32_e64 v248, 4, v255
    v_mfma_f32_16x16x32_bf16 v[148:151], a[92:95], a[68:71], v[148:151]
    s_waitcnt vmcnt(11)
    ds_read_b128 v[8:11], v240 offset:32768
    v_mfma_f32_16x16x32_bf16 v[132:135], a[96:99], a[72:75], v[132:135]
    buffer_load_dwordx4 v[36:39], v239, s[40:43], s63 offen offset:1024 sc1
    v_mfma_f32_16x16x32_bf16 v[136:139], a[100:103], a[72:75], v[136:139]
    ds_read_b128 v[12:15], v240 offset:36864
    v_lshlrev_b32 v248, 8, v248
    v_mfma_f32_16x16x32_bf16 v[140:143], a[104:107], a[72:75], v[140:143]
    ds_read_b128 v[16:19], v240 offset:40960
    v_and_b32_e64 v244, 15, v255
    v_mfma_f32_16x16x32_bf16 v[144:147], a[108:111], a[72:75], v[144:147]
    ds_read_b128 v[20:23], v240 offset:45056
    v_lshl_add_u32 v244, v244, 3, v248
    v_mfma_f32_16x16x32_bf16 v[148:151], a[112:115], a[72:75], v[148:151]
    s_waitcnt vmcnt(11)
    ds_read_b128 v[24:27], v240 offset:49152
    v_mfma_f32_16x16x32_bf16 v[132:135], a[116:119], a[76:79], v[132:135]
    s_waitcnt vmcnt(10)
    buffer_load_dwordx4 v[40:43], v239, s[40:43], s63 offen offset:2048 sc1
    v_mfma_f32_16x16x32_bf16 v[136:139], a[0:3], a[76:79], v[136:139]
    s_waitcnt vmcnt(10)
    buffer_load_dwordx4 a[48:51], v239, s[32:35], s62 offen offset:1024 sc1
    v_mfma_f32_16x16x32_bf16 v[140:143], a[4:7], a[76:79], v[140:143]
    s_waitcnt vmcnt(10)
    buffer_load_dwordx4 v[44:47], v239, s[40:43], s63 offen offset:3072 sc1
    v_mfma_f32_16x16x32_bf16 v[144:147], a[8:11], a[76:79], v[144:147]
    s_waitcnt vmcnt(10)
    s_add_u32 s63, s11, 4096
    buffer_load_dwordx4 v[48:51], v239, s[40:43], s63 offen offset:0 sc1
    v_mfma_f32_16x16x32_bf16 v[148:151], a[12:15], a[76:79], v[148:151]
    s_waitcnt vmcnt(9)
    ds_read_b128 v[28:31], v240 offset:53248
    v_mfma_f32_16x16x32_bf16 v[132:135], a[16:19], a[80:83], v[132:135]
    s_waitcnt lgkmcnt(13)
    buffer_load_dwordx4 a[52:55], v239, s[32:35], s62 offen offset:2048 sc1
    v_mfma_f32_16x16x32_bf16 v[136:139], a[20:23], a[80:83], v[136:139]
    s_waitcnt lgkmcnt(12)
    buffer_load_dwordx4 v[52:55], v239, s[40:43], s63 offen offset:1024 sc1
    v_mfma_f32_16x16x32_bf16 v[140:143], a[24:27], a[80:83], v[140:143]
    s_waitcnt lgkmcnt(11)
    buffer_load_dwordx4 v[56:59], v239, s[40:43], s63 offen offset:2048 sc1
    v_mfma_f32_16x16x32_bf16 v[144:147], a[28:31], a[80:83], v[144:147]
    s_waitcnt lgkmcnt(10)
    v_mov_b32 v243, 0
    v_and_b32 v249, 15, v255
    v_mfma_f32_16x16x32_bf16 v[148:151], a[32:35], a[80:83], v[148:151]
    s_waitcnt vmcnt(11) lgkmcnt(9)
    v_lshlrev_b32_e64 v249, 2, v249
    s_lshl_b32 s59, s44, 13
    v_mfma_f32_16x16x32_bf16 v[132:135], a[36:39], a[84:87], v[132:135]
    s_waitcnt lgkmcnt(8)
    buffer_load_dword v243, v242, s[68:71], s47 offen sc1
    v_mfma_f32_16x16x32_bf16 v[136:139], a[40:43], a[84:87], v[136:139]
    s_waitcnt lgkmcnt(7)
    buffer_load_dwordx4 a[56:59], v239, s[32:35], s62 offen offset:3072 sc1
    v_mfma_f32_16x16x32_bf16 v[140:143], v[0:3], a[84:87], v[140:143]
    s_waitcnt lgkmcnt(6)
    v_add_u32 v249, s59, v249
    s_mul_i32 s59, s44, 5376
    s_add_u32 s59, s59, 0
    v_mfma_f32_16x16x32_bf16 v[144:147], v[4:7], a[84:87], v[144:147]
    s_waitcnt lgkmcnt(5)
    v_bfe_u32 v248, v255, 4, 1
    v_mul_u32_u24 v248, 2624, v248
    v_mfma_f32_16x16x32_bf16 v[148:151], v[8:11], a[84:87], v[148:151]
    s_waitcnt vmcnt(12) lgkmcnt(4)
    v_and_b32 v232, 15, v255
    v_mul_u32_u24 v232, 160, v232
    v_mfma_f32_16x16x32_bf16 v[132:135], v[12:15], a[88:91], v[132:135]
    s_waitcnt lgkmcnt(3)
    buffer_load_dwordx4 v[60:63], v239, s[40:43], s63 offen offset:3072 sc1
    v_mfma_f32_16x16x32_bf16 v[136:139], v[16:19], a[88:91], v[136:139]
    s_waitcnt lgkmcnt(2)
    v_add3_u32 v232, v248, v232, s59
    v_lshrrev_b32_e64 v248, 5, v255
    v_mfma_f32_16x16x32_bf16 v[140:143], v[20:23], a[88:91], v[140:143]
    s_waitcnt lgkmcnt(1)
    v_lshl_add_u32 v232, v248, 4, v232
    v_add_u32 v233, 0xaa00, v232
    v_mfma_f32_16x16x32_bf16 v[144:147], v[24:27], a[88:91], v[144:147]
    s_waitcnt lgkmcnt(0)
    v_mul_u32_u24 v248, 205, v255
    v_lshrrev_b32_e64 v248, 11, v248
    v_mfma_f32_16x16x32_bf16 v[148:151], v[28:31], a[88:91], v[148:151]
    s_waitcnt vmcnt(12)
    v_mul_u32_u24 v247, 10, v248
    v_sub_u32_e64 v247, v255, v247
    v_mfma_f32_16x16x32_bf16 v[152:155], a[120:123], a[44:47], 0
    s_add_u32 s63, s11, 8192
    buffer_load_dwordx4 v[64:67], v239, s[40:43], s63 offen offset:0 sc1
    v_mfma_f32_16x16x32_bf16 v[156:159], a[124:127], a[44:47], 0
    s_add_u32 s62, s62, 4096
    s_lshl_b32 s59, s44, 2
    v_add_u32 v248, s59, v248
    v_mfma_f32_16x16x32_bf16 v[160:163], a[128:131], a[44:47], 0
    buffer_load_dwordx4 a[60:63], v239, s[32:35], s62 offen offset:0 sc1
    v_mfma_f32_16x16x32_bf16 v[164:167], a[132:135], a[44:47], 0
    buffer_load_dwordx4 v[68:71], v239, s[40:43], s63 offen offset:1024 sc1
    v_mfma_f32_16x16x32_bf16 v[168:171], a[136:139], a[44:47], 0
    s_waitcnt vmcnt(11)
    v_and_b32 v248, 15, v248
    s_mul_i32 s59, s44, 640
    v_mfma_f32_16x16x32_bf16 v[152:155], a[140:143], a[48:51], v[152:155]
    buffer_load_dwordx4 v[72:75], v239, s[40:43], s63 offen offset:2048 sc1
    v_mfma_f32_16x16x32_bf16 v[156:159], a[144:147], a[48:51], v[156:159]
    buffer_load_dwordx4 a[64:67], v239, s[32:35], s62 offen offset:1024 sc1
    v_mfma_f32_16x16x32_bf16 v[160:163], a[148:151], a[48:51], v[160:163]
    buffer_load_dwordx4 v[76:79], v239, s[40:43], s63 offen offset:3072 sc1
    v_mfma_f32_16x16x32_bf16 v[164:167], a[152:155], a[48:51], v[164:167]
    s_add_u32 s59, s59, 0
    v_add_u32 v234, s59, v239
    v_add_u32 v235, 0xaa00, v234
    v_mfma_f32_16x16x32_bf16 v[168:171], a[156:159], a[48:51], v[168:171]
    s_waitcnt vmcnt(11)
    v_lshlrev_b32 v247, 4, v247
    v_mul_u32_u24 v248, 1280, v248
    v_mfma_f32_16x16x32_bf16 v[152:155], a[160:163], a[52:55], v[152:155]
    s_add_u32 s63, s11, 12288
    buffer_load_dwordx4 v[80:83], v239, s[40:43], s63 offen offset:0 sc1
    v_mfma_f32_16x16x32_bf16 v[156:159], a[164:167], a[52:55], v[156:159]
    buffer_load_dwordx4 a[68:71], v239, s[32:35], s62 offen offset:2048 sc1
    v_mfma_f32_16x16x32_bf16 v[160:163], a[168:171], a[52:55], v[160:163]
    buffer_load_dwordx4 v[84:87], v239, s[40:43], s63 offen offset:1024 sc1
    v_mfma_f32_16x16x32_bf16 v[164:167], a[172:175], a[52:55], v[164:167]
    v_add_u32_e64 v247, v247, v248
    v_cmp_gt_u32 s[8:9], 40, v255
    v_mfma_f32_16x16x32_bf16 v[168:171], a[176:179], a[52:55], v[168:171]
    s_waitcnt vmcnt(10)
    v_mov_b32 v248, 0x40000000
    s_mul_i32 s15, s54, 160
    v_mfma_f32_16x16x32_bf16 v[152:155], a[180:183], a[56:59], v[152:155]
    buffer_load_dwordx4 v[88:91], v239, s[40:43], s63 offen offset:2048 sc1
    v_mfma_f32_16x16x32_bf16 v[156:159], a[184:187], a[56:59], v[156:159]
    buffer_load_dwordx4 a[72:75], v239, s[32:35], s62 offen offset:3072 sc1
    v_mfma_f32_16x16x32_bf16 v[160:163], a[188:191], a[56:59], v[160:163]
    buffer_load_dwordx4 v[92:95], v239, s[40:43], s63 offen offset:3072 sc1
    v_mfma_f32_16x16x32_bf16 v[164:167], a[192:195], a[56:59], v[164:167]
    v_cndmask_b32 v247, v248, v247, s[8:9]
    v_mfma_f32_16x16x32_bf16 v[168:171], a[196:199], a[56:59], v[168:171]
    s_waitcnt vmcnt(10)
    v_mfma_f32_16x16x32_bf16 v[152:155], a[200:203], a[60:63], v[152:155]
    s_add_u32 s63, s11, 16384
    buffer_load_dwordx4 v[96:99], v239, s[40:43], s63 offen offset:0 sc1
    v_mfma_f32_16x16x32_bf16 v[156:159], a[204:207], a[60:63], v[156:159]
    s_add_u32 s62, s62, 4096
    v_mfma_f32_16x16x32_bf16 v[160:163], a[208:211], a[60:63], v[160:163]
    buffer_load_dwordx4 a[76:79], v239, s[32:35], s62 offen offset:0 sc1
    v_mfma_f32_16x16x32_bf16 v[164:167], a[212:215], a[60:63], v[164:167]
    buffer_load_dwordx4 v[100:103], v239, s[40:43], s63 offen offset:1024 sc1
    v_mfma_f32_16x16x32_bf16 v[168:171], a[216:219], a[60:63], v[168:171]
    s_waitcnt vmcnt(10)
    v_mfma_f32_16x16x32_bf16 v[152:155], a[220:223], a[64:67], v[152:155]
    buffer_load_dwordx4 v[104:107], v239, s[40:43], s63 offen offset:2048 sc1
    v_mfma_f32_16x16x32_bf16 v[156:159], a[224:227], a[64:67], v[156:159]
    buffer_load_dwordx4 a[80:83], v239, s[32:35], s62 offen offset:1024 sc1
    v_mfma_f32_16x16x32_bf16 v[160:163], a[228:231], a[64:67], v[160:163]
    buffer_load_dwordx4 v[108:111], v239, s[40:43], s63 offen offset:3072 sc1
    v_mfma_f32_16x16x32_bf16 v[164:167], a[232:235], a[64:67], v[164:167]
    s_add_u32 s63, s3, 0
    buffer_load_dwordx4 v[112:115], v239, s[40:43], s63 offen offset:0 sc1
    v_mfma_f32_16x16x32_bf16 v[168:171], a[236:239], a[64:67], v[168:171]
    s_waitcnt vmcnt(11)
    v_mfma_f32_16x16x32_bf16 v[152:155], a[240:243], a[68:71], v[152:155]
    buffer_load_dwordx4 a[84:87], v239, s[32:35], s62 offen offset:2048 sc1
    v_mfma_f32_16x16x32_bf16 v[156:159], a[244:247], a[68:71], v[156:159]
    buffer_load_dwordx4 v[116:119], v239, s[40:43], s63 offen offset:1024 sc1
    v_mfma_f32_16x16x32_bf16 v[160:163], a[248:251], a[68:71], v[160:163]
    v_mfma_f32_16x16x32_bf16 v[164:167], a[252:255], a[68:71], v[164:167]
    buffer_load_dwordx4 v[120:123], v239, s[40:43], s63 offen offset:2048 sc1
    v_mfma_f32_16x16x32_bf16 v[168:171], a[92:95], a[68:71], v[168:171]
    s_waitcnt vmcnt(11)
    v_mfma_f32_16x16x32_bf16 v[152:155], a[96:99], a[72:75], v[152:155]
    buffer_load_dwordx4 a[88:91], v239, s[32:35], s62 offen offset:3072 sc1
    v_mfma_f32_16x16x32_bf16 v[156:159], a[100:103], a[72:75], v[156:159]
    buffer_load_dwordx4 v[124:127], v239, s[40:43], s63 offen offset:3072 sc1
    v_mfma_f32_16x16x32_bf16 v[160:163], a[104:107], a[72:75], v[160:163]
    v_mfma_f32_16x16x32_bf16 v[164:167], a[108:111], a[72:75], v[164:167]
    s_add_u32 s63, s3, 4096
    buffer_load_dwordx4 v[128:131], v239, s[40:43], s63 offen offset:0 sc1
    v_mfma_f32_16x16x32_bf16 v[168:171], a[112:115], a[72:75], v[168:171]
    s_waitcnt vmcnt(11)
    v_cmp_le_u32_e64 vcc, 1, v243
    v_mfma_f32_16x16x32_bf16 v[152:155], a[116:119], a[76:79], v[152:155]
    s_andn2_b32 s84, 0x7, vcc_lo
    s_cbranch_scc1 L_retry46
L_ok46:
    s_barrier
    v_mfma_f32_16x16x32_bf16 v[156:159], a[0:3], a[76:79], v[156:159]
    s_mul_i32 s51, s6, 69632
    v_mfma_f32_16x16x32_bf16 v[160:163], a[4:7], a[76:79], v[160:163]
    s_add_u32 s62, s51, s12
    v_mfma_f32_16x16x32_bf16 v[164:167], a[8:11], a[76:79], v[164:167]
    buffer_load_dwordx4 a[44:47], v239, s[32:35], s62 offen offset:0 sc1
    v_mfma_f32_16x16x32_bf16 v[168:171], a[12:15], a[76:79], v[168:171]
    s_waitcnt vmcnt(9)
    v_mfma_f32_16x16x32_bf16 v[152:155], a[16:19], a[80:83], v[152:155]
    buffer_load_dwordx4 a[48:51], v239, s[32:35], s62 offen offset:1024 sc1
    v_mfma_f32_16x16x32_bf16 v[156:159], a[20:23], a[80:83], v[156:159]
    buffer_load_dwordx4 a[52:55], v239, s[32:35], s62 offen offset:2048 sc1
    v_mfma_f32_16x16x32_bf16 v[160:163], a[24:27], a[80:83], v[160:163]
    v_mov_b32 v243, 0
    v_mfma_f32_16x16x32_bf16 v[164:167], a[28:31], a[80:83], v[164:167]
    buffer_load_dword v243, v242, s[68:71], s48 offen sc1
    v_mfma_f32_16x16x32_bf16 v[168:171], a[32:35], a[80:83], v[168:171]
    s_waitcnt vmcnt(9)
    v_mfma_f32_16x16x32_bf16 v[152:155], a[36:39], a[84:87], v[152:155]
    buffer_load_dwordx4 a[56:59], v239, s[32:35], s62 offen offset:3072 sc1
    v_mfma_f32_16x16x32_bf16 v[156:159], a[40:43], a[84:87], v[156:159]
    s_add_u32 s62, s62, 4096
    v_mfma_f32_16x16x32_bf16 v[160:163], v[0:3], a[84:87], v[160:163]
    buffer_load_dwordx4 a[60:63], v239, s[32:35], s62 offen offset:0 sc1
    v_mfma_f32_16x16x32_bf16 v[164:167], v[4:7], a[84:87], v[164:167]
    buffer_load_dwordx4 a[64:67], v239, s[32:35], s62 offen offset:1024 sc1
    v_mfma_f32_16x16x32_bf16 v[168:171], v[8:11], a[84:87], v[168:171]
    s_waitcnt vmcnt(9)
    v_mfma_f32_16x16x32_bf16 v[152:155], v[12:15], a[88:91], v[152:155]
    buffer_load_dwordx4 a[68:71], v239, s[32:35], s62 offen offset:2048 sc1
    v_mfma_f32_16x16x32_bf16 v[156:159], v[16:19], a[88:91], v[156:159]
    buffer_load_dwordx4 a[72:75], v239, s[32:35], s62 offen offset:3072 sc1
    v_mfma_f32_16x16x32_bf16 v[160:163], v[20:23], a[88:91], v[160:163]
    s_add_u32 s62, s62, 4096
    v_mfma_f32_16x16x32_bf16 v[164:167], v[24:27], a[88:91], v[164:167]
    buffer_load_dwordx4 a[76:79], v239, s[32:35], s62 offen offset:0 sc1
    v_mfma_f32_16x16x32_bf16 v[168:171], v[28:31], a[88:91], v[168:171]
    s_waitcnt vmcnt(9)
    v_mfma_f32_16x16x32_bf16 v[172:175], a[120:123], a[44:47], 0
    buffer_load_dwordx4 a[80:83], v239, s[32:35], s62 offen offset:1024 sc1
    v_mfma_f32_16x16x32_bf16 v[176:179], a[124:127], a[44:47], 0
    buffer_load_dwordx4 a[84:87], v239, s[32:35], s62 offen offset:2048 sc1
    v_mfma_f32_16x16x32_bf16 v[180:183], a[128:131], a[44:47], 0
    buffer_load_dwordx4 a[88:91], v239, s[32:35], s62 offen offset:3072 sc1
    v_mfma_f32_16x16x32_bf16 v[184:187], a[132:135], a[44:47], 0
    v_cmp_le_u32 vcc, 1, v243
    v_mfma_f32_16x16x32_bf16 v[188:191], a[136:139], a[44:47], 0
    s_waitcnt vmcnt(11)
    s_andn2_b32 s84, 0x7, vcc_lo
    s_cbranch_scc1 L_retry47
L_ok47:
    v_mfma_f32_16x16x32_bf16 v[172:175], a[140:143], a[48:51], v[172:175]
    s_mul_i32 s51, s7, 69632
    v_mfma_f32_16x16x32_bf16 v[176:179], a[144:147], a[48:51], v[176:179]
    s_add_u32 s62, s51, s12
    v_mfma_f32_16x16x32_bf16 v[180:183], a[148:151], a[48:51], v[180:183]
    buffer_load_dwordx4 a[44:47], v239, s[32:35], s62 offen offset:0 sc1
    v_mfma_f32_16x16x32_bf16 v[184:187], a[152:155], a[48:51], v[184:187]
    v_mfma_f32_16x16x32_bf16 v[188:191], a[156:159], a[48:51], v[188:191]
    s_waitcnt vmcnt(11)
    v_mfma_f32_16x16x32_bf16 v[172:175], a[160:163], a[52:55], v[172:175]
    buffer_load_dwordx4 a[48:51], v239, s[32:35], s62 offen offset:1024 sc1
    v_mfma_f32_16x16x32_bf16 v[176:179], a[164:167], a[52:55], v[176:179]
    v_mfma_f32_16x16x32_bf16 v[180:183], a[168:171], a[52:55], v[180:183]
    v_mfma_f32_16x16x32_bf16 v[184:187], a[172:175], a[52:55], v[184:187]
    v_mfma_f32_16x16x32_bf16 v[188:191], a[176:179], a[52:55], v[188:191]
    s_waitcnt vmcnt(10)
    v_mfma_f32_16x16x32_bf16 v[172:175], a[180:183], a[56:59], v[172:175]
    buffer_load_dwordx4 a[52:55], v239, s[32:35], s62 offen offset:2048 sc1
    v_mfma_f32_16x16x32_bf16 v[176:179], a[184:187], a[56:59], v[176:179]
    v_mfma_f32_16x16x32_bf16 v[180:183], a[188:191], a[56:59], v[180:183]
    v_mfma_f32_16x16x32_bf16 v[184:187], a[192:195], a[56:59], v[184:187]
    v_cmp_le_u32 s[22:23], 1, v246
    v_mfma_f32_16x16x32_bf16 v[188:191], a[196:199], a[56:59], v[188:191]
    s_waitcnt vmcnt(10)
    s_andn2_b32 s84, 0xff, s22
    s_cbranch_scc1 L_ps48
L_pr48:
    v_mfma_f32_16x16x32_bf16 v[172:175], a[200:203], a[60:63], v[172:175]
    buffer_load_dwordx4 a[56:59], v239, s[32:35], s62 offen offset:3072 sc1
    v_mfma_f32_16x16x32_bf16 v[176:179], a[204:207], a[60:63], v[176:179]
    v_mfma_f32_16x16x32_bf16 v[180:183], a[208:211], a[60:63], v[180:183]
    v_mfma_f32_16x16x32_bf16 v[184:187], a[212:215], a[60:63], v[184:187]
    v_mfma_f32_16x16x32_bf16 v[188:191], a[216:219], a[60:63], v[188:191]
    s_waitcnt vmcnt(10)
    s_add_u32 s62, s62, 4096
    v_mfma_f32_16x16x32_bf16 v[172:175], a[220:223], a[64:67], v[172:175]
    buffer_load_dwordx4 a[60:63], v239, s[32:35], s62 offen offset:0 sc1
    v_mfma_f32_16x16x32_bf16 v[176:179], a[224:227], a[64:67], v[176:179]
    v_mfma_f32_16x16x32_bf16 v[180:183], a[228:231], a[64:67], v[180:183]
    v_mfma_f32_16x16x32_bf16 v[184:187], a[232:235], a[64:67], v[184:187]
    v_mfma_f32_16x16x32_bf16 v[188:191], a[236:239], a[64:67], v[188:191]
    s_waitcnt vmcnt(10)
    v_mfma_f32_16x16x32_bf16 v[172:175], a[240:243], a[68:71], v[172:175]
    buffer_load_dwordx4 a[64:67], v239, s[32:35], s62 offen offset:1024 sc1
    v_mfma_f32_16x16x32_bf16 v[176:179], a[244:247], a[68:71], v[176:179]
    v_mfma_f32_16x16x32_bf16 v[180:183], a[248:251], a[68:71], v[180:183]
    v_mfma_f32_16x16x32_bf16 v[184:187], a[252:255], a[68:71], v[184:187]
    v_mfma_f32_16x16x32_bf16 v[188:191], a[92:95], a[68:71], v[188:191]
    s_waitcnt vmcnt(10)
    v_mfma_f32_16x16x32_bf16 v[172:175], a[96:99], a[72:75], v[172:175]
    buffer_load_dwordx4 a[68:71], v239, s[32:35], s62 offen offset:2048 sc1
    v_mfma_f32_16x16x32_bf16 v[176:179], a[100:103], a[72:75], v[176:179]
    v_mfma_f32_16x16x32_bf16 v[180:183], a[104:107], a[72:75], v[180:183]
    v_mfma_f32_16x16x32_bf16 v[184:187], a[108:111], a[72:75], v[184:187]
    v_mfma_f32_16x16x32_bf16 v[188:191], a[112:115], a[72:75], v[188:191]
    s_waitcnt vmcnt(10)
    v_mfma_f32_16x16x32_bf16 v[172:175], a[116:119], a[76:79], v[172:175]
    buffer_load_dwordx4 a[72:75], v239, s[32:35], s62 offen offset:3072 sc1
    v_mfma_f32_16x16x32_bf16 v[176:179], a[0:3], a[76:79], v[176:179]
    v_mfma_f32_16x16x32_bf16 v[180:183], a[4:7], a[76:79], v[180:183]
    v_mfma_f32_16x16x32_bf16 v[184:187], a[8:11], a[76:79], v[184:187]
    v_mfma_f32_16x16x32_bf16 v[188:191], a[12:15], a[76:79], v[188:191]
    s_waitcnt vmcnt(10)
    s_add_u32 s62, s62, 4096
    v_mfma_f32_16x16x32_bf16 v[172:175], a[16:19], a[80:83], v[172:175]
    buffer_load_dwordx4 a[76:79], v239, s[32:35], s62 offen offset:0 sc1
    v_mfma_f32_16x16x32_bf16 v[176:179], a[20:23], a[80:83], v[176:179]
    v_mfma_f32_16x16x32_bf16 v[180:183], a[24:27], a[80:83], v[180:183]
    v_mfma_f32_16x16x32_bf16 v[184:187], a[28:31], a[80:83], v[184:187]
    v_mfma_f32_16x16x32_bf16 v[188:191], a[32:35], a[80:83], v[188:191]
    s_waitcnt vmcnt(10)
    v_mfma_f32_16x16x32_bf16 v[172:175], a[36:39], a[84:87], v[172:175]
    buffer_load_dwordx4 a[80:83], v239, s[32:35], s62 offen offset:1024 sc1
    v_mfma_f32_16x16x32_bf16 v[176:179], a[40:43], a[84:87], v[176:179]
    v_mfma_f32_16x16x32_bf16 v[180:183], v[0:3], a[84:87], v[180:183]
    v_mfma_f32_16x16x32_bf16 v[184:187], v[4:7], a[84:87], v[184:187]
    v_mfma_f32_16x16x32_bf16 v[188:191], v[8:11], a[84:87], v[188:191]
    s_waitcnt vmcnt(10)
    v_mfma_f32_16x16x32_bf16 v[172:175], v[12:15], a[88:91], v[172:175]
    buffer_load_dwordx4 a[84:87], v239, s[32:35], s62 offen offset:2048 sc1
    v_mfma_f32_16x16x32_bf16 v[176:179], v[16:19], a[88:91], v[176:179]
    v_mfma_f32_16x16x32_bf16 v[180:183], v[20:23], a[88:91], v[180:183]
    v_mfma_f32_16x16x32_bf16 v[184:187], v[24:27], a[88:91], v[184:187]
    v_mfma_f32_16x16x32_bf16 v[188:191], v[28:31], a[88:91], v[188:191]
    s_waitcnt vmcnt(10)
    v_mfma_f32_16x16x32_bf16 v[192:195], a[120:123], a[44:47], 0
    buffer_load_dwordx4 a[88:91], v239, s[32:35], s62 offen offset:3072 sc1
    v_mfma_f32_16x16x32_bf16 v[196:199], a[124:127], a[44:47], 0
    v_cmp_le_u32_e64 vcc, 1, v246
    v_mfma_f32_16x16x32_bf16 v[200:203], a[128:131], a[44:47], 0
    s_andn2_b32 s84, 0x3, vcc_lo
    s_cbranch_scc1 L_retry49
L_ok49:
    v_mfma_f32_16x16x32_bf16 v[204:207], a[132:135], a[44:47], 0
    s_mul_i32 s51, s4, 69632
    v_mfma_f32_16x16x32_bf16 v[208:211], a[136:139], a[44:47], 0
    s_waitcnt vmcnt(10)
    v_cmp_le_u32 s[22:23], 1, v246
    v_mfma_f32_16x16x32_bf16 v[192:195], a[140:143], a[48:51], v[192:195]
    s_andn2_b32 s84, 0xff, s22
    s_cbranch_scc1 L_ps50
L_pr50:
    v_mfma_f32_16x16x32_bf16 v[196:199], a[144:147], a[48:51], v[196:199]
    s_lshl_b32 s62, s4, 6
    v_mfma_f32_16x16x32_bf16 v[200:203], a[148:151], a[48:51], v[200:203]
    buffer_load_dword v236, v249, s[64:67], s62 offen sc1
    v_mfma_f32_16x16x32_bf16 v[204:207], a[152:155], a[48:51], v[204:207]
    s_add_u32 s62, s51, s13
    v_mfma_f32_16x16x32_bf16 v[208:211], a[156:159], a[48:51], v[208:211]
    s_waitcnt vmcnt(10)
    v_mfma_f32_16x16x32_bf16 v[192:195], a[160:163], a[52:55], v[192:195]
    buffer_load_dwordx4 a[44:47], v239, s[32:35], s62 offen offset:0 sc1
    v_mfma_f32_16x16x32_bf16 v[196:199], a[164:167], a[52:55], v[196:199]
    buffer_load_dwordx4 a[48:51], v239, s[32:35], s62 offen offset:1024 sc1
    v_mfma_f32_16x16x32_bf16 v[200:203], a[168:171], a[52:55], v[200:203]
    v_mfma_f32_16x16x32_bf16 v[204:207], a[172:175], a[52:55], v[204:207]
    v_mfma_f32_16x16x32_bf16 v[208:211], a[176:179], a[52:55], v[208:211]
    s_waitcnt vmcnt(11)
    v_mfma_f32_16x16x32_bf16 v[192:195], a[180:183], a[56:59], v[192:195]
    buffer_load_dwordx4 a[52:55], v239, s[32:35], s62 offen offset:2048 sc1
    v_mfma_f32_16x16x32_bf16 v[196:199], a[184:187], a[56:59], v[196:199]
    v_mfma_f32_16x16x32_bf16 v[200:203], a[188:191], a[56:59], v[200:203]
    v_mfma_f32_16x16x32_bf16 v[204:207], a[192:195], a[56:59], v[204:207]
    v_mfma_f32_16x16x32_bf16 v[208:211], a[196:199], a[56:59], v[208:211]
    s_waitcnt vmcnt(11)
    v_mfma_f32_16x16x32_bf16 v[192:195], a[200:203], a[60:63], v[192:195]
    buffer_load_dwordx4 a[56:59], v239, s[32:35], s62 offen offset:3072 sc1
    v_mfma_f32_16x16x32_bf16 v[196:199], a[204:207], a[60:63], v[196:199]
    v_mfma_f32_16x16x32_bf16 v[200:203], a[208:211], a[60:63], v[200:203]
    v_mfma_f32_16x16x32_bf16 v[204:207], a[212:215], a[60:63], v[204:207]
    v_mfma_f32_16x16x32_bf16 v[208:211], a[216:219], a[60:63], v[208:211]
    s_waitcnt vmcnt(11)
    s_add_u32 s62, s51, s14
    v_mfma_f32_16x16x32_bf16 v[192:195], a[220:223], a[64:67], v[192:195]
    buffer_load_dwordx2 a[60:61], v244, s[32:35], s62 offen sc1
    v_mfma_f32_16x16x32_bf16 v[196:199], a[224:227], a[64:67], v[196:199]
    buffer_load_dwordx2 a[62:63], v244, s[32:35], s62 offen offset:128 sc1
    v_mfma_f32_16x16x32_bf16 v[200:203], a[228:231], a[64:67], v[200:203]
    v_cmp_le_u32 vcc, 1, v246
    v_mfma_f32_16x16x32_bf16 v[204:207], a[232:235], a[64:67], v[204:207]
    s_andn2_b32 s84, 0xc, vcc_lo
    s_cbranch_scc1 L_retry51
L_ok51:
    v_mfma_f32_16x16x32_bf16 v[208:211], a[236:239], a[64:67], v[208:211]
    s_waitcnt vmcnt(12)
    s_mul_i32 s51, s5, 69632
    v_mfma_f32_16x16x32_bf16 v[192:195], a[240:243], a[68:71], v[192:195]
    v_cmp_le_u32 s[22:23], 1, v246
    v_mfma_f32_16x16x32_bf16 v[196:199], a[244:247], a[68:71], v[196:199]
    s_andn2_b32 s84, 0xff, s22
    s_cbranch_scc1 L_ps52
L_pr52:
    v_mfma_f32_16x16x32_bf16 v[200:203], a[248:251], a[68:71], v[200:203]
    s_lshl_b32 s62, s5, 6
    v_mfma_f32_16x16x32_bf16 v[204:207], a[252:255], a[68:71], v[204:207]
    buffer_load_dword v237, v249, s[64:67], s62 offen sc1
    v_mfma_f32_16x16x32_bf16 v[208:211], a[92:95], a[68:71], v[208:211]
    s_waitcnt vmcnt(12)
    s_add_u32 s62, s51, s13
    v_mfma_f32_16x16x32_bf16 v[192:195], a[96:99], a[72:75], v[192:195]
    buffer_load_dwordx4 a[64:67], v239, s[32:35], s62 offen offset:0 sc1
    v_mfma_f32_16x16x32_bf16 v[196:199], a[100:103], a[72:75], v[196:199]
    buffer_load_dwordx4 a[68:71], v239, s[32:35], s62 offen offset:1024 sc1
    v_mfma_f32_16x16x32_bf16 v[200:203], a[104:107], a[72:75], v[200:203]
    s_waitcnt vmcnt(9)
    v_mul_f32 v132, v236, v132
    v_mul_f32 v133, v236, v133
    v_mfma_f32_16x16x32_bf16 v[204:207], a[108:111], a[72:75], v[204:207]
    v_mul_f32 v134, v236, v134
    v_mul_f32 v135, v236, v135
    v_mfma_f32_16x16x32_bf16 v[208:211], a[112:115], a[72:75], v[208:211]
    v_mul_f32 v136, v236, v136
    v_mul_f32 v137, v236, v137
    v_mfma_f32_16x16x32_bf16 v[192:195], a[116:119], a[76:79], v[192:195]
    buffer_load_dwordx4 a[72:75], v239, s[32:35], s62 offen offset:2048 sc1
    v_mfma_f32_16x16x32_bf16 v[196:199], a[0:3], a[76:79], v[196:199]
    v_mul_f32 v138, v236, v138
    v_mul_f32 v139, v236, v139
    v_mfma_f32_16x16x32_bf16 v[200:203], a[4:7], a[76:79], v[200:203]
    v_mul_f32 v140, v236, v140
    v_mul_f32 v141, v236, v141
    v_mfma_f32_16x16x32_bf16 v[204:207], a[8:11], a[76:79], v[204:207]
    v_mul_f32 v142, v236, v142
    v_mul_f32 v143, v236, v143
    v_mfma_f32_16x16x32_bf16 v[208:211], a[12:15], a[76:79], v[208:211]
    v_mul_f32 v144, v236, v144
    v_mul_f32 v145, v236, v145
    v_mfma_f32_16x16x32_bf16 v[192:195], a[16:19], a[80:83], v[192:195]
    buffer_load_dwordx4 a[76:79], v239, s[32:35], s62 offen offset:3072 sc1
    v_mfma_f32_16x16x32_bf16 v[196:199], a[20:23], a[80:83], v[196:199]
    v_mul_f32 v146, v236, v146
    v_mul_f32 v147, v236, v147
    v_mfma_f32_16x16x32_bf16 v[200:203], a[24:27], a[80:83], v[200:203]
    v_mul_f32 v148, v236, v148
    v_mul_f32 v149, v236, v149
    v_mfma_f32_16x16x32_bf16 v[204:207], a[28:31], a[80:83], v[204:207]
    v_mul_f32 v150, v236, v150
    v_mul_f32 v151, v236, v151
    v_mfma_f32_16x16x32_bf16 v[208:211], a[32:35], a[80:83], v[208:211]
    s_add_u32 s62, s51, s14
    v_mfma_f32_16x16x32_bf16 v[192:195], a[36:39], a[84:87], v[192:195]
    buffer_load_dwordx2 a[80:81], v244, s[32:35], s62 offen sc1
    v_mfma_f32_16x16x32_bf16 v[196:199], a[40:43], a[84:87], v[196:199]
    buffer_load_dwordx2 a[82:83], v244, s[32:35], s62 offen offset:128 sc1
    v_mfma_f32_16x16x32_bf16 v[200:203], v[0:3], a[84:87], v[200:203]
    v_cmp_le_u32 vcc, 1, v246
    v_mfma_f32_16x16x32_bf16 v[204:207], v[4:7], a[84:87], v[204:207]
    s_andn2_b32 s84, 0x30, vcc_lo
    s_cbranch_scc1 L_retry53
L_ok53:
    v_mfma_f32_16x16x32_bf16 v[208:211], v[8:11], a[84:87], v[208:211]
    s_mul_i32 s51, s6, 69632
    v_mfma_f32_16x16x32_bf16 v[192:195], v[12:15], a[88:91], v[192:195]
    v_cmp_le_u32 s[22:23], 1, v246
    v_mfma_f32_16x16x32_bf16 v[196:199], v[16:19], a[88:91], v[196:199]
    s_andn2_b32 s84, 0xff, s22
    s_cbranch_scc1 L_ps54
L_pr54:
    v_mfma_f32_16x16x32_bf16 v[200:203], v[20:23], a[88:91], v[200:203]
    s_lshl_b32 s62, s6, 6
    v_mfma_f32_16x16x32_bf16 v[204:207], v[24:27], a[88:91], v[204:207]
    buffer_load_dword v238, v249, s[64:67], s62 offen sc1
    v_mfma_f32_16x16x32_bf16 v[208:211], v[28:31], a[88:91], v[208:211]
    s_waitcnt vmcnt(13)
    s_add_u32 s62, s51, s13
    v_mfma_f32_16x16x32_bf16 v[132:135], v[32:35], a[44:47], v[132:135]
    buffer_load_dwordx4 a[84:87], v239, s[32:35], s62 offen offset:0 sc1
    v_mfma_f32_16x16x32_bf16 v[136:139], v[36:39], a[44:47], v[136:139]
    buffer_load_dwordx4 a[88:91], v239, s[32:35], s62 offen offset:1024 sc1
    v_mfma_f32_16x16x32_bf16 v[140:143], v[40:43], a[44:47], v[140:143]
    s_waitcnt vmcnt(9)
    v_mul_f32 v152, v237, v152
    v_mul_f32_e64 v153, v237, v153
    v_mfma_f32_16x16x32_bf16 v[144:147], v[44:47], a[44:47], v[144:147]
    v_mul_f32 v154, v237, v154
    v_mul_f32 v155, v237, v155
    v_mfma_f32_16x16x32_bf16 v[148:151], v[48:51], a[44:47], v[148:151]
    v_mul_f32 v156, v237, v156
    v_mul_f32 v157, v237, v157
    v_mfma_f32_16x16x32_bf16 v[132:135], v[52:55], a[48:51], v[132:135]
    buffer_load_dwordx4 a[44:47], v239, s[32:35], s62 offen offset:2048 sc1
    v_mfma_f32_16x16x32_bf16 v[136:139], v[56:59], a[48:51], v[136:139]
    v_mul_f32 v158, v237, v158
    v_mul_f32 v159, v237, v159
    v_mfma_f32_16x16x32_bf16 v[140:143], v[60:63], a[48:51], v[140:143]
    v_mul_f32 v160, v237, v160
    v_mul_f32 v161, v237, v161
    v_mfma_f32_16x16x32_bf16 v[144:147], v[64:67], a[48:51], v[144:147]
    v_mul_f32 v162, v237, v162
    v_mul_f32 v163, v237, v163
    v_mfma_f32_16x16x32_bf16 v[148:151], v[68:71], a[48:51], v[148:151]
    v_mul_f32 v164, v237, v164
    v_mul_f32 v165, v237, v165
    v_mfma_f32_16x16x32_bf16 v[132:135], v[72:75], a[52:55], v[132:135]
    buffer_load_dwordx4 a[48:51], v239, s[32:35], s62 offen offset:3072 sc1
    v_mfma_f32_16x16x32_bf16 v[136:139], v[76:79], a[52:55], v[136:139]
    v_mul_f32 v166, v237, v166
    v_mul_f32 v167, v237, v167
    v_mfma_f32_16x16x32_bf16 v[140:143], v[80:83], a[52:55], v[140:143]
    v_mul_f32 v168, v237, v168
    v_mul_f32 v169, v237, v169
    v_mfma_f32_16x16x32_bf16 v[144:147], v[84:87], a[52:55], v[144:147]
    v_mul_f32 v170, v237, v170
    v_mul_f32 v171, v237, v171
    v_mfma_f32_16x16x32_bf16 v[148:151], v[88:91], a[52:55], v[148:151]
    s_add_u32 s62, s51, s14
    v_mfma_f32_16x16x32_bf16 v[132:135], v[92:95], a[56:59], v[132:135]
    buffer_load_dwordx2 a[52:53], v244, s[32:35], s62 offen sc1
    v_mfma_f32_16x16x32_bf16 v[136:139], v[96:99], a[56:59], v[136:139]
    buffer_load_dwordx2 a[54:55], v244, s[32:35], s62 offen offset:128 sc1
    v_mfma_f32_16x16x32_bf16 v[140:143], v[100:103], a[56:59], v[140:143]
    v_cmp_le_u32 vcc, 1, v246
    v_mfma_f32_16x16x32_bf16 v[144:147], v[104:107], a[56:59], v[144:147]
    s_andn2_b32 s84, 0xc0, vcc_lo
    s_cbranch_scc1 L_retry55
L_ok55:
    v_mfma_f32_16x16x32_bf16 v[148:151], v[108:111], a[56:59], v[148:151]
    s_mul_i32 s51, s7, 69632
    v_mfma_f32_16x16x32_bf16 v[132:135], v[112:115], a[60:63], v[132:135]
    s_lshl_b32 s62, s7, 6
    v_mfma_f32_16x16x32_bf16 v[136:139], v[116:119], a[60:63], v[136:139]
    buffer_load_dword v236, v249, s[64:67], s62 offen sc1
    v_mfma_f32_16x16x32_bf16 v[140:143], v[120:123], a[60:63], v[140:143]
    s_add_u32 s62, s51, s13
    v_mfma_f32_16x16x32_bf16 v[144:147], v[124:127], a[60:63], v[144:147]
    buffer_load_dwordx4 a[56:59], v239, s[32:35], s62 offen offset:0 sc1
    v_mfma_f32_16x16x32_bf16 v[148:151], v[128:131], a[60:63], v[148:151]
    s_waitcnt vmcnt(14)
    v_mfma_f32_16x16x32_bf16 v[152:155], v[32:35], a[64:67], v[152:155]
    buffer_load_dwordx4 a[60:63], v239, s[32:35], s62 offen offset:1024 sc1
    v_mfma_f32_16x16x32_bf16 v[156:159], v[36:39], a[64:67], v[156:159]
    ds_write_b128 v232, v[132:135] offset:0
    v_mfma_f32_16x16x32_bf16 v[160:163], v[40:43], a[64:67], v[160:163]
    s_waitcnt vmcnt(9)
    v_mul_f32 v172, v238, v172
    v_mul_f32_e64 v173, v238, v173
    v_mfma_f32_16x16x32_bf16 v[164:167], v[44:47], a[64:67], v[164:167]
    v_mul_f32 v174, v238, v174
    v_mul_f32 v175, v238, v175
    v_mfma_f32_16x16x32_bf16 v[168:171], v[48:51], a[64:67], v[168:171]
    v_mul_f32 v176, v238, v176
    v_mul_f32 v177, v238, v177
    v_mfma_f32_16x16x32_bf16 v[152:155], v[52:55], a[68:71], v[152:155]
    buffer_load_dwordx4 a[64:67], v239, s[32:35], s62 offen offset:2048 sc1
    v_mfma_f32_16x16x32_bf16 v[156:159], v[56:59], a[68:71], v[156:159]
    ds_write_b128 v232, v[136:139] offset:32
    v_mfma_f32_16x16x32_bf16 v[160:163], v[60:63], a[68:71], v[160:163]
    v_mul_f32 v178, v238, v178
    v_mul_f32 v179, v238, v179
    v_mfma_f32_16x16x32_bf16 v[164:167], v[64:67], a[68:71], v[164:167]
    v_mul_f32 v180, v238, v180
    v_mul_f32 v181, v238, v181
    v_mfma_f32_16x16x32_bf16 v[168:171], v[68:71], a[68:71], v[168:171]
    v_mul_f32 v182, v238, v182
    v_mul_f32 v183, v238, v183
    v_mfma_f32_16x16x32_bf16 v[152:155], v[72:75], a[72:75], v[152:155]
    buffer_load_dwordx4 a[68:71], v239, s[32:35], s62 offen offset:3072 sc1
    v_mfma_f32_16x16x32_bf16 v[156:159], v[76:79], a[72:75], v[156:159]
    ds_write_b128 v232, v[140:143] offset:64
    v_mfma_f32_16x16x32_bf16 v[160:163], v[80:83], a[72:75], v[160:163]
    v_mul_f32 v184, v238, v184
    v_mul_f32 v185, v238, v185
    v_mfma_f32_16x16x32_bf16 v[164:167], v[84:87], a[72:75], v[164:167]
    v_mul_f32 v186, v238, v186
    v_mul_f32 v187, v238, v187
    v_mfma_f32_16x16x32_bf16 v[168:171], v[88:91], a[72:75], v[168:171]
    s_add_u32 s62, s51, s14
    v_mul_f32 v188, v238, v188
    v_mfma_f32_16x16x32_bf16 v[152:155], v[92:95], a[76:79], v[152:155]
    buffer_load_dwordx2 a[72:73], v244, s[32:35], s62 offen sc1
    v_mfma_f32_16x16x32_bf16 v[156:159], v[96:99], a[76:79], v[156:159]
    buffer_load_dwordx2 a[74:75], v244, s[32:35], s62 offen offset:128 sc1
    v_mfma_f32_16x16x32_bf16 v[160:163], v[100:103], a[76:79], v[160:163]
    ds_write_b128 v232, v[144:147] offset:96
    v_mfma_f32_16x16x32_bf16 v[164:167], v[104:107], a[76:79], v[164:167]
    v_mul_f32 v189, v238, v189
    v_mul_f32 v190, v238, v190
    v_mfma_f32_16x16x32_bf16 v[168:171], v[108:111], a[76:79], v[168:171]
    v_mul_f32_e64 v191, v238, v191
    v_mfma_f32_16x16x32_bf16 v[152:155], v[112:115], a[80:83], v[152:155]
    ds_write_b128 v232, v[148:151] offset:128
    v_mfma_f32_16x16x32_bf16 v[156:159], v[116:119], a[80:83], v[156:159]
    v_mfma_f32_16x16x32_bf16 v[160:163], v[120:123], a[80:83], v[160:163]
    v_mfma_f32_16x16x32_bf16 v[164:167], v[124:127], a[80:83], v[164:167]
    s_waitcnt lgkmcnt(0)
    s_barrier
    v_mfma_f32_16x16x32_bf16 v[168:171], v[128:131], a[80:83], v[168:171]
    s_waitcnt vmcnt(12)
    ds_read_b128 v[132:135], v234 offset:0
    v_mfma_f32_16x16x32_bf16 v[172:175], v[32:35], a[84:87], v[172:175]
    ds_read_b128 v[136:139], v234 offset:5376
    v_mfma_f32_16x16x32_bf16 v[176:179], v[36:39], a[84:87], v[176:179]
    ds_write_b128 v232, v[152:155] offset:21760
    v_mfma_f32_16x16x32_bf16 v[180:183], v[40:43], a[84:87], v[180:183]
    s_waitcnt vmcnt(6)
    v_mul_f32 v192, v236, v192
    v_mul_f32 v193, v236, v193
    v_mfma_f32_16x16x32_bf16 v[184:187], v[44:47], a[84:87], v[184:187]
    v_mul_f32 v194, v236, v194
    v_mul_f32 v195, v236, v195
    v_mfma_f32_16x16x32_bf16 v[188:191], v[48:51], a[84:87], v[188:191]
    v_mul_f32 v196, v236, v196
    v_mul_f32 v197, v236, v197
    v_mfma_f32_16x16x32_bf16 v[172:175], v[52:55], a[88:91], v[172:175]
    ds_write_b128 v232, v[156:159] offset:21792
    v_mfma_f32_16x16x32_bf16 v[176:179], v[56:59], a[88:91], v[176:179]
    v_mul_f32 v198, v236, v198
    v_mul_f32 v199, v236, v199
    v_mfma_f32_16x16x32_bf16 v[180:183], v[60:63], a[88:91], v[180:183]
    v_mul_f32 v200, v236, v200
    v_mul_f32 v201, v236, v201
    v_mfma_f32_16x16x32_bf16 v[184:187], v[64:67], a[88:91], v[184:187]
    ds_write_b128 v232, v[160:163] offset:21824
    v_mfma_f32_16x16x32_bf16 v[188:191], v[68:71], a[88:91], v[188:191]
    v_mul_f32 v202, v236, v202
    v_mul_f32 v203, v236, v203
    v_mfma_f32_16x16x32_bf16 v[172:175], v[72:75], a[44:47], v[172:175]
    v_mul_f32 v204, v236, v204
    v_mul_f32 v205, v236, v205
    v_mfma_f32_16x16x32_bf16 v[176:179], v[76:79], a[44:47], v[176:179]
    ds_write_b128 v232, v[164:167] offset:21856
    v_mfma_f32_16x16x32_bf16 v[180:183], v[80:83], a[44:47], v[180:183]
    v_mul_f32 v206, v236, v206
    v_mul_f32 v207, v236, v207
    v_mfma_f32_16x16x32_bf16 v[184:187], v[84:87], a[44:47], v[184:187]
    v_mul_f32 v208, v236, v208
    v_mul_f32 v209, v236, v209
    v_mfma_f32_16x16x32_bf16 v[188:191], v[88:91], a[44:47], v[188:191]
    v_mul_f32 v210, v236, v210
    v_mul_f32 v211, v236, v211
    v_mfma_f32_16x16x32_bf16 v[172:175], v[92:95], a[48:51], v[172:175]
    ds_write_b128 v232, v[168:171] offset:21888
    v_mfma_f32_16x16x32_bf16 v[176:179], v[96:99], a[48:51], v[176:179]
    ds_read_b128 v[140:143], v234 offset:10752
    v_mfma_f32_16x16x32_bf16 v[180:183], v[100:103], a[48:51], v[180:183]
    ds_read_b128 v[144:147], v234 offset:16128
    v_mfma_f32_16x16x32_bf16 v[184:187], v[104:107], a[48:51], v[184:187]
    s_waitcnt lgkmcnt(2)
    s_barrier
    v_mfma_f32_16x16x32_bf16 v[188:191], v[108:111], a[48:51], v[188:191]
    ds_read_b128 v[0:3], v234 offset:2624
    v_mfma_f32_16x16x32_bf16 v[172:175], v[112:115], a[52:55], v[172:175]
    ds_read_b128 v[4:7], v234 offset:8000
    v_mfma_f32_16x16x32_bf16 v[176:179], v[116:119], a[52:55], v[176:179]
    ds_read_b128 v[8:11], v234 offset:13376
    v_mfma_f32_16x16x32_bf16 v[180:183], v[120:123], a[52:55], v[180:183]
    ds_read_b128 v[12:15], v234 offset:18752
    v_mfma_f32_16x16x32_bf16 v[184:187], v[124:127], a[52:55], v[184:187]
    v_mfma_f32_16x16x32_bf16 v[188:191], v[128:131], a[52:55], v[188:191]
    s_waitcnt vmcnt(5)
    s_waitcnt lgkmcnt(4)
    v_add_f32 v132, v132, v136
    v_add_f32 v133, v133, v137
    v_mfma_f32_16x16x32_bf16 v[192:195], v[32:35], a[56:59], v[192:195]
    v_add_f32 v134, v134, v138
    v_add_f32 v135, v135, v139
    v_mfma_f32_16x16x32_bf16 v[196:199], v[36:39], a[56:59], v[196:199]
    ds_write_b128 v233, v[172:175] offset:0
    v_mfma_f32_16x16x32_bf16 v[200:203], v[40:43], a[56:59], v[200:203]
    v_add_f32 v140, v140, v144
    v_add_f32 v141, v141, v145
    v_mfma_f32_16x16x32_bf16 v[204:207], v[44:47], a[56:59], v[204:207]
    v_add_f32 v142, v142, v146
    v_add_f32 v143, v143, v147
    v_mfma_f32_16x16x32_bf16 v[208:211], v[48:51], a[56:59], v[208:211]
    s_waitcnt vmcnt(4)
    v_add_f32 v132, v132, v140
    v_add_f32_e64 v133, v133, v141
    v_mfma_f32_16x16x32_bf16 v[192:195], v[52:55], a[60:63], v[192:195]
    ds_write_b128 v233, v[176:179] offset:32
    v_mfma_f32_16x16x32_bf16 v[196:199], v[56:59], a[60:63], v[196:199]
    v_add_f32 v134, v134, v142
    v_add_f32 v135, v135, v143
    v_mfma_f32_16x16x32_bf16 v[200:203], v[60:63], a[60:63], v[200:203]
    v_cvt_pk_bf16_f32 v148, v132, v133
    v_cvt_pk_bf16_f32 v149, v134, v135
    v_mfma_f32_16x16x32_bf16 v[204:207], v[64:67], a[60:63], v[204:207]
    ds_write_b128 v233, v[180:183] offset:64
    v_mfma_f32_16x16x32_bf16 v[208:211], v[68:71], a[60:63], v[208:211]
    s_waitcnt vmcnt(3)
    s_waitcnt lgkmcnt(3)
    v_add_f32 v0, v0, v4
    v_add_f32 v1, v1, v5
    v_mfma_f32_16x16x32_bf16 v[192:195], v[72:75], a[64:67], v[192:195]
    v_add_f32 v2, v2, v6
    v_add_f32 v3, v3, v7
    v_mfma_f32_16x16x32_bf16 v[196:199], v[76:79], a[64:67], v[196:199]
    ds_write_b128 v233, v[184:187] offset:96
    v_mfma_f32_16x16x32_bf16 v[200:203], v[80:83], a[64:67], v[200:203]
    v_add_f32 v8, v8, v12
    v_add_f32 v9, v9, v13
    v_mfma_f32_16x16x32_bf16 v[204:207], v[84:87], a[64:67], v[204:207]
    v_add_f32 v10, v10, v14
    v_add_f32 v11, v11, v15
    v_mfma_f32_16x16x32_bf16 v[208:211], v[88:91], a[64:67], v[208:211]
    s_waitcnt vmcnt(2)
    v_add_f32 v0, v0, v8
    v_add_f32_e64 v1, v1, v9
    v_mfma_f32_16x16x32_bf16 v[192:195], v[92:95], a[68:71], v[192:195]
    ds_write_b128 v233, v[188:191] offset:128
    v_mfma_f32_16x16x32_bf16 v[196:199], v[96:99], a[68:71], v[196:199]
    v_add_f32 v2, v2, v10
    v_add_f32 v3, v3, v11
    v_mfma_f32_16x16x32_bf16 v[200:203], v[100:103], a[68:71], v[200:203]
    v_cvt_pk_bf16_f32 v150, v0, v1
    v_cvt_pk_bf16_f32 v151, v2, v3
    v_mfma_f32_16x16x32_bf16 v[204:207], v[104:107], a[68:71], v[204:207]
    s_waitcnt lgkmcnt(0)
    s_barrier
    v_mfma_f32_16x16x32_bf16 v[208:211], v[108:111], a[68:71], v[208:211]
    s_waitcnt vmcnt(0)
    v_mfma_f32_16x16x32_bf16 v[192:195], v[112:115], a[72:75], v[192:195]
    s_mul_i32 s60, s4, 20480
    s_add_u32 s60, s60, s15
    buffer_store_dwordx4 v[148:151], v247, s[76:79], s60 offen sc1
    v_mfma_f32_16x16x32_bf16 v[196:199], v[116:119], a[72:75], v[196:199]
    ds_read_b128 v[152:155], v234 offset:21760
    v_mfma_f32_16x16x32_bf16 v[200:203], v[120:123], a[72:75], v[200:203]
    ds_read_b128 v[156:159], v234 offset:27136
    v_mfma_f32_16x16x32_bf16 v[204:207], v[124:127], a[72:75], v[204:207]
    ds_read_b128 v[160:163], v234 offset:32512
    v_mfma_f32_16x16x32_bf16 v[208:211], v[128:131], a[72:75], v[208:211]
    ds_read_b128 v[164:167], v234 offset:37888
    ds_read_b128 v[16:19], v234 offset:24384
    ds_read_b128 v[20:23], v234 offset:29760
    ds_read_b128 v[24:27], v234 offset:35136
    ds_read_b128 v[28:31], v234 offset:40512
    s_waitcnt lgkmcnt(4)
    v_add_f32 v152, v152, v156
    v_add_f32 v153, v153, v157
    v_add_f32 v154, v154, v158
    v_add_f32 v155, v155, v159
    v_add_f32 v160, v160, v164
    v_add_f32 v161, v161, v165
    v_add_f32 v162, v162, v166
    v_add_f32_e64 v163, v163, v167
    ds_write_b128 v233, v[192:195] offset:21760
    v_add_f32 v152, v152, v160
    v_add_f32 v153, v153, v161
    v_add_f32 v154, v154, v162
    v_add_f32 v155, v155, v163
    v_cvt_pk_bf16_f32 v168, v152, v153
    ds_write_b128 v233, v[196:199] offset:21792
    v_cvt_pk_bf16_f32 v169, v154, v155
    s_waitcnt lgkmcnt(2)
    v_add_f32 v16, v16, v20
    v_add_f32 v17, v17, v21
    v_add_f32 v18, v18, v22
    v_add_f32_e64 v19, v19, v23
    ds_write_b128 v233, v[200:203] offset:21824
    v_add_f32 v24, v24, v28
    v_add_f32 v25, v25, v29
    v_add_f32 v26, v26, v30
    v_add_f32 v27, v27, v31
    v_add_f32_e64 v16, v16, v24
    ds_write_b128 v233, v[204:207] offset:21856
    v_add_f32 v17, v17, v25
    v_add_f32 v18, v18, v26
    v_add_f32_e64 v19, v19, v27
    v_cvt_pk_bf16_f32 v170, v16, v17
    ds_write_b128 v233, v[208:211] offset:21888
    s_waitcnt lgkmcnt(0)
    s_barrier
    ds_read_b128 v[192:195], v235 offset:21760
    ds_read_b128 v[196:199], v235 offset:27136
    ds_read_b128 v[200:203], v235 offset:32512
    ds_read_b128 v[204:207], v235 offset:37888
    ds_read_b128 v[32:35], v235 offset:24384
    ds_read_b128 v[36:39], v235 offset:29760
    ds_read_b128 v[40:43], v235 offset:35136
    ds_read_b128 v[44:47], v235 offset:40512
    v_cvt_pk_bf16_f32 v171, v18, v19
    s_mul_i32 s60, s5, 20480
    s_add_u32 s60, s60, s15
    buffer_store_dwordx4 v[168:171], v247, s[76:79], s60 offen sc1
    ds_read_b128 v[172:175], v235 offset:0
    ds_read_b128 v[176:179], v235 offset:5376
    ds_read_b128 v[180:183], v235 offset:10752
    ds_read_b128 v[184:187], v235 offset:16128
    ds_read_b128 v[212:215], v235 offset:2624
    ds_read_b128 v[216:219], v235 offset:8000
    ds_read_b128 v[220:223], v235 offset:13376
    ds_read_b128 v[224:227], v235 offset:18752
    s_waitcnt lgkmcnt(4)
    v_add_f32 v172, v172, v176
    v_add_f32 v173, v173, v177
    v_add_f32 v174, v174, v178
    v_add_f32 v175, v175, v179
    v_add_f32 v180, v180, v184
    v_add_f32 v181, v181, v185
    v_add_f32 v182, v182, v186
    v_add_f32 v183, v183, v187
    v_add_f32 v172, v172, v180
    v_add_f32 v173, v173, v181
    v_add_f32 v174, v174, v182
    v_add_f32 v175, v175, v183
    v_cvt_pk_bf16_f32 v188, v172, v173
    v_cvt_pk_bf16_f32 v189, v174, v175
    s_waitcnt lgkmcnt(0)
    v_add_f32 v212, v212, v216
    v_add_f32 v213, v213, v217
    v_add_f32 v214, v214, v218
    v_add_f32 v215, v215, v219
    v_add_f32 v220, v220, v224
    v_add_f32 v221, v221, v225
    v_add_f32 v222, v222, v226
    v_add_f32 v223, v223, v227
    v_add_f32 v212, v212, v220
    v_add_f32 v213, v213, v221
    v_add_f32 v214, v214, v222
    v_add_f32_e64 v215, v215, v223
    v_cvt_pk_bf16_f32 v190, v212, v213
    v_cvt_pk_bf16_f32 v191, v214, v215
    s_mul_i32 s60, s6, 20480
    s_add_u32 s60, s60, s15
    buffer_store_dwordx4 v[188:191], v247, s[76:79], s60 offen sc1
    v_pk_add_f32 v[192:193], v[192:193], v[196:197]
    v_pk_add_f32 v[194:195], v[194:195], v[198:199]
    v_pk_add_f32 v[200:201], v[200:201], v[204:205]
    v_pk_add_f32 v[202:203], v[202:203], v[206:207]
    v_pk_add_f32 v[192:193], v[192:193], v[200:201]
    v_pk_add_f32 v[194:195], v[194:195], v[202:203]
    v_cvt_pk_bf16_f32 v208, v192, v193
    v_cvt_pk_bf16_f32 v209, v194, v195
    v_pk_add_f32 v[32:33], v[32:33], v[36:37]
    v_pk_add_f32 v[34:35], v[34:35], v[38:39]
    v_pk_add_f32 v[40:41], v[40:41], v[44:45]
    v_pk_add_f32 v[42:43], v[42:43], v[46:47]
    v_pk_add_f32 v[32:33], v[32:33], v[40:41]
    v_pk_add_f32 v[34:35], v[34:35], v[42:43]
    v_cvt_pk_bf16_f32 v210, v32, v33
    v_cvt_pk_bf16_f32 v211, v34, v35
    s_mul_i32 s60, s7, 20480
    s_add_u32 s60, s60, s15
    buffer_store_dwordx4 v[208:211], v247, s[76:79], s60 offen sc1
    s_endpgm
L_ps48:
    buffer_load_dword v246, v245, s[68:71], 0 offen sc1
    s_branch L_pr48
L_ps50:
    buffer_load_dword v246, v245, s[68:71], 0 offen sc1
    s_branch L_pr50
L_ps52:
    buffer_load_dword v246, v245, s[68:71], 0 offen sc1
    s_branch L_pr52
L_ps54:
    buffer_load_dword v246, v245, s[68:71], 0 offen sc1
    s_branch L_pr54
L_retry37:
    s_mov_b32 s85, 0x8000
L_spin37:
    s_waitcnt vmcnt(0)
    v_cmp_le_u32_e64 vcc, 20, v243
    s_sub_u32 s85, s85, 1
    s_cbranch_scc1 L_ok37
    s_andn2_b32 s84, 0x2, vcc_lo
    s_cbranch_scc0 L_ok37
    s_cmp_eq_u32 s85, 0x7fff
    s_cbranch_scc1 L_nosl37
    s_sleep 8
L_nosl37:
    buffer_load_dword v243, v242, s[72:75], 0 offen sc1
    s_branch L_spin37
L_retry42:
    s_mov_b32 s85, 0x8000
L_spin42:
    s_waitcnt vmcnt(0)
    v_cmp_le_u32_e64 vcc, 20, v243
    s_sub_u32 s85, s85, 1
    s_cbranch_scc1 L_ok42
    s_andn2_b32 s84, 0x4, vcc_lo
    s_cbranch_scc0 L_ok42
    s_cmp_eq_u32 s85, 0x7fff
    s_cbranch_scc1 L_nosl42
    s_sleep 8
L_nosl42:
    buffer_load_dword v243, v242, s[72:75], 0 offen sc1
    s_branch L_spin42
L_retry43:
    s_mov_b32 s85, 0x8000
L_spin43:
    s_waitcnt vmcnt(0)
    v_cmp_le_u32_e64 vcc, 1, v243
    s_sub_u32 s85, s85, 1
    s_cbranch_scc1 L_ok43
    s_andn2_b32 s84, 0x7, vcc_lo
    s_cbranch_scc0 L_ok43
    s_cmp_eq_u32 s85, 0x7fff
    s_cbranch_scc1 L_nosl43
    s_sleep 8
L_nosl43:
    buffer_load_dword v243, v242, s[68:71], s45 offen sc1
    s_branch L_spin43
L_retry44:
    s_waitcnt vmcnt(0)
    s_mov_b64 exec, 1
    v_mov_b32 v253, s19
    ds_or_rtn_b32 v253, v241, v253 offset:0
    s_mov_b64 exec, -1
    s_waitcnt lgkmcnt(0)
    v_readfirstlane_b32 s84, v253
    v_mov_b32_e64 v253, 1
    s_or_b32 s84, s84, s19
    s_cmp_lg_u32 s84, 15
    s_cbranch_scc1 L_pb56
    buffer_store_dword v253, v252, s[68:71], s18 offen offset:0 sc1
    L_pb56:
    s_mov_b32 s85, 0x8000
L_spin44:
    s_waitcnt vmcnt(0)
    v_cmp_le_u32 vcc, 1, v243
    s_sub_u32 s85, s85, 1
    s_cbranch_scc1 L_ok44
    s_andn2_b32 s84, 0x7, vcc_lo
    s_cbranch_scc0 L_ok44
    s_cmp_eq_u32 s85, 0x7fff
    s_cbranch_scc1 L_nosl44
    s_sleep 8
L_nosl44:
    buffer_load_dword v243, v242, s[68:71], s46 offen sc1
    s_branch L_spin44
L_retry46:
    s_mov_b32 s85, 0x8000
L_spin46:
    s_waitcnt vmcnt(0)
    v_cmp_le_u32_e64 vcc, 1, v243
    s_sub_u32 s85, s85, 1
    s_cbranch_scc1 L_ok46
    s_andn2_b32 s84, 0x7, vcc_lo
    s_cbranch_scc0 L_ok46
    s_cmp_eq_u32 s85, 0x7fff
    s_cbranch_scc1 L_nosl46
    s_sleep 8
L_nosl46:
    buffer_load_dword v243, v242, s[68:71], s47 offen sc1
    s_branch L_spin46
L_retry47:
    s_mov_b32 s85, 0x8000
L_spin47:
    s_waitcnt vmcnt(0)
    v_cmp_le_u32_e64 vcc, 1, v243
    s_sub_u32 s85, s85, 1
    s_cbranch_scc1 L_ok47
    s_andn2_b32 s84, 0x7, vcc_lo
    s_cbranch_scc0 L_ok47
    s_cmp_eq_u32 s85, 0x7fff
    s_cbranch_scc1 L_nosl47
    s_sleep 8
L_nosl47:
    buffer_load_dword v243, v242, s[68:71], s48 offen sc1
    s_branch L_spin47
L_retry49:
    s_mov_b32 s85, 0x8000
L_spin49:
    s_waitcnt vmcnt(0)
    v_cmp_le_u32_e64 vcc, 1, v246
    s_sub_u32 s85, s85, 1
    s_cbranch_scc1 L_ok49
    s_andn2_b32 s84, 0x3, vcc_lo
    s_cbranch_scc0 L_ok49
    s_cmp_eq_u32 s85, 0x7fff
    s_cbranch_scc1 L_nosl49
    s_sleep 8
L_nosl49:
    buffer_load_dword v246, v245, s[68:71], 0 offen sc1
    s_branch L_spin49
L_retry51:
    s_mov_b32 s85, 0x8000
L_spin51:
    s_waitcnt vmcnt(0)
    v_cmp_le_u32_e64 vcc, 1, v246
    s_sub_u32 s85, s85, 1
    s_cbranch_scc1 L_ok51
    s_andn2_b32 s84, 0xc, vcc_lo
    s_cbranch_scc0 L_ok51
    s_cmp_eq_u32 s85, 0x7fff
    s_cbranch_scc1 L_nosl51
    s_sleep 8
L_nosl51:
    buffer_load_dword v246, v245, s[68:71], 0 offen sc1
    s_branch L_spin51
L_retry53:
    s_mov_b32 s85, 0x8000
L_spin53:
    s_waitcnt vmcnt(0)
    v_cmp_le_u32_e64 vcc, 1, v246
    s_sub_u32 s85, s85, 1
    s_cbranch_scc1 L_ok53
    s_andn2_b32 s84, 0x30, vcc_lo
    s_cbranch_scc0 L_ok53
    s_cmp_eq_u32 s85, 0x7fff
    s_cbranch_scc1 L_nosl53
    s_sleep 8
L_nosl53:
    buffer_load_dword v246, v245, s[68:71], 0 offen sc1
    s_branch L_spin53
L_retry55:
    s_mov_b32 s85, 0x8000
L_spin55:
    s_waitcnt vmcnt(0)
    v_cmp_le_u32_e64 vcc, 1, v246
    s_sub_u32 s85, s85, 1
    s_cbranch_scc1 L_ok55
    s_andn2_b32 s84, 0xc0, vcc_lo
    s_cbranch_scc0 L_ok55
    s_cmp_eq_u32 s85, 0x7fff
    s_cbranch_scc1 L_nosl55
    s_sleep 8
L_nosl55:
    buffer_load_dword v246, v245, s[68:71], 0 offen sc1
    s_branch L_spin55
.p2align 6
L_Fmain:
    s_mul_i32 s50, s53, 43
    s_lshr_b32 s50, s50, 7
    s_mul_i32 s60, s50, 3
    s_sub_u32 s59, s53, s60
    s_lshl_b32 s59, s59, 2
    s_add_u32 s59, s59, s44
    s_cmp_lt_u32 s59, 9
    s_cselect_b32 s36, s12, s14
    s_cselect_b32 s37, s13, s15
    s_cselect_b32 s60, 6, 9
    s_sub_u32 s60, s59, s60
    s_lshl_b32 s60, s60, 6
    v_add_u32_e64 v190, s60, v185
    v_mul_u32_u24 v191, 171, v190
    v_lshrrev_b32_e64 v191, 10, v191
    v_mul_u32_u24 v191, 2304, v191
    v_lshl_add_u32 v190, v190, 7, v191
    s_mul_i32 s60, s54, 98304
    s_mul_i32 s61, s3, 768
    s_add_u32 s60, s60, s61
    v_add_u32 v190, s60, v190
    s_lshl_b32 s60, s59, 6
    v_add_u32 v191, s60, v185
    v_min_u32 v191, 287, v191
    s_mul_i32 s60, s54, 1152
    s_mul_i32 s61, s3, 288
    s_add_u32 s60, s60, s61
    v_add_u32 v191, s60, v191
    v_mul_u32_u24 v191, 1280, v191
    s_cmp_lt_u32 s59, 6
    s_cselect_b64 vcc, -1, 0
    s_cselect_b32 s36, s4, s36
    s_cselect_b32 s37, s5, s37
    s_mov_b32 s38, 1966080
    s_cselect_b32 s38, 2621440, s38
    s_mov_b32 s49, 196608
    s_cselect_b32 s49, 128, s49
    s_mov_b32 s39, 0x20000
    v_cndmask_b32 v190, v190, v191, vcc
    s_cmp_lg_u32 s50, 1
    s_cbranch_scc1 L_t57
    s_mul_i32 s84, s49, 1
    buffer_load_dword v191, v190, s[36:39], s84 offen
L_t57:
    s_cmp_lg_u32 s50, 2
    s_cbranch_scc1 L_t58
    s_mul_i32 s84, s49, 2
    buffer_load_dword v191, v190, s[36:39], s84 offen
L_t58:
    s_mul_i32 s51, s81, 12
    s_add_u32 s51, s51, s80
    s_lshl_b32 s51, s51, 9
    v_lshrrev_b32 v186, 5, v185
    v_lshlrev_b32 v186, 30, v186
    v_lshl_add_u32 v189, v185, 2, v186
    v_mov_b32 v175, 163584
    v_mov_b32_e64 v186, 0
    v_lshl_add_u32 v187, v185, 2, v175
    ds_write_b32 v187, v186
    s_lshl_b32 s19, 1, s44
    s_add_u32 s68, s20, 0xc10000
    s_addc_u32 s69, s21, 0
    s_mov_b32 s70, 81920
    s_mov_b32 s71, 0x20000
    s_mov_b32 s32, s20
    s_mov_b32 s33, s21
    s_mov_b32 s34, 8912896
    s_mov_b32 s35, 0x20000
    s_add_u32 s40, s20, 0x900000
    s_addc_u32 s41, s21, 0
    s_mov_b32 s42, 2785280
    s_mov_b32 s43, 0x20000
    s_add_u32 s64, s20, 0xc00000
    s_addc_u32 s65, s21, 0
    s_mov_b32 s66, 32768
    s_mov_b32 s67, 0x20000
    s_mov_b32 s72, s22
    s_mov_b32 s73, s23
    s_mov_b32 s74, 256
    s_mov_b32 s75, 0x20000
    s_mov_b32 s76, s82
    s_mov_b32 s77, s83
    s_mov_b32 s78, 2621440
    s_mov_b32 s79, 0x20000
    s_lshl_b32 s52, s44, 1
    v_bfe_u32 v186, v185, 2, 3
    v_xor_b32 v187, s52, v186
    v_lshlrev_b32_e64 v187, 5, v187
    v_lshl_add_u32 v187, v186, 8, v187
    v_lshrrev_b32_e64 v186, 5, v185
    v_lshl_add_u32 v187, v186, 12, v187
    v_and_b32_e64 v186, 3, v185
    v_lshl_add_u32 v180, v186, 3, v187
    v_xor_b32_e64 v181, 32, v180
    v_bfe_u32 v186, v185, 1, 3
    v_lshrrev_b32 v187, 5, v185
    v_xor_b32 v186, v186, v187
    v_lshlrev_b32 v186, 4, v186
    v_and_b32 v187, 31, v185
    v_lshl_add_u32 v186, v187, 7, v186
    v_add_u32 v176, 98304, v186
    v_xor_b32 v177, 32, v176
    v_xor_b32 v178, 64, v176
    v_xor_b32 v179, 96, v176
    v_bfe_u32 v186, v185, 4, 1
    v_mul_u32_u24 v186, 69632, v186
    v_lshrrev_b32_e64 v187, 5, v185
    v_lshl_add_u32 v186, v187, 8, v186
    v_and_b32_e64 v187, 15, v185
    v_lshl_add_u32 v184, v187, 4, v186
    v_lshlrev_b32_e64 v188, 4, v185
    s_mul_i32 s16, s81, 835584
    s_lshl_b32 s52, s80, 2
    s_add_u32 s52, s52, s44
    s_add_u32 s52, s52, 20
    s_lshl_b32 s52, s52, 10
    s_add_u32 s16, s16, s52
    s_mov_b32 s17, 0xbfb8aa3b
    s_mov_b32 s18, s51
    s_add_u32 m0, s48, 16384
    s_add_u32 s61, s46, 128
    buffer_load_dwordx4 v183, s[24:27], s61 offen lds
    s_add_u32 m0, s48, 20480
    s_add_u32 s61, s46, 41088
    buffer_load_dwordx4 v183, s[24:27], s61 offen lds
    s_add_u32 m0, s47, 16384
    s_add_u32 s45, s45, 24576
    buffer_load_dwordx4 v182, s[28:31], s45 offen lds
    s_add_u32 m0, s47, 20480
    s_add_u32 s45, s45, 24576
    buffer_load_dwordx4 v182, s[28:31], s45 offen lds
    s_add_u32 m0, s48, 24576
    s_add_u32 s61, s46, 82048
    buffer_load_dwordx4 v183, s[24:27], s61 offen lds
    s_add_u32 m0, s47, 24576
    s_add_u32 s45, s45, 24576
    buffer_load_dwordx4 v182, s[28:31], s45 offen lds
    s_add_u32 m0, s47, 28672
    s_add_u32 s45, s45, 24576
    buffer_load_dwordx4 v182, s[28:31], s45 offen lds
    s_add_u32 m0, s48, 28672
    s_add_u32 s61, s46, 123008
    buffer_load_dwordx4 v183, s[24:27], s61 offen lds
    s_waitcnt vmcnt(10) lgkmcnt(0)
    s_barrier
    ds_read_b64_tr_b16 a[0:1], v180 offset:0
    ds_read_b64_tr_b16 a[2:3], v180 offset:2048
    ds_read_b128 v[128:131], v176 offset:0
    ds_read_b64_tr_b16 a[4:5], v181 offset:0
    ds_read_b64_tr_b16 a[6:7], v181 offset:2048
    ds_read_b128 v[132:135], v176 offset:4096
    ds_read_b128 v[136:139], v176 offset:8192
    ds_read_b128 v[140:143], v176 offset:12288
    s_waitcnt lgkmcnt(5)
    v_mfma_f32_32x32x16_bf16 v[0:15], a[0:3], v[128:131], 0
    s_waitcnt lgkmcnt(3)
    s_add_u32 m0, s47, 32768
    s_add_u32 s45, s45, 24576
    buffer_load_dwordx4 v182, s[28:31], s45 offen lds
    v_mfma_f32_32x32x16_bf16 v[16:31], a[4:7], v[128:131], 0
    s_waitcnt vmcnt(9) lgkmcnt(0)
    s_barrier
    ds_read_b64_tr_b16 a[8:9], v180 offset:8192
    v_mfma_f32_32x32x16_bf16 v[32:47], a[0:3], v[132:135], 0
    ds_read_b64_tr_b16 a[10:11], v180 offset:10240
    ds_read_b128 v[144:147], v177 offset:0
    s_add_u32 m0, s47, 36864
    s_add_u32 s45, s45, 24576
    buffer_load_dwordx4 v182, s[28:31], s45 offen lds
    v_mfma_f32_32x32x16_bf16 v[48:63], a[4:7], v[132:135], 0
    ds_read_b64_tr_b16 a[12:13], v181 offset:8192
    ds_read_b64_tr_b16 a[14:15], v181 offset:10240
    v_mfma_f32_32x32x16_bf16 v[64:79], a[0:3], v[136:139], 0
    ds_read_b128 v[148:151], v177 offset:4096
    v_mfma_f32_32x32x16_bf16 v[80:95], a[4:7], v[136:139], 0
    ds_read_b128 v[152:155], v177 offset:8192
    s_add_u32 m0, s48, 32768
    s_add_u32 s61, s46, 256
    buffer_load_dwordx4 v183, s[24:27], s61 offen lds
    v_mfma_f32_32x32x16_bf16 v[96:111], a[0:3], v[140:143], 0
    ds_read_b128 v[156:159], v177 offset:12288
    v_mfma_f32_32x32x16_bf16 v[112:127], a[4:7], v[140:143], 0
    s_waitcnt lgkmcnt(5)
    v_mfma_f32_32x32x16_bf16 v[0:15], a[8:11], v[144:147], v[0:15]
    s_waitcnt lgkmcnt(3)
    s_add_u32 m0, s47, 40960
    s_add_u32 s45, s45, 24576
    buffer_load_dwordx4 v182, s[28:31], s45 offen lds
    v_mfma_f32_32x32x16_bf16 v[16:31], a[12:15], v[144:147], v[16:31]
    s_waitcnt vmcnt(8) lgkmcnt(0)
    s_barrier
    ds_read_b64_tr_b16 a[16:17], v180 offset:16384
    v_mfma_f32_32x32x16_bf16 v[32:47], a[8:11], v[148:151], v[32:47]
    ds_read_b64_tr_b16 a[18:19], v180 offset:18432
    ds_read_b128 v[128:131], v178 offset:0
    s_add_u32 m0, s47, 45056
    s_add_u32 s45, s45, 24576
    buffer_load_dwordx4 v182, s[28:31], s45 offen lds
    v_mfma_f32_32x32x16_bf16 v[48:63], a[12:15], v[148:151], v[48:63]
    ds_read_b64_tr_b16 a[20:21], v181 offset:16384
    ds_read_b64_tr_b16 a[22:23], v181 offset:18432
    v_mfma_f32_32x32x16_bf16 v[64:79], a[8:11], v[152:155], v[64:79]
    ds_read_b128 v[132:135], v178 offset:4096
    v_mfma_f32_32x32x16_bf16 v[80:95], a[12:15], v[152:155], v[80:95]
    ds_read_b128 v[136:139], v178 offset:8192
    s_add_u32 m0, s48, 36864
    s_add_u32 s61, s46, 41216
    buffer_load_dwordx4 v183, s[24:27], s61 offen lds
    v_mfma_f32_32x32x16_bf16 v[96:111], a[8:11], v[156:159], v[96:111]
    ds_read_b128 v[140:143], v178 offset:12288
    v_mfma_f32_32x32x16_bf16 v[112:127], a[12:15], v[156:159], v[112:127]
    s_waitcnt lgkmcnt(5)
    v_mfma_f32_32x32x16_bf16 v[0:15], a[16:19], v[128:131], v[0:15]
    s_waitcnt lgkmcnt(3)
    s_add_u32 m0, s47, 49152
    s_add_u32 s45, s45, 24576
    buffer_load_dwordx4 v182, s[28:31], s45 offen lds
    v_mfma_f32_32x32x16_bf16 v[16:31], a[20:23], v[128:131], v[16:31]
    s_waitcnt vmcnt(8) lgkmcnt(0)
    s_barrier
    ds_read_b64_tr_b16 a[24:25], v180 offset:24576
    v_mfma_f32_32x32x16_bf16 v[32:47], a[16:19], v[132:135], v[32:47]
    ds_read_b64_tr_b16 a[26:27], v180 offset:26624
    ds_read_b128 v[144:147], v179 offset:0
    s_add_u32 m0, s47, 53248
    s_add_u32 s45, s45, 24576
    buffer_load_dwordx4 v182, s[28:31], s45 offen lds
    v_mfma_f32_32x32x16_bf16 v[48:63], a[20:23], v[132:135], v[48:63]
    ds_read_b64_tr_b16 a[28:29], v181 offset:24576
    ds_read_b64_tr_b16 a[30:31], v181 offset:26624
    v_mfma_f32_32x32x16_bf16 v[64:79], a[16:19], v[136:139], v[64:79]
    ds_read_b128 v[148:151], v179 offset:4096
    v_mfma_f32_32x32x16_bf16 v[80:95], a[20:23], v[136:139], v[80:95]
    ds_read_b128 v[152:155], v179 offset:8192
    s_add_u32 m0, s48, 40960
    s_add_u32 s61, s46, 82176
    buffer_load_dwordx4 v183, s[24:27], s61 offen lds
    v_mfma_f32_32x32x16_bf16 v[96:111], a[16:19], v[140:143], v[96:111]
    ds_read_b128 v[156:159], v179 offset:12288
    v_mfma_f32_32x32x16_bf16 v[112:127], a[20:23], v[140:143], v[112:127]
    s_waitcnt lgkmcnt(5)
    v_mfma_f32_32x32x16_bf16 v[0:15], a[24:27], v[144:147], v[0:15]
    s_waitcnt lgkmcnt(3)
    s_add_u32 m0, s47, 57344
    s_add_u32 s45, s45, 24576
    buffer_load_dwordx4 v182, s[28:31], s45 offen lds
    v_mfma_f32_32x32x16_bf16 v[16:31], a[28:31], v[144:147], v[16:31]
    s_waitcnt vmcnt(8) lgkmcnt(0)
    s_barrier
    v_add_u32 v180, 32768, v180
    v_add_u32 v181, 32768, v181
    ds_read_b64_tr_b16 a[32:33], v180 offset:0
    v_mfma_f32_32x32x16_bf16 v[32:47], a[24:27], v[148:151], v[32:47]
    ds_read_b64_tr_b16 a[34:35], v180 offset:2048
    ds_read_b128 v[128:131], v176 offset:16384
    s_add_u32 m0, s47, 61440
    s_add_u32 s45, s45, 24576
    buffer_load_dwordx4 v182, s[28:31], s45 offen lds
    v_mfma_f32_32x32x16_bf16 v[48:63], a[28:31], v[148:151], v[48:63]
    ds_read_b64_tr_b16 a[36:37], v181 offset:0
    ds_read_b64_tr_b16 a[38:39], v181 offset:2048
    v_mfma_f32_32x32x16_bf16 v[64:79], a[24:27], v[152:155], v[64:79]
    ds_read_b128 v[132:135], v176 offset:20480
    s_cmp_lg_u32 s50, 3
    s_cbranch_scc1 L_t59
    s_mul_i32 s84, s49, 3
    buffer_load_dword v191, v190, s[36:39], s84 offen
L_t59:
    s_cmp_lg_u32 s50, 4
    s_cbranch_scc1 L_t60
    s_mul_i32 s84, s49, 4
    buffer_load_dword v191, v190, s[36:39], s84 offen
L_t60:
    v_mfma_f32_32x32x16_bf16 v[80:95], a[28:31], v[152:155], v[80:95]
    ds_read_b128 v[136:139], v176 offset:24576
    s_add_u32 m0, s48, 45056
    s_add_u32 s61, s46, 123136
    buffer_load_dwordx4 v183, s[24:27], s61 offen lds
    v_mfma_f32_32x32x16_bf16 v[96:111], a[24:27], v[156:159], v[96:111]
    ds_read_b128 v[140:143], v176 offset:28672
    v_mfma_f32_32x32x16_bf16 v[112:127], a[28:31], v[156:159], v[112:127]
    s_waitcnt lgkmcnt(5)
    v_mfma_f32_32x32x16_bf16 v[0:15], a[32:35], v[128:131], v[0:15]
    s_waitcnt lgkmcnt(3)
    s_add_u32 m0, s47, 65536
    s_add_u32 s45, s45, 24576
    buffer_load_dwordx4 v182, s[28:31], s45 offen lds
    v_mfma_f32_32x32x16_bf16 v[16:31], a[36:39], v[128:131], v[16:31]
    s_waitcnt vmcnt(8) lgkmcnt(0)
    s_barrier
    ds_read_b64_tr_b16 a[40:41], v180 offset:8192
    v_mfma_f32_32x32x16_bf16 v[32:47], a[32:35], v[132:135], v[32:47]
    ds_read_b64_tr_b16 a[42:43], v180 offset:10240
    ds_read_b128 v[144:147], v177 offset:16384
    s_add_u32 m0, s47, 69632
    s_add_u32 s45, s45, 24576
    buffer_load_dwordx4 v182, s[28:31], s45 offen lds
    v_mfma_f32_32x32x16_bf16 v[48:63], a[36:39], v[132:135], v[48:63]
    ds_read_b64_tr_b16 a[44:45], v181 offset:8192
    ds_read_b64_tr_b16 a[46:47], v181 offset:10240
    v_mfma_f32_32x32x16_bf16 v[64:79], a[32:35], v[136:139], v[64:79]
    ds_read_b128 v[148:151], v177 offset:20480
    v_mfma_f32_32x32x16_bf16 v[80:95], a[36:39], v[136:139], v[80:95]
    ds_read_b128 v[152:155], v177 offset:24576
    s_add_u32 m0, s48, 0
    s_add_u32 s61, s46, 384
    buffer_load_dwordx4 v183, s[24:27], s61 offen lds
    v_mfma_f32_32x32x16_bf16 v[96:111], a[32:35], v[140:143], v[96:111]
    ds_read_b128 v[156:159], v177 offset:28672
    v_mfma_f32_32x32x16_bf16 v[112:127], a[36:39], v[140:143], v[112:127]
    s_waitcnt lgkmcnt(5)
    v_mfma_f32_32x32x16_bf16 v[0:15], a[40:43], v[144:147], v[0:15]
    s_waitcnt lgkmcnt(3)
    s_add_u32 m0, s47, 73728
    s_add_u32 s45, s45, 24576
    buffer_load_dwordx4 v182, s[28:31], s45 offen lds
    v_mfma_f32_32x32x16_bf16 v[16:31], a[44:47], v[144:147], v[16:31]
    s_waitcnt vmcnt(8) lgkmcnt(0)
    s_barrier
    ds_read_b64_tr_b16 a[48:49], v180 offset:16384
    v_mfma_f32_32x32x16_bf16 v[32:47], a[40:43], v[148:151], v[32:47]
    ds_read_b64_tr_b16 a[50:51], v180 offset:18432
    ds_read_b128 v[128:131], v178 offset:16384
    s_add_u32 m0, s47, 77824
    s_add_u32 s45, s45, 24576
    buffer_load_dwordx4 v182, s[28:31], s45 offen lds
    v_mfma_f32_32x32x16_bf16 v[48:63], a[44:47], v[148:151], v[48:63]
    ds_read_b64_tr_b16 a[52:53], v181 offset:16384
    ds_read_b64_tr_b16 a[54:55], v181 offset:18432
    v_mfma_f32_32x32x16_bf16 v[64:79], a[40:43], v[152:155], v[64:79]
    ds_read_b128 v[132:135], v178 offset:20480
    v_mfma_f32_32x32x16_bf16 v[80:95], a[44:47], v[152:155], v[80:95]
    ds_read_b128 v[136:139], v178 offset:24576
    s_add_u32 m0, s48, 4096
    s_add_u32 s61, s46, 41344
    buffer_load_dwordx4 v183, s[24:27], s61 offen lds
    v_mfma_f32_32x32x16_bf16 v[96:111], a[40:43], v[156:159], v[96:111]
    ds_read_b128 v[140:143], v178 offset:28672
    v_mfma_f32_32x32x16_bf16 v[112:127], a[44:47], v[156:159], v[112:127]
    s_waitcnt lgkmcnt(5)
    v_mfma_f32_32x32x16_bf16 v[0:15], a[48:51], v[128:131], v[0:15]
    s_waitcnt lgkmcnt(3)
    s_add_u32 m0, s47, 81920
    s_add_u32 s45, s45, 24576
    buffer_load_dwordx4 v182, s[28:31], s45 offen lds
    v_mfma_f32_32x32x16_bf16 v[16:31], a[52:55], v[128:131], v[16:31]
    s_waitcnt vmcnt(8) lgkmcnt(0)
    s_barrier
    ds_read_b64_tr_b16 a[56:57], v180 offset:24576
    v_mfma_f32_32x32x16_bf16 v[32:47], a[48:51], v[132:135], v[32:47]
    ds_read_b64_tr_b16 a[58:59], v180 offset:26624
    ds_read_b128 v[144:147], v179 offset:16384
    s_add_u32 m0, s47, 86016
    s_add_u32 s45, s45, 24576
    buffer_load_dwordx4 v182, s[28:31], s45 offen lds
    v_mfma_f32_32x32x16_bf16 v[48:63], a[52:55], v[132:135], v[48:63]
    ds_read_b64_tr_b16 a[60:61], v181 offset:24576
    ds_read_b64_tr_b16 a[62:63], v181 offset:26624
    v_mfma_f32_32x32x16_bf16 v[64:79], a[48:51], v[136:139], v[64:79]
    ds_read_b128 v[148:151], v179 offset:20480
    v_mfma_f32_32x32x16_bf16 v[80:95], a[52:55], v[136:139], v[80:95]
    ds_read_b128 v[152:155], v179 offset:24576
    s_add_u32 m0, s48, 8192
    s_add_u32 s61, s46, 82304
    buffer_load_dwordx4 v183, s[24:27], s61 offen lds
    v_mfma_f32_32x32x16_bf16 v[96:111], a[48:51], v[140:143], v[96:111]
    ds_read_b128 v[156:159], v179 offset:28672
    v_mfma_f32_32x32x16_bf16 v[112:127], a[52:55], v[140:143], v[112:127]
    s_waitcnt lgkmcnt(5)
    v_mfma_f32_32x32x16_bf16 v[0:15], a[56:59], v[144:147], v[0:15]
    s_waitcnt lgkmcnt(3)
    s_add_u32 m0, s47, 90112
    s_add_u32 s45, s45, 24576
    buffer_load_dwordx4 v182, s[28:31], s45 offen lds
    v_mfma_f32_32x32x16_bf16 v[16:31], a[60:63], v[144:147], v[16:31]
    s_waitcnt vmcnt(8) lgkmcnt(0)
    s_barrier
    v_add_u32 v180, 32768, v180
    v_add_u32 v181, 32768, v181
    ds_read_b64_tr_b16 a[64:65], v180 offset:0
    v_mfma_f32_32x32x16_bf16 v[32:47], a[56:59], v[148:151], v[32:47]
    ds_read_b64_tr_b16 a[66:67], v180 offset:2048
    ds_read_b128 v[128:131], v176 offset:32768
    s_add_u32 m0, s47, 94208
    s_add_u32 s45, s45, 24576
    buffer_load_dwordx4 v182, s[28:31], s45 offen lds
    v_mfma_f32_32x32x16_bf16 v[48:63], a[60:63], v[148:151], v[48:63]
    ds_read_b64_tr_b16 a[68:69], v181 offset:0
    ds_read_b64_tr_b16 a[70:71], v181 offset:2048
    s_lshr_b32 s53, s2, 3
    s_lshr_b32 s54, s2, 6
    s_and_b32 s55, s2, 1
    v_mfma_f32_32x32x16_bf16 v[64:79], a[56:59], v[152:155], v[64:79]
    ds_read_b128 v[132:135], v176 offset:36864
    s_cmp_lg_u32 s50, 0
    s_cbranch_scc1 L_t61
    s_mul_i32 s84, s49, 5
    buffer_load_dword v191, v190, s[36:39], s84 offen
L_t61:
    s_lshl_b32 s55, s55, 2
    s_add_u32 s54, s54, s55
    v_mfma_f32_32x32x16_bf16 v[80:95], a[60:63], v[152:155], v[80:95]
    ds_read_b128 v[136:139], v176 offset:40960
    s_add_u32 m0, s48, 12288
    s_add_u32 s61, s46, 123264
    buffer_load_dwordx4 v183, s[24:27], s61 offen lds
    v_mfma_f32_32x32x16_bf16 v[96:111], a[56:59], v[156:159], v[96:111]
    ds_read_b128 v[140:143], v176 offset:45056
    s_and_b32 s55, s53, 3
    s_mov_b32 s56, 4
    s_mul_i32 s59, s54, 348160
    s_mul_i32 s10, s44, 61440
    s_add_u32 s10, s10, s59
    v_mfma_f32_32x32x16_bf16 v[112:127], a[60:63], v[156:159], v[112:127]
    s_waitcnt lgkmcnt(5)
    s_add_u32 s10, s10, 102400
    s_mul_i32 s11, s44, 20480
    s_add_u32 s11, s11, s59
    s_mul_i32 s3, s44, 5120
    s_add_u32 s3, s3, s59
    s_add_u32 s3, s3, 81920
    v_mfma_f32_32x32x16_bf16 v[0:15], a[64:67], v[128:131], v[0:15]
    s_waitcnt lgkmcnt(3)
    s_add_u32 m0, s47, 0
    s_add_u32 s45, s45, 24576
    buffer_load_dwordx4 v182, s[28:31], s45 offen lds
    v_mfma_f32_32x32x16_bf16 v[16:31], a[68:71], v[128:131], v[16:31]
    s_waitcnt vmcnt(8) lgkmcnt(0)
    s_barrier
    ds_read_b64_tr_b16 a[72:73], v180 offset:8192
    v_mfma_f32_32x32x16_bf16 v[32:47], a[64:67], v[132:135], v[32:47]
    ds_read_b64_tr_b16 a[74:75], v180 offset:10240
    ds_read_b128 v[144:147], v177 offset:32768
    s_add_u32 m0, s47, 4096
    s_add_u32 s45, s45, 24576
    buffer_load_dwordx4 v182, s[28:31], s45 offen lds
    v_mfma_f32_32x32x16_bf16 v[48:63], a[68:71], v[132:135], v[48:63]
    ds_read_b64_tr_b16 a[76:77], v181 offset:8192
    ds_read_b64_tr_b16 a[78:79], v181 offset:10240
    v_mfma_f32_32x32x16_bf16 v[64:79], a[64:67], v[136:139], v[64:79]
    ds_read_b128 v[148:151], v177 offset:36864
    v_mfma_f32_32x32x16_bf16 v[80:95], a[68:71], v[136:139], v[80:95]
    ds_read_b128 v[152:155], v177 offset:40960
    s_add_u32 m0, s48, 16384
    s_add_u32 s61, s46, 512
    buffer_load_dwordx4 v183, s[24:27], s61 offen lds
    v_mfma_f32_32x32x16_bf16 v[96:111], a[64:67], v[140:143], v[96:111]
    ds_read_b128 v[156:159], v177 offset:45056
    v_mfma_f32_32x32x16_bf16 v[112:127], a[68:71], v[140:143], v[112:127]
    s_waitcnt lgkmcnt(5)
    v_mfma_f32_32x32x16_bf16 v[0:15], a[72:75], v[144:147], v[0:15]
    s_waitcnt lgkmcnt(3)
    s_add_u32 m0, s47, 8192
    s_add_u32 s45, s45, 24576
    buffer_load_dwordx4 v182, s[28:31], s45 offen lds
    v_mfma_f32_32x32x16_bf16 v[16:31], a[76:79], v[144:147], v[16:31]
    s_waitcnt vmcnt(8) lgkmcnt(0)
    s_barrier
    ds_read_b64_tr_b16 a[80:81], v180 offset:16384
    v_mfma_f32_32x32x16_bf16 v[32:47], a[72:75], v[148:151], v[32:47]
    ds_read_b64_tr_b16 a[82:83], v180 offset:18432
    ds_read_b128 v[128:131], v178 offset:32768
    s_add_u32 m0, s47, 12288
    s_add_u32 s45, s45, 24576
    buffer_load_dwordx4 v182, s[28:31], s45 offen lds
    v_mfma_f32_32x32x16_bf16 v[48:63], a[76:79], v[148:151], v[48:63]
    ds_read_b64_tr_b16 a[84:85], v181 offset:16384
    ds_read_b64_tr_b16 a[86:87], v181 offset:18432
    v_mfma_f32_32x32x16_bf16 v[64:79], a[72:75], v[152:155], v[64:79]
    ds_read_b128 v[132:135], v178 offset:36864
    v_mfma_f32_32x32x16_bf16 v[80:95], a[76:79], v[152:155], v[80:95]
    ds_read_b128 v[136:139], v178 offset:40960
    s_add_u32 m0, s48, 20480
    s_add_u32 s61, s46, 41472
    buffer_load_dwordx4 v183, s[24:27], s61 offen lds
    v_mfma_f32_32x32x16_bf16 v[96:111], a[72:75], v[156:159], v[96:111]
    ds_read_b128 v[140:143], v178 offset:45056
    v_mfma_f32_32x32x16_bf16 v[112:127], a[76:79], v[156:159], v[112:127]
    s_waitcnt lgkmcnt(5)
    v_mfma_f32_32x32x16_bf16 v[0:15], a[80:83], v[128:131], v[0:15]
    s_waitcnt lgkmcnt(3)
    s_add_u32 m0, s47, 16384
    s_add_u32 s45, s45, 24576
    buffer_load_dwordx4 v182, s[28:31], s45 offen lds
    v_mfma_f32_32x32x16_bf16 v[16:31], a[84:87], v[128:131], v[16:31]
    s_waitcnt vmcnt(8) lgkmcnt(0)
    s_barrier
    ds_read_b64_tr_b16 a[88:89], v180 offset:24576
    v_mfma_f32_32x32x16_bf16 v[32:47], a[80:83], v[132:135], v[32:47]
    ds_read_b64_tr_b16 a[90:91], v180 offset:26624
    ds_read_b128 v[144:147], v179 offset:32768
    s_add_u32 m0, s47, 20480
    s_add_u32 s45, s45, 24576
    buffer_load_dwordx4 v182, s[28:31], s45 offen lds
    v_mfma_f32_32x32x16_bf16 v[48:63], a[84:87], v[132:135], v[48:63]
    ds_read_b64_tr_b16 a[92:93], v181 offset:24576
    ds_read_b64_tr_b16 a[94:95], v181 offset:26624
    v_mfma_f32_32x32x16_bf16 v[64:79], a[80:83], v[136:139], v[64:79]
    ds_read_b128 v[148:151], v179 offset:36864
    v_mfma_f32_32x32x16_bf16 v[80:95], a[84:87], v[136:139], v[80:95]
    ds_read_b128 v[152:155], v179 offset:40960
    s_add_u32 m0, s48, 24576
    s_add_u32 s61, s46, 82432
    buffer_load_dwordx4 v183, s[24:27], s61 offen lds
    v_mfma_f32_32x32x16_bf16 v[96:111], a[80:83], v[140:143], v[96:111]
    ds_read_b128 v[156:159], v179 offset:45056
    v_mfma_f32_32x32x16_bf16 v[112:127], a[84:87], v[140:143], v[112:127]
    s_waitcnt lgkmcnt(5)
    v_mfma_f32_32x32x16_bf16 v[0:15], a[88:91], v[144:147], v[0:15]
    s_waitcnt lgkmcnt(3)
    s_add_u32 m0, s47, 24576
    s_add_u32 s45, s45, 24576
    buffer_load_dwordx4 v182, s[28:31], s45 offen lds
    v_mfma_f32_32x32x16_bf16 v[16:31], a[92:95], v[144:147], v[16:31]
    s_waitcnt vmcnt(8) lgkmcnt(0)
    s_barrier
    v_subrev_u32 v180, 65536, v180
    v_subrev_u32 v181, 65536, v181
    ds_read_b64_tr_b16 a[96:97], v180 offset:0
    v_mfma_f32_32x32x16_bf16 v[32:47], a[88:91], v[148:151], v[32:47]
    ds_read_b64_tr_b16 a[98:99], v180 offset:2048
    ds_read_b128 v[128:131], v176 offset:0
    s_add_u32 m0, s47, 28672
    s_add_u32 s45, s45, 24576
    buffer_load_dwordx4 v182, s[28:31], s45 offen lds
    v_mfma_f32_32x32x16_bf16 v[48:63], a[92:95], v[148:151], v[48:63]
    ds_read_b64_tr_b16 a[100:101], v181 offset:0
    ds_read_b64_tr_b16 a[102:103], v181 offset:2048
    v_mfma_f32_32x32x16_bf16 v[64:79], a[88:91], v[152:155], v[64:79]
    ds_read_b128 v[132:135], v176 offset:4096
    s_cmp_lg_u32 s50, 1
    s_cbranch_scc1 L_t62
    s_mul_i32 s84, s49, 6
    buffer_load_dword v191, v190, s[36:39], s84 offen
L_t62:
    v_mfma_f32_32x32x16_bf16 v[80:95], a[92:95], v[152:155], v[80:95]
    ds_read_b128 v[136:139], v176 offset:8192
    s_add_u32 m0, s48, 28672
    s_add_u32 s61, s46, 123392
    buffer_load_dwordx4 v183, s[24:27], s61 offen lds
    v_mfma_f32_32x32x16_bf16 v[96:111], a[88:91], v[156:159], v[96:111]
    ds_read_b128 v[140:143], v176 offset:12288
    v_mfma_f32_32x32x16_bf16 v[112:127], a[92:95], v[156:159], v[112:127]
    s_waitcnt lgkmcnt(5)
    v_mfma_f32_32x32x16_bf16 v[0:15], a[96:99], v[128:131], v[0:15]
    s_waitcnt lgkmcnt(3)
    s_add_u32 m0, s47, 32768
    s_add_u32 s45, s45, 24576
    buffer_load_dwordx4 v182, s[28:31], s45 offen lds
    v_mfma_f32_32x32x16_bf16 v[16:31], a[100:103], v[128:131], v[16:31]
    s_waitcnt vmcnt(8) lgkmcnt(0)
    s_barrier
    ds_read_b64_tr_b16 a[104:105], v180 offset:8192
    v_mfma_f32_32x32x16_bf16 v[32:47], a[96:99], v[132:135], v[32:47]
    ds_read_b64_tr_b16 a[106:107], v180 offset:10240
    ds_read_b128 v[144:147], v177 offset:0
    s_add_u32 m0, s47, 36864
    s_add_u32 s45, s45, 24576
    buffer_load_dwordx4 v182, s[28:31], s45 offen lds
    v_mfma_f32_32x32x16_bf16 v[48:63], a[100:103], v[132:135], v[48:63]
    ds_read_b64_tr_b16 a[108:109], v181 offset:8192
    ds_read_b64_tr_b16 a[110:111], v181 offset:10240
    v_mfma_f32_32x32x16_bf16 v[64:79], a[96:99], v[136:139], v[64:79]
    ds_read_b128 v[148:151], v177 offset:4096
    v_mfma_f32_32x32x16_bf16 v[80:95], a[100:103], v[136:139], v[80:95]
    ds_read_b128 v[152:155], v177 offset:8192
    s_add_u32 m0, s48, 32768
    s_add_u32 s61, s46, 640
    buffer_load_dwordx4 v183, s[24:27], s61 offen lds
    v_mfma_f32_32x32x16_bf16 v[96:111], a[96:99], v[140:143], v[96:111]
    ds_read_b128 v[156:159], v177 offset:12288
    v_mfma_f32_32x32x16_bf16 v[112:127], a[100:103], v[140:143], v[112:127]
    s_waitcnt lgkmcnt(5)
    v_mfma_f32_32x32x16_bf16 v[0:15], a[104:107], v[144:147], v[0:15]
    s_waitcnt lgkmcnt(3)
    s_add_u32 m0, s47, 40960
    s_add_u32 s45, s45, 24576
    buffer_load_dwordx4 v182, s[28:31], s45 offen lds
    v_mfma_f32_32x32x16_bf16 v[16:31], a[108:111], v[144:147], v[16:31]
    s_waitcnt vmcnt(8) lgkmcnt(0)
    s_barrier
    ds_read_b64_tr_b16 a[112:113], v180 offset:16384
    v_mfma_f32_32x32x16_bf16 v[32:47], a[104:107], v[148:151], v[32:47]
    ds_read_b64_tr_b16 a[114:115], v180 offset:18432
    ds_read_b128 v[128:131], v178 offset:0
    s_add_u32 m0, s47, 45056
    s_add_u32 s45, s45, 24576
    buffer_load_dwordx4 v182, s[28:31], s45 offen lds
    v_mfma_f32_32x32x16_bf16 v[48:63], a[108:111], v[148:151], v[48:63]
    ds_read_b64_tr_b16 a[116:117], v181 offset:16384
    ds_read_b64_tr_b16 a[118:119], v181 offset:18432
    v_mfma_f32_32x32x16_bf16 v[64:79], a[104:107], v[152:155], v[64:79]
    ds_read_b128 v[132:135], v178 offset:4096
    v_mfma_f32_32x32x16_bf16 v[80:95], a[108:111], v[152:155], v[80:95]
    ds_read_b128 v[136:139], v178 offset:8192
    s_add_u32 m0, s48, 36864
    s_add_u32 s61, s46, 41600
    buffer_load_dwordx4 v183, s[24:27], s61 offen lds
    v_mfma_f32_32x32x16_bf16 v[96:111], a[104:107], v[156:159], v[96:111]
    ds_read_b128 v[140:143], v178 offset:12288
    v_mfma_f32_32x32x16_bf16 v[112:127], a[108:111], v[156:159], v[112:127]
    s_waitcnt lgkmcnt(5)
    v_mfma_f32_32x32x16_bf16 v[0:15], a[112:115], v[128:131], v[0:15]
    s_waitcnt lgkmcnt(3)
    s_add_u32 m0, s47, 49152
    s_add_u32 s45, s45, 24576
    buffer_load_dwordx4 v182, s[28:31], s45 offen lds
    v_mfma_f32_32x32x16_bf16 v[16:31], a[116:119], v[128:131], v[16:31]
    s_waitcnt vmcnt(8) lgkmcnt(0)
    s_barrier
    ds_read_b64_tr_b16 a[120:121], v180 offset:24576
    v_mfma_f32_32x32x16_bf16 v[32:47], a[112:115], v[132:135], v[32:47]
    ds_read_b64_tr_b16 a[122:123], v180 offset:26624
    ds_read_b128 v[144:147], v179 offset:0
    s_add_u32 m0, s47, 53248
    s_add_u32 s45, s45, 24576
    buffer_load_dwordx4 v182, s[28:31], s45 offen lds
    v_mfma_f32_32x32x16_bf16 v[48:63], a[116:119], v[132:135], v[48:63]
    ds_read_b64_tr_b16 a[124:125], v181 offset:24576
    ds_read_b64_tr_b16 a[126:127], v181 offset:26624
    v_mfma_f32_32x32x16_bf16 v[64:79], a[112:115], v[136:139], v[64:79]
    ds_read_b128 v[148:151], v179 offset:4096
    v_mfma_f32_32x32x16_bf16 v[80:95], a[116:119], v[136:139], v[80:95]
    ds_read_b128 v[152:155], v179 offset:8192
    s_add_u32 m0, s48, 40960
    s_add_u32 s61, s46, 82560
    buffer_load_dwordx4 v183, s[24:27], s61 offen lds
    v_mfma_f32_32x32x16_bf16 v[96:111], a[112:115], v[140:143], v[96:111]
    ds_read_b128 v[156:159], v179 offset:12288
    v_mfma_f32_32x32x16_bf16 v[112:127], a[116:119], v[140:143], v[112:127]
    s_waitcnt lgkmcnt(5)
    v_mfma_f32_32x32x16_bf16 v[0:15], a[120:123], v[144:147], v[0:15]
    s_waitcnt lgkmcnt(3)
    s_add_u32 m0, s47, 57344
    s_add_u32 s45, s45, 24576
    buffer_load_dwordx4 v182, s[28:31], s45 offen lds
    v_mfma_f32_32x32x16_bf16 v[16:31], a[124:127], v[144:147], v[16:31]
    s_waitcnt vmcnt(8) lgkmcnt(0)
    s_barrier
    v_add_u32 v180, 32768, v180
    v_add_u32 v181, 32768, v181
    ds_read_b64_tr_b16 a[128:129], v180 offset:0
    v_mfma_f32_32x32x16_bf16 v[32:47], a[120:123], v[148:151], v[32:47]
    ds_read_b64_tr_b16 a[130:131], v180 offset:2048
    ds_read_b128 v[128:131], v176 offset:16384
    s_add_u32 m0, s47, 61440
    s_add_u32 s45, s45, 24576
    buffer_load_dwordx4 v182, s[28:31], s45 offen lds
    v_mfma_f32_32x32x16_bf16 v[48:63], a[124:127], v[148:151], v[48:63]
    ds_read_b64_tr_b16 a[132:133], v181 offset:0
    ds_read_b64_tr_b16 a[134:135], v181 offset:2048
    v_mfma_f32_32x32x16_bf16 v[64:79], a[120:123], v[152:155], v[64:79]
    ds_read_b128 v[132:135], v176 offset:20480
    s_cmp_lg_u32 s50, 2
    s_cbranch_scc1 L_t63
    s_mul_i32 s84, s49, 7
    buffer_load_dword v191, v190, s[36:39], s84 offen
L_t63:
    v_mfma_f32_32x32x16_bf16 v[80:95], a[124:127], v[152:155], v[80:95]
    ds_read_b128 v[136:139], v176 offset:24576
    s_add_u32 m0, s48, 45056
    s_add_u32 s61, s46, 123520
    buffer_load_dwordx4 v183, s[24:27], s61 offen lds
    v_mfma_f32_32x32x16_bf16 v[96:111], a[120:123], v[156:159], v[96:111]
    ds_read_b128 v[140:143], v176 offset:28672
    v_mfma_f32_32x32x16_bf16 v[112:127], a[124:127], v[156:159], v[112:127]
    s_waitcnt lgkmcnt(5)
    v_mfma_f32_32x32x16_bf16 v[0:15], a[128:131], v[128:131], v[0:15]
    s_waitcnt lgkmcnt(3)
    s_add_u32 m0, s47, 65536
    s_add_u32 s45, s45, 24576
    buffer_load_dwordx4 v182, s[28:31], s45 offen lds
    v_mfma_f32_32x32x16_bf16 v[16:31], a[132:135], v[128:131], v[16:31]
    s_waitcnt vmcnt(8) lgkmcnt(0)
    s_barrier
    ds_read_b64_tr_b16 a[136:137], v180 offset:8192
    v_mfma_f32_32x32x16_bf16 v[32:47], a[128:131], v[132:135], v[32:47]
    ds_read_b64_tr_b16 a[138:139], v180 offset:10240
    ds_read_b128 v[144:147], v177 offset:16384
    s_add_u32 m0, s47, 69632
    s_add_u32 s45, s45, 24576
    buffer_load_dwordx4 v182, s[28:31], s45 offen lds
    v_mfma_f32_32x32x16_bf16 v[48:63], a[132:135], v[132:135], v[48:63]
    ds_read_b64_tr_b16 a[140:141], v181 offset:8192
    ds_read_b64_tr_b16 a[142:143], v181 offset:10240
    v_mfma_f32_32x32x16_bf16 v[64:79], a[128:131], v[136:139], v[64:79]
    ds_read_b128 v[148:151], v177 offset:20480
    v_mfma_f32_32x32x16_bf16 v[80:95], a[132:135], v[136:139], v[80:95]
    ds_read_b128 v[152:155], v177 offset:24576
    s_add_u32 m0, s48, 0
    s_add_u32 s61, s46, 768
    buffer_load_dwordx4 v183, s[24:27], s61 offen lds
    v_mfma_f32_32x32x16_bf16 v[96:111], a[128:131], v[140:143], v[96:111]
    ds_read_b128 v[156:159], v177 offset:28672
    v_mfma_f32_32x32x16_bf16 v[112:127], a[132:135], v[140:143], v[112:127]
    s_waitcnt lgkmcnt(5)
    v_mfma_f32_32x32x16_bf16 v[0:15], a[136:139], v[144:147], v[0:15]
    s_waitcnt lgkmcnt(3)
    s_add_u32 m0, s47, 73728
    s_add_u32 s45, s45, 24576
    buffer_load_dwordx4 v182, s[28:31], s45 offen lds
    v_mfma_f32_32x32x16_bf16 v[16:31], a[140:143], v[144:147], v[16:31]
    s_waitcnt vmcnt(8) lgkmcnt(0)
    s_barrier
    ds_read_b64_tr_b16 a[144:145], v180 offset:16384
    v_mfma_f32_32x32x16_bf16 v[32:47], a[136:139], v[148:151], v[32:47]
    ds_read_b64_tr_b16 a[146:147], v180 offset:18432
    ds_read_b128 v[128:131], v178 offset:16384
    s_add_u32 m0, s47, 77824
    s_add_u32 s45, s45, 24576
    buffer_load_dwordx4 v182, s[28:31], s45 offen lds
    v_mfma_f32_32x32x16_bf16 v[48:63], a[140:143], v[148:151], v[48:63]
    ds_read_b64_tr_b16 a[148:149], v181 offset:16384
    ds_read_b64_tr_b16 a[150:151], v181 offset:18432
    v_mfma_f32_32x32x16_bf16 v[64:79], a[136:139], v[152:155], v[64:79]
    ds_read_b128 v[132:135], v178 offset:20480
    v_mfma_f32_32x32x16_bf16 v[80:95], a[140:143], v[152:155], v[80:95]
    ds_read_b128 v[136:139], v178 offset:24576
    s_add_u32 m0, s48, 4096
    s_add_u32 s61, s46, 41728
    buffer_load_dwordx4 v183, s[24:27], s61 offen lds
    v_mfma_f32_32x32x16_bf16 v[96:111], a[136:139], v[156:159], v[96:111]
    ds_read_b128 v[140:143], v178 offset:28672
    v_mfma_f32_32x32x16_bf16 v[112:127], a[140:143], v[156:159], v[112:127]
    s_waitcnt lgkmcnt(5)
    v_mfma_f32_32x32x16_bf16 v[0:15], a[144:147], v[128:131], v[0:15]
    s_waitcnt lgkmcnt(3)
    s_add_u32 m0, s47, 81920
    s_add_u32 s45, s45, 24576
    buffer_load_dwordx4 v182, s[28:31], s45 offen lds
    v_mfma_f32_32x32x16_bf16 v[16:31], a[148:151], v[128:131], v[16:31]
    s_waitcnt vmcnt(8) lgkmcnt(0)
    s_barrier
    ds_read_b64_tr_b16 a[152:153], v180 offset:24576
    v_mfma_f32_32x32x16_bf16 v[32:47], a[144:147], v[132:135], v[32:47]
    ds_read_b64_tr_b16 a[154:155], v180 offset:26624
    ds_read_b128 v[144:147], v179 offset:16384
    s_add_u32 m0, s47, 86016
    s_add_u32 s45, s45, 24576
    buffer_load_dwordx4 v182, s[28:31], s45 offen lds
    v_mfma_f32_32x32x16_bf16 v[48:63], a[148:151], v[132:135], v[48:63]
    ds_read_b64_tr_b16 a[156:157], v181 offset:24576
    ds_read_b64_tr_b16 a[158:159], v181 offset:26624
    v_mfma_f32_32x32x16_bf16 v[64:79], a[144:147], v[136:139], v[64:79]
    ds_read_b128 v[148:151], v179 offset:20480
    v_mfma_f32_32x32x16_bf16 v[80:95], a[148:151], v[136:139], v[80:95]
    ds_read_b128 v[152:155], v179 offset:24576
    s_add_u32 m0, s48, 8192
    s_add_u32 s61, s46, 82688
    buffer_load_dwordx4 v183, s[24:27], s61 offen lds
    v_mfma_f32_32x32x16_bf16 v[96:111], a[144:147], v[140:143], v[96:111]
    ds_read_b128 v[156:159], v179 offset:28672
    v_mfma_f32_32x32x16_bf16 v[112:127], a[148:151], v[140:143], v[112:127]
    s_waitcnt lgkmcnt(5)
    v_mfma_f32_32x32x16_bf16 v[0:15], a[152:155], v[144:147], v[0:15]
    s_waitcnt lgkmcnt(3)
    s_add_u32 m0, s47, 90112
    s_add_u32 s45, s45, 24576
    buffer_load_dwordx4 v182, s[28:31], s45 offen lds
    v_mfma_f32_32x32x16_bf16 v[16:31], a[156:159], v[144:147], v[16:31]
    s_waitcnt vmcnt(8) lgkmcnt(0)
    s_barrier
    v_add_u32 v180, 32768, v180
    v_add_u32 v181, 32768, v181
    ds_read_b64_tr_b16 a[160:161], v180 offset:0
    v_mfma_f32_32x32x16_bf16 v[32:47], a[152:155], v[148:151], v[32:47]
    ds_read_b64_tr_b16 a[162:163], v180 offset:2048
    ds_read_b128 v[128:131], v176 offset:32768
    s_add_u32 m0, s47, 94208
    s_add_u32 s45, s45, 24576
    buffer_load_dwordx4 v182, s[28:31], s45 offen lds
    v_mfma_f32_32x32x16_bf16 v[48:63], a[156:159], v[148:151], v[48:63]
    ds_read_b64_tr_b16 a[164:165], v181 offset:0
    ds_read_b64_tr_b16 a[166:167], v181 offset:2048
    v_mfma_f32_32x32x16_bf16 v[64:79], a[152:155], v[152:155], v[64:79]
    ds_read_b128 v[132:135], v176 offset:36864
    s_cmp_lg_u32 s50, 3
    s_cbranch_scc1 L_t64
    s_mul_i32 s84, s49, 8
    buffer_load_dword v191, v190, s[36:39], s84 offen
L_t64:
    v_mfma_f32_32x32x16_bf16 v[80:95], a[156:159], v[152:155], v[80:95]
    ds_read_b128 v[136:139], v176 offset:40960
    s_add_u32 m0, s48, 12288
    s_add_u32 s61, s46, 123648
    buffer_load_dwordx4 v183, s[24:27], s61 offen lds
    v_mfma_f32_32x32x16_bf16 v[96:111], a[152:155], v[156:159], v[96:111]
    ds_read_b128 v[140:143], v176 offset:45056
    v_mfma_f32_32x32x16_bf16 v[112:127], a[156:159], v[156:159], v[112:127]
    s_waitcnt lgkmcnt(5)
    v_mfma_f32_32x32x16_bf16 v[0:15], a[160:163], v[128:131], v[0:15]
    s_waitcnt lgkmcnt(3)
    s_add_u32 m0, s47, 0
    s_add_u32 s45, s45, 24576
    buffer_load_dwordx4 v182, s[28:31], s45 offen lds
    v_mfma_f32_32x32x16_bf16 v[16:31], a[164:167], v[128:131], v[16:31]
    s_waitcnt vmcnt(8) lgkmcnt(0)
    s_barrier
    ds_read_b64_tr_b16 a[168:169], v180 offset:8192
    v_mfma_f32_32x32x16_bf16 v[32:47], a[160:163], v[132:135], v[32:47]
    ds_read_b64_tr_b16 a[170:171], v180 offset:10240
    ds_read_b128 v[144:147], v177 offset:32768
    s_add_u32 m0, s47, 4096
    s_add_u32 s45, s45, 24576
    buffer_load_dwordx4 v182, s[28:31], s45 offen lds
    v_mfma_f32_32x32x16_bf16 v[48:63], a[164:167], v[132:135], v[48:63]
    ds_read_b64_tr_b16 a[172:173], v181 offset:8192
    ds_read_b64_tr_b16 a[174:175], v181 offset:10240
    v_mfma_f32_32x32x16_bf16 v[64:79], a[160:163], v[136:139], v[64:79]
    ds_read_b128 v[148:151], v177 offset:36864
    v_mfma_f32_32x32x16_bf16 v[80:95], a[164:167], v[136:139], v[80:95]
    ds_read_b128 v[152:155], v177 offset:40960
    s_add_u32 m0, s48, 16384
    s_add_u32 s61, s46, 896
    buffer_load_dwordx4 v183, s[24:27], s61 offen lds
    v_mfma_f32_32x32x16_bf16 v[96:111], a[160:163], v[140:143], v[96:111]
    ds_read_b128 v[156:159], v177 offset:45056
    v_mfma_f32_32x32x16_bf16 v[112:127], a[164:167], v[140:143], v[112:127]
    s_waitcnt lgkmcnt(5)
    v_mfma_f32_32x32x16_bf16 v[0:15], a[168:171], v[144:147], v[0:15]
    s_waitcnt lgkmcnt(3)
    s_add_u32 m0, s47, 8192
    s_add_u32 s45, s45, 24576
    buffer_load_dwordx4 v182, s[28:31], s45 offen lds
    v_mfma_f32_32x32x16_bf16 v[16:31], a[172:175], v[144:147], v[16:31]
    s_waitcnt vmcnt(8) lgkmcnt(0)
    s_barrier
    ds_read_b64_tr_b16 a[176:177], v180 offset:16384
    v_mfma_f32_32x32x16_bf16 v[32:47], a[168:171], v[148:151], v[32:47]
    ds_read_b64_tr_b16 a[178:179], v180 offset:18432
    ds_read_b128 v[128:131], v178 offset:32768
    s_add_u32 m0, s47, 12288
    s_add_u32 s45, s45, 24576
    buffer_load_dwordx4 v182, s[28:31], s45 offen lds
    v_mfma_f32_32x32x16_bf16 v[48:63], a[172:175], v[148:151], v[48:63]
    ds_read_b64_tr_b16 a[180:181], v181 offset:16384
    ds_read_b64_tr_b16 a[182:183], v181 offset:18432
    v_mfma_f32_32x32x16_bf16 v[64:79], a[168:171], v[152:155], v[64:79]
    ds_read_b128 v[132:135], v178 offset:36864
    v_mfma_f32_32x32x16_bf16 v[80:95], a[172:175], v[152:155], v[80:95]
    ds_read_b128 v[136:139], v178 offset:40960
    s_add_u32 m0, s48, 20480
    s_add_u32 s61, s46, 41856
    buffer_load_dwordx4 v183, s[24:27], s61 offen lds
    v_mfma_f32_32x32x16_bf16 v[96:111], a[168:171], v[156:159], v[96:111]
    ds_read_b128 v[140:143], v178 offset:45056
    v_mfma_f32_32x32x16_bf16 v[112:127], a[172:175], v[156:159], v[112:127]
    s_waitcnt lgkmcnt(5)
    v_mfma_f32_32x32x16_bf16 v[0:15], a[176:179], v[128:131], v[0:15]
    s_waitcnt lgkmcnt(3)
    s_add_u32 m0, s47, 16384
    s_add_u32 s45, s45, 24576
    buffer_load_dwordx4 v182, s[28:31], s45 offen lds
    v_mfma_f32_32x32x16_bf16 v[16:31], a[180:183], v[128:131], v[16:31]
    s_waitcnt vmcnt(8) lgkmcnt(0)
    s_barrier
    ds_read_b64_tr_b16 a[184:185], v180 offset:24576
    v_mfma_f32_32x32x16_bf16 v[32:47], a[176:179], v[132:135], v[32:47]
    ds_read_b64_tr_b16 a[186:187], v180 offset:26624
    ds_read_b128 v[144:147], v179 offset:32768
    s_add_u32 m0, s47, 20480
    s_add_u32 s45, s45, 24576
    buffer_load_dwordx4 v182, s[28:31], s45 offen lds
    v_mfma_f32_32x32x16_bf16 v[48:63], a[180:183], v[132:135], v[48:63]
    ds_read_b64_tr_b16 a[188:189], v181 offset:24576
    ds_read_b64_tr_b16 a[190:191], v181 offset:26624
    v_mfma_f32_32x32x16_bf16 v[64:79], a[176:179], v[136:139], v[64:79]
    ds_read_b128 v[148:151], v179 offset:36864
    v_mfma_f32_32x32x16_bf16 v[80:95], a[180:183], v[136:139], v[80:95]
    ds_read_b128 v[152:155], v179 offset:40960
    s_add_u32 m0, s48, 24576
    s_add_u32 s61, s46, 82816
    buffer_load_dwordx4 v183, s[24:27], s61 offen lds
    v_mfma_f32_32x32x16_bf16 v[96:111], a[176:179], v[140:143], v[96:111]
    ds_read_b128 v[156:159], v179 offset:45056
    v_mfma_f32_32x32x16_bf16 v[112:127], a[180:183], v[140:143], v[112:127]
    s_waitcnt lgkmcnt(5)
    v_mfma_f32_32x32x16_bf16 v[0:15], a[184:187], v[144:147], v[0:15]
    s_waitcnt lgkmcnt(3)
    s_add_u32 m0, s47, 24576
    s_add_u32 s45, s45, 24576
    buffer_load_dwordx4 v182, s[28:31], s45 offen lds
    v_mfma_f32_32x32x16_bf16 v[16:31], a[188:191], v[144:147], v[16:31]
    s_waitcnt vmcnt(8) lgkmcnt(0)
    s_barrier
    v_subrev_u32 v180, 65536, v180
    v_subrev_u32 v181, 65536, v181
    ds_read_b64_tr_b16 a[192:193], v180 offset:0
    v_mfma_f32_32x32x16_bf16 v[32:47], a[184:187], v[148:151], v[32:47]
    ds_read_b64_tr_b16 a[194:195], v180 offset:2048
    ds_read_b128 v[128:131], v176 offset:0
    s_add_u32 m0, s47, 28672
    s_add_u32 s45, s45, 24576
    buffer_load_dwordx4 v182, s[28:31], s45 offen lds
    v_mfma_f32_32x32x16_bf16 v[48:63], a[188:191], v[148:151], v[48:63]
    ds_read_b64_tr_b16 a[196:197], v181 offset:0
    ds_read_b64_tr_b16 a[198:199], v181 offset:2048
    v_mfma_f32_32x32x16_bf16 v[64:79], a[184:187], v[152:155], v[64:79]
    ds_read_b128 v[132:135], v176 offset:4096
    s_cmp_lg_u32 s50, 4
    s_cbranch_scc1 L_t65
    s_mul_i32 s84, s49, 9
    buffer_load_dword v191, v190, s[36:39], s84 offen
L_t65:
    v_mfma_f32_32x32x16_bf16 v[80:95], a[188:191], v[152:155], v[80:95]
    ds_read_b128 v[136:139], v176 offset:8192
    s_add_u32 m0, s48, 28672
    s_add_u32 s61, s46, 123776
    buffer_load_dwordx4 v183, s[24:27], s61 offen lds
    v_mfma_f32_32x32x16_bf16 v[96:111], a[184:187], v[156:159], v[96:111]
    ds_read_b128 v[140:143], v176 offset:12288
    v_mfma_f32_32x32x16_bf16 v[112:127], a[188:191], v[156:159], v[112:127]
    s_waitcnt lgkmcnt(5)
    v_mfma_f32_32x32x16_bf16 v[0:15], a[192:195], v[128:131], v[0:15]
    s_waitcnt lgkmcnt(3)
    s_add_u32 m0, s47, 32768
    s_add_u32 s45, s45, 24576
    buffer_load_dwordx4 v182, s[28:31], s45 offen lds
    v_mfma_f32_32x32x16_bf16 v[16:31], a[196:199], v[128:131], v[16:31]
    s_waitcnt vmcnt(8) lgkmcnt(0)
    s_barrier
    ds_read_b64_tr_b16 a[200:201], v180 offset:8192
    v_mfma_f32_32x32x16_bf16 v[32:47], a[192:195], v[132:135], v[32:47]
    ds_read_b64_tr_b16 a[202:203], v180 offset:10240
    ds_read_b128 v[144:147], v177 offset:0
    s_add_u32 m0, s47, 36864
    s_add_u32 s45, s45, 24576
    buffer_load_dwordx4 v182, s[28:31], s45 offen lds
    v_mfma_f32_32x32x16_bf16 v[48:63], a[196:199], v[132:135], v[48:63]
    ds_read_b64_tr_b16 a[204:205], v181 offset:8192
    ds_read_b64_tr_b16 a[206:207], v181 offset:10240
    v_mfma_f32_32x32x16_bf16 v[64:79], a[192:195], v[136:139], v[64:79]
    ds_read_b128 v[148:151], v177 offset:4096
    v_mfma_f32_32x32x16_bf16 v[80:95], a[196:199], v[136:139], v[80:95]
    ds_read_b128 v[152:155], v177 offset:8192
    s_add_u32 m0, s48, 32768
    s_add_u32 s61, s46, 1024
    buffer_load_dwordx4 v183, s[24:27], s61 offen lds
    v_mfma_f32_32x32x16_bf16 v[96:111], a[192:195], v[140:143], v[96:111]
    ds_read_b128 v[156:159], v177 offset:12288
    v_mfma_f32_32x32x16_bf16 v[112:127], a[196:199], v[140:143], v[112:127]
    s_waitcnt lgkmcnt(5)
    v_mfma_f32_32x32x16_bf16 v[0:15], a[200:203], v[144:147], v[0:15]
    s_waitcnt lgkmcnt(3)
    s_add_u32 m0, s47, 40960
    s_add_u32 s45, s45, 24576
    buffer_load_dwordx4 v182, s[28:31], s45 offen lds
    v_mfma_f32_32x32x16_bf16 v[16:31], a[204:207], v[144:147], v[16:31]
    s_waitcnt vmcnt(8) lgkmcnt(0)
    s_barrier
    ds_read_b64_tr_b16 a[208:209], v180 offset:16384
    v_mfma_f32_32x32x16_bf16 v[32:47], a[200:203], v[148:151], v[32:47]
    ds_read_b64_tr_b16 a[210:211], v180 offset:18432
    ds_read_b128 v[128:131], v178 offset:0
    s_add_u32 m0, s47, 45056
    s_add_u32 s45, s45, 24576
    buffer_load_dwordx4 v182, s[28:31], s45 offen lds
    v_mfma_f32_32x32x16_bf16 v[48:63], a[204:207], v[148:151], v[48:63]
    ds_read_b64_tr_b16 a[212:213], v181 offset:16384
    ds_read_b64_tr_b16 a[214:215], v181 offset:18432
    v_mfma_f32_32x32x16_bf16 v[64:79], a[200:203], v[152:155], v[64:79]
    ds_read_b128 v[132:135], v178 offset:4096
    v_mfma_f32_32x32x16_bf16 v[80:95], a[204:207], v[152:155], v[80:95]
    ds_read_b128 v[136:139], v178 offset:8192
    s_add_u32 m0, s48, 36864
    s_add_u32 s61, s46, 41984
    buffer_load_dwordx4 v183, s[24:27], s61 offen lds
    v_mfma_f32_32x32x16_bf16 v[96:111], a[200:203], v[156:159], v[96:111]
    ds_read_b128 v[140:143], v178 offset:12288
    v_mfma_f32_32x32x16_bf16 v[112:127], a[204:207], v[156:159], v[112:127]
    s_waitcnt lgkmcnt(5)
    v_lshlrev_b32_e64 v190, 2, v185
    v_mfma_f32_32x32x16_bf16 v[0:15], a[208:211], v[128:131], v[0:15]
    s_waitcnt lgkmcnt(3)
    s_add_u32 m0, s47, 49152
    s_add_u32 s45, s45, 24576
    buffer_load_dwordx4 v182, s[28:31], s45 offen lds
    v_cmp_ne_u32 vcc, 0, v185
    v_mfma_f32_32x32x16_bf16 v[16:31], a[212:215], v[128:131], v[16:31]
    s_waitcnt vmcnt(8) lgkmcnt(0)
    s_barrier
    ds_read_b64_tr_b16 a[216:217], v180 offset:24576
    v_add_u32 v190, 124, v190
    v_mfma_f32_32x32x16_bf16 v[32:47], a[208:211], v[132:135], v[32:47]
    ds_read_b64_tr_b16 a[218:219], v180 offset:26624
    ds_read_b128 v[144:147], v179 offset:0
    s_add_u32 m0, s47, 53248
    s_add_u32 s45, s45, 24576
    buffer_load_dwordx4 v182, s[28:31], s45 offen lds
    v_mfma_f32_32x32x16_bf16 v[48:63], a[212:215], v[132:135], v[48:63]
    ds_read_b64_tr_b16 a[220:221], v181 offset:24576
    ds_read_b64_tr_b16 a[222:223], v181 offset:26624
    s_nop 0
    v_mfma_f32_32x32x16_bf16 v[64:79], a[208:211], v[136:139], v[64:79]
    ds_read_b128 v[148:151], v179 offset:4096
    v_cndmask_b32 v190, 0, v190, vcc
    v_mfma_f32_32x32x16_bf16 v[80:95], a[212:215], v[136:139], v[80:95]
    ds_read_b128 v[152:155], v179 offset:8192
    s_add_u32 m0, s48, 40960
    s_add_u32 s61, s46, 82944
    buffer_load_dwordx4 v183, s[24:27], s61 offen lds
    v_mfma_f32_32x32x16_bf16 v[96:111], a[208:211], v[140:143], v[96:111]
    ds_read_b128 v[156:159], v179 offset:12288
    v_mfma_f32_32x32x16_bf16 v[112:127], a[212:215], v[140:143], v[112:127]
    s_waitcnt lgkmcnt(5)
    v_mfma_f32_32x32x16_bf16 v[0:15], a[216:219], v[144:147], v[0:15]
    s_waitcnt lgkmcnt(3)
    s_add_u32 m0, s47, 57344
    s_add_u32 s45, s45, 24576
    buffer_load_dwordx4 v182, s[28:31], s45 offen lds
    v_mfma_f32_32x32x16_bf16 v[16:31], a[220:223], v[144:147], v[16:31]
    s_waitcnt vmcnt(8) lgkmcnt(0)
    s_barrier
    v_add_u32 v180, 32768, v180
    v_add_u32 v181, 32768, v181
    ds_read_b64_tr_b16 a[224:225], v180 offset:0
    v_mfma_f32_32x32x16_bf16 v[32:47], a[216:219], v[148:151], v[32:47]
    ds_read_b64_tr_b16 a[226:227], v180 offset:2048
    ds_read_b128 v[128:131], v176 offset:16384
    s_add_u32 m0, s47, 61440
    s_add_u32 s45, s45, 24576
    buffer_load_dwordx4 v182, s[28:31], s45 offen lds
    v_mfma_f32_32x32x16_bf16 v[48:63], a[220:223], v[148:151], v[48:63]
    ds_read_b64_tr_b16 a[228:229], v181 offset:0
    ds_read_b64_tr_b16 a[230:231], v181 offset:2048
    v_mfma_f32_32x32x16_bf16 v[64:79], a[216:219], v[152:155], v[64:79]
    ds_read_b128 v[132:135], v176 offset:20480
    v_mfma_f32_32x32x16_bf16 v[80:95], a[220:223], v[152:155], v[80:95]
    ds_read_b128 v[136:139], v176 offset:24576
    s_add_u32 m0, s48, 45056
    s_add_u32 s61, s46, 123904
    buffer_load_dwordx4 v183, s[24:27], s61 offen lds
    v_mfma_f32_32x32x16_bf16 v[96:111], a[216:219], v[156:159], v[96:111]
    ds_read_b128 v[140:143], v176 offset:28672
    v_mfma_f32_32x32x16_bf16 v[112:127], a[220:223], v[156:159], v[112:127]
    s_waitcnt lgkmcnt(5)
    v_mfma_f32_32x32x16_bf16 v[0:15], a[224:227], v[128:131], v[0:15]
    s_waitcnt lgkmcnt(3)
    s_add_u32 m0, s47, 65536
    s_add_u32 s45, s45, 24576
    buffer_load_dwordx4 v182, s[28:31], s45 offen lds
    v_mfma_f32_32x32x16_bf16 v[16:31], a[228:231], v[128:131], v[16:31]
    s_waitcnt vmcnt(8) lgkmcnt(0)
    s_barrier
    ds_read_b64_tr_b16 a[232:233], v180 offset:8192
    v_mfma_f32_32x32x16_bf16 v[32:47], a[224:227], v[132:135], v[32:47]
    ds_read_b64_tr_b16 a[234:235], v180 offset:10240
    ds_read_b128 v[144:147], v177 offset:16384
    s_add_u32 m0, s47, 69632
    s_add_u32 s45, s45, 24576
    buffer_load_dwordx4 v182, s[28:31], s45 offen lds
    v_mfma_f32_32x32x16_bf16 v[48:63], a[228:231], v[132:135], v[48:63]
    ds_read_b64_tr_b16 a[236:237], v181 offset:8192
    ds_read_b64_tr_b16 a[238:239], v181 offset:10240
    v_mfma_f32_32x32x16_bf16 v[64:79], a[224:227], v[136:139], v[64:79]
    ds_read_b128 v[148:151], v177 offset:20480
    v_mfma_f32_32x32x16_bf16 v[80:95], a[228:231], v[136:139], v[80:95]
    ds_read_b128 v[152:155], v177 offset:24576
    s_add_u32 m0, s48, 0
    s_add_u32 s61, s46, 1152
    buffer_load_dwordx4 v183, s[24:27], s61 offen lds
    v_mfma_f32_32x32x16_bf16 v[96:111], a[224:227], v[140:143], v[96:111]
    ds_read_b128 v[156:159], v177 offset:28672
    v_mfma_f32_32x32x16_bf16 v[112:127], a[228:231], v[140:143], v[112:127]
    s_waitcnt lgkmcnt(5)
    v_mfma_f32_32x32x16_bf16 v[0:15], a[232:235], v[144:147], v[0:15]
    s_waitcnt lgkmcnt(3)
    s_add_u32 m0, s47, 73728
    s_add_u32 s45, s45, 24576
    buffer_load_dwordx4 v182, s[28:31], s45 offen lds
    v_mfma_f32_32x32x16_bf16 v[16:31], a[236:239], v[144:147], v[16:31]
    s_waitcnt vmcnt(8) lgkmcnt(0)
    s_barrier
    ds_read_b64_tr_b16 a[240:241], v180 offset:16384
    v_mfma_f32_32x32x16_bf16 v[32:47], a[232:235], v[148:151], v[32:47]
    ds_read_b64_tr_b16 a[242:243], v180 offset:18432
    ds_read_b128 v[128:131], v178 offset:16384
    s_add_u32 m0, s47, 77824
    s_add_u32 s45, s45, 24576
    buffer_load_dwordx4 v182, s[28:31], s45 offen lds
    v_mfma_f32_32x32x16_bf16 v[48:63], a[236:239], v[148:151], v[48:63]
    ds_read_b64_tr_b16 a[244:245], v181 offset:16384
    ds_read_b64_tr_b16 a[246:247], v181 offset:18432
    v_mfma_f32_32x32x16_bf16 v[64:79], a[232:235], v[152:155], v[64:79]
    ds_read_b128 v[132:135], v178 offset:20480
    v_mfma_f32_32x32x16_bf16 v[80:95], a[236:239], v[152:155], v[80:95]
    ds_read_b128 v[136:139], v178 offset:24576
    s_add_u32 m0, s48, 4096
    s_add_u32 s61, s46, 42112
    buffer_load_dwordx4 v183, s[24:27], s61 offen lds
    v_mfma_f32_32x32x16_bf16 v[96:111], a[232:235], v[156:159], v[96:111]
    ds_read_b128 v[140:143], v178 offset:28672
    v_mfma_f32_32x32x16_bf16 v[112:127], a[236:239], v[156:159], v[112:127]
    s_waitcnt lgkmcnt(5)
    v_mfma_f32_32x32x16_bf16 v[0:15], a[240:243], v[128:131], v[0:15]
    s_waitcnt lgkmcnt(3)
    s_add_u32 m0, s47, 81920
    s_add_u32 s45, s45, 24576
    buffer_load_dwordx4 v182, s[28:31], s45 offen lds
    v_mfma_f32_32x32x16_bf16 v[16:31], a[244:247], v[128:131], v[16:31]
    s_waitcnt vmcnt(8) lgkmcnt(0)
    s_barrier
    ds_read_b64_tr_b16 a[248:249], v180 offset:24576
    v_mfma_f32_32x32x16_bf16 v[32:47], a[240:243], v[132:135], v[32:47]
    ds_read_b64_tr_b16 a[250:251], v180 offset:26624
    ds_read_b128 v[144:147], v179 offset:16384
    s_add_u32 m0, s47, 86016
    s_add_u32 s45, s45, 24576
    buffer_load_dwordx4 v182, s[28:31], s45 offen lds
    v_mfma_f32_32x32x16_bf16 v[48:63], a[244:247], v[132:135], v[48:63]
    ds_read_b64_tr_b16 a[252:253], v181 offset:24576
    ds_read_b64_tr_b16 a[254:255], v181 offset:26624
    buffer_load_dword v191, v190, s[72:75], 0 offen sc1
    v_mfma_f32_32x32x16_bf16 v[64:79], a[240:243], v[136:139], v[64:79]
    ds_read_b128 v[148:151], v179 offset:20480
    v_mfma_f32_32x32x16_bf16 v[80:95], a[244:247], v[136:139], v[80:95]
    ds_read_b128 v[152:155], v179 offset:24576
    s_add_u32 m0, s48, 8192
    s_add_u32 s61, s46, 83072
    buffer_load_dwordx4 v183, s[24:27], s61 offen lds
    v_mfma_f32_32x32x16_bf16 v[96:111], a[240:243], v[140:143], v[96:111]
    ds_read_b128 v[156:159], v179 offset:28672
    v_mfma_f32_32x32x16_bf16 v[112:127], a[244:247], v[140:143], v[112:127]
    s_waitcnt lgkmcnt(5)
    v_mfma_f32_32x32x16_bf16 v[0:15], a[248:251], v[144:147], v[0:15]
    s_waitcnt lgkmcnt(3)
    s_add_u32 m0, s47, 90112
    s_add_u32 s45, s45, 24576
    buffer_load_dwordx4 v182, s[28:31], s45 offen lds
    v_mfma_f32_32x32x16_bf16 v[16:31], a[252:255], v[144:147], v[16:31]
    s_waitcnt vmcnt(9) lgkmcnt(0)
    s_barrier
    v_add_u32 v180, 32768, v180
    v_add_u32 v181, 32768, v181
    ds_read_b64_tr_b16 v[192:193], v180 offset:0
    v_mfma_f32_32x32x16_bf16 v[32:47], a[248:251], v[148:151], v[32:47]
    ds_read_b64_tr_b16 v[194:195], v180 offset:2048
    ds_read_b128 v[128:131], v176 offset:32768
    s_add_u32 m0, s47, 94208
    s_add_u32 s45, s45, 24576
    buffer_load_dwordx4 v182, s[28:31], s45 offen lds
    v_mfma_f32_32x32x16_bf16 v[48:63], a[252:255], v[148:151], v[48:63]
    ds_read_b64_tr_b16 v[196:197], v181 offset:0
    ds_read_b64_tr_b16 v[198:199], v181 offset:2048
    v_mfma_f32_32x32x16_bf16 v[64:79], a[248:251], v[152:155], v[64:79]
    ds_read_b128 v[132:135], v176 offset:36864
    v_mfma_f32_32x32x16_bf16 v[80:95], a[252:255], v[152:155], v[80:95]
    ds_read_b128 v[136:139], v176 offset:40960
    s_add_u32 m0, s48, 12288
    s_add_u32 s61, s46, 124032
    buffer_load_dwordx4 v183, s[24:27], s61 offen lds
    v_mfma_f32_32x32x16_bf16 v[96:111], a[248:251], v[156:159], v[96:111]
    ds_read_b128 v[140:143], v176 offset:45056
    v_mfma_f32_32x32x16_bf16 v[112:127], a[252:255], v[156:159], v[112:127]
    s_waitcnt lgkmcnt(5)
    v_mfma_f32_32x32x16_bf16 v[0:15], v[192:195], v[128:131], v[0:15]
    s_waitcnt lgkmcnt(3)
    s_add_u32 m0, s47, 0
    s_add_u32 s45, s45, 24576
    buffer_load_dwordx4 v182, s[28:31], s45 offen lds
    v_mfma_f32_32x32x16_bf16 v[16:31], v[196:199], v[128:131], v[16:31]
    s_waitcnt vmcnt(9) lgkmcnt(0)
    s_barrier
    ds_read_b64_tr_b16 v[200:201], v180 offset:8192
    v_mfma_f32_32x32x16_bf16 v[32:47], v[192:195], v[132:135], v[32:47]
    ds_read_b64_tr_b16 v[202:203], v180 offset:10240
    ds_read_b128 v[144:147], v177 offset:32768
    s_add_u32 m0, s47, 4096
    s_add_u32 s45, s45, 24576
    buffer_load_dwordx4 v182, s[28:31], s45 offen lds
    v_mfma_f32_32x32x16_bf16 v[48:63], v[196:199], v[132:135], v[48:63]
    ds_read_b64_tr_b16 v[204:205], v181 offset:8192
    ds_read_b64_tr_b16 v[206:207], v181 offset:10240
    v_mfma_f32_32x32x16_bf16 v[64:79], v[192:195], v[136:139], v[64:79]
    ds_read_b128 v[148:151], v177 offset:36864
    v_mfma_f32_32x32x16_bf16 v[80:95], v[196:199], v[136:139], v[80:95]
    ds_read_b128 v[152:155], v177 offset:40960
    s_add_u32 m0, s48, 16384
    s_add_u32 s61, s46, 163840
    buffer_load_dwordx4 v183, s[24:27], s61 offen lds
    v_mfma_f32_32x32x16_bf16 v[96:111], v[192:195], v[140:143], v[96:111]
    ds_read_b128 v[156:159], v177 offset:45056
    v_mfma_f32_32x32x16_bf16 v[112:127], v[196:199], v[140:143], v[112:127]
    s_waitcnt lgkmcnt(5)
    v_mfma_f32_32x32x16_bf16 v[0:15], v[200:203], v[144:147], v[0:15]
    s_waitcnt lgkmcnt(3)
    s_add_u32 m0, s47, 8192
    s_add_u32 s45, s45, 24576
    buffer_load_dwordx4 v182, s[28:31], s45 offen lds
    v_mfma_f32_32x32x16_bf16 v[16:31], v[204:207], v[144:147], v[16:31]
    s_waitcnt vmcnt(9) lgkmcnt(0)
    s_barrier
    ds_read_b64_tr_b16 v[208:209], v180 offset:16384
    v_mfma_f32_32x32x16_bf16 v[32:47], v[200:203], v[148:151], v[32:47]
    ds_read_b64_tr_b16 v[210:211], v180 offset:18432
    ds_read_b128 v[128:131], v178 offset:32768
    s_add_u32 m0, s47, 12288
    s_add_u32 s45, s45, 24576
    buffer_load_dwordx4 v182, s[28:31], s45 offen lds
    v_mfma_f32_32x32x16_bf16 v[48:63], v[204:207], v[148:151], v[48:63]
    ds_read_b64_tr_b16 v[212:213], v181 offset:16384
    ds_read_b64_tr_b16 v[214:215], v181 offset:18432
    v_mfma_f32_32x32x16_bf16 v[64:79], v[200:203], v[152:155], v[64:79]
    ds_read_b128 v[132:135], v178 offset:36864
    v_mfma_f32_32x32x16_bf16 v[80:95], v[204:207], v[152:155], v[80:95]
    ds_read_b128 v[136:139], v178 offset:40960
    s_add_u32 m0, s48, 20480
    s_add_u32 s61, s46, 163968
    buffer_load_dwordx4 v183, s[24:27], s61 offen lds
    v_mfma_f32_32x32x16_bf16 v[96:111], v[200:203], v[156:159], v[96:111]
    ds_read_b128 v[140:143], v178 offset:45056
    v_mfma_f32_32x32x16_bf16 v[112:127], v[204:207], v[156:159], v[112:127]
    s_waitcnt lgkmcnt(5)
    v_mfma_f32_32x32x16_bf16 v[0:15], v[208:211], v[128:131], v[0:15]
    s_waitcnt lgkmcnt(3)
    s_add_u32 m0, s47, 16384
    s_add_u32 s45, s45, 24576
    buffer_load_dwordx4 v182, s[28:31], s45 offen lds
    v_mfma_f32_32x32x16_bf16 v[16:31], v[212:215], v[128:131], v[16:31]
    s_waitcnt vmcnt(8) lgkmcnt(0)
    s_barrier
    ds_read_b64_tr_b16 v[216:217], v180 offset:24576
    v_cmp_le_u32 vcc, 20, v191
    s_nop 0
    s_andn2_b32 s84, 0x2, vcc_lo
    s_cbranch_scc1 L_retry66
L_ok66:
    v_mfma_f32_32x32x16_bf16 v[32:47], v[208:211], v[132:135], v[32:47]
    ds_read_b64_tr_b16 v[218:219], v180 offset:26624
    ds_read_b128 v[144:147], v179 offset:32768
    s_add_u32 m0, s47, 147456
    s_add_u32 s61, s10, 33792
    buffer_load_dwordx4 v188, s[40:43], s61 offen sc1 lds
    s_add_u32 m0, s47, 20480
    s_add_u32 s45, s45, 24576
    buffer_load_dwordx4 v182, s[28:31], s45 offen lds
    v_mfma_f32_32x32x16_bf16 v[48:63], v[212:215], v[132:135], v[48:63]
    ds_read_b64_tr_b16 v[220:221], v181 offset:24576
    ds_read_b64_tr_b16 v[222:223], v181 offset:26624
    v_mfma_f32_32x32x16_bf16 v[64:79], v[208:211], v[136:139], v[64:79]
    ds_read_b128 v[148:151], v179 offset:36864
    s_add_u32 m0, s47, 151552
    s_add_u32 s61, s10, 34816
    buffer_load_dwordx4 v188, s[40:43], s61 offen sc1 lds
    v_mfma_f32_32x32x16_bf16 v[80:95], v[212:215], v[136:139], v[80:95]
    ds_read_b128 v[152:155], v179 offset:40960
    s_add_u32 m0, s48, 24576
    s_add_u32 s61, s46, 164096
    buffer_load_dwordx4 v183, s[24:27], s61 offen lds
    v_mfma_f32_32x32x16_bf16 v[96:111], v[208:211], v[140:143], v[96:111]
    ds_read_b128 v[156:159], v179 offset:45056
    v_mfma_f32_32x32x16_bf16 v[112:127], v[212:215], v[140:143], v[112:127]
    s_add_u32 m0, s47, 155648
    s_add_u32 s61, s10, 35840
    buffer_load_dwordx4 v188, s[40:43], s61 offen sc1 lds
    s_waitcnt lgkmcnt(5)
    v_mfma_f32_32x32x16_bf16 v[0:15], v[216:219], v[144:147], v[0:15]
    s_waitcnt lgkmcnt(3)
    s_add_u32 m0, s47, 24576
    s_add_u32 s45, s45, 24576
    buffer_load_dwordx4 v182, s[28:31], s45 offen lds
    v_mfma_f32_32x32x16_bf16 v[16:31], v[220:223], v[144:147], v[16:31]
    s_waitcnt vmcnt(11) lgkmcnt(0)
    s_barrier
    v_subrev_u32 v180, 65536, v180
    v_subrev_u32 v181, 65536, v181
    ds_read_b64_tr_b16 v[224:225], v180 offset:0
    v_mfma_f32_32x32x16_bf16 v[32:47], v[216:219], v[148:151], v[32:47]
    ds_read_b64_tr_b16 v[226:227], v180 offset:2048
    ds_read_b128 v[128:131], v176 offset:0
    s_add_u32 m0, s47, 32768
    s_add_u32 s61, s10, 36864
    buffer_load_dwordx4 v188, s[40:43], s61 offen sc1 lds
    s_add_u32 m0, s47, 28672
    s_add_u32 s45, s45, 24576
    buffer_load_dwordx4 v182, s[28:31], s45 offen lds
    v_mfma_f32_32x32x16_bf16 v[48:63], v[220:223], v[148:151], v[48:63]
    ds_read_b64_tr_b16 v[228:229], v181 offset:0
    ds_read_b64_tr_b16 v[230:231], v181 offset:2048
    v_mfma_f32_32x32x16_bf16 v[64:79], v[216:219], v[152:155], v[64:79]
    ds_read_b128 v[132:135], v176 offset:4096
    s_add_u32 m0, s47, 36864
    s_add_u32 s61, s10, 37888
    buffer_load_dwordx4 v188, s[40:43], s61 offen sc1 lds
    v_mfma_f32_32x32x16_bf16 v[80:95], v[220:223], v[152:155], v[80:95]
    ds_read_b128 v[136:139], v176 offset:8192
    s_add_u32 m0, s48, 28672
    s_add_u32 s61, s46, 164224
    buffer_load_dwordx4 v183, s[24:27], s61 offen lds
    v_mfma_f32_32x32x16_bf16 v[96:111], v[216:219], v[156:159], v[96:111]
    ds_read_b128 v[140:143], v176 offset:12288
    v_mfma_f32_32x32x16_bf16 v[112:127], v[220:223], v[156:159], v[112:127]
    s_add_u32 m0, s47, 40960
    s_add_u32 s61, s10, 38912
    buffer_load_dwordx4 v188, s[40:43], s61 offen sc1 lds
    s_waitcnt lgkmcnt(5)
    v_mfma_f32_32x32x16_bf16 v[0:15], v[224:227], v[128:131], v[0:15]
    s_waitcnt lgkmcnt(3)
    s_add_u32 m0, s48, 32768
    s_add_u32 s61, s46, 164352
    buffer_load_dwordx4 v183, s[24:27], s61 offen lds
    v_mfma_f32_32x32x16_bf16 v[16:31], v[228:231], v[128:131], v[16:31]
    s_waitcnt vmcnt(14) lgkmcnt(0)
    s_barrier
    ds_read_b64_tr_b16 v[232:233], v180 offset:8192
    v_mfma_f32_32x32x16_bf16 v[32:47], v[224:227], v[132:135], v[32:47]
    ds_read_b64_tr_b16 v[234:235], v180 offset:10240
    ds_read_b128 v[144:147], v177 offset:0
    s_add_u32 m0, s47, 45056
    s_add_u32 s61, s10, 39936
    buffer_load_dwordx4 v188, s[40:43], s61 offen sc1 lds
    v_mfma_f32_32x32x16_bf16 v[48:63], v[228:231], v[132:135], v[48:63]
    ds_read_b64_tr_b16 v[236:237], v181 offset:8192
    ds_read_b64_tr_b16 v[238:239], v181 offset:10240
    v_mfma_f32_32x32x16_bf16 v[64:79], v[224:227], v[136:139], v[64:79]
    ds_read_b128 v[148:151], v177 offset:4096
    s_add_u32 m0, s47, 49152
    s_add_u32 s61, s10, 40960
    buffer_load_dwordx4 v188, s[40:43], s61 offen sc1 lds
    v_mfma_f32_32x32x16_bf16 v[80:95], v[228:231], v[136:139], v[80:95]
    ds_read_b128 v[152:155], v177 offset:8192
    v_mfma_f32_32x32x16_bf16 v[96:111], v[224:227], v[140:143], v[96:111]
    ds_read_b128 v[156:159], v177 offset:12288
    s_add_u32 m0, s48, 36864
    s_add_u32 s61, s46, 164480
    buffer_load_dwordx4 v183, s[24:27], s61 offen lds
    v_mfma_f32_32x32x16_bf16 v[112:127], v[228:231], v[140:143], v[112:127]
    s_add_u32 m0, s47, 53248
    s_add_u32 s61, s10, 41984
    buffer_load_dwordx4 v188, s[40:43], s61 offen sc1 lds
    s_waitcnt lgkmcnt(5)
    v_mfma_f32_32x32x16_bf16 v[0:15], v[232:235], v[144:147], v[0:15]
    s_waitcnt lgkmcnt(3)
    v_mfma_f32_32x32x16_bf16 v[16:31], v[236:239], v[144:147], v[16:31]
    s_waitcnt vmcnt(14) lgkmcnt(0)
    s_barrier
    ds_read_b64_tr_b16 v[240:241], v180 offset:16384
    v_mfma_f32_32x32x16_bf16 v[32:47], v[232:235], v[148:151], v[32:47]
    ds_read_b64_tr_b16 v[242:243], v180 offset:18432
    ds_read_b128 v[128:131], v178 offset:0
    s_add_u32 m0, s47, 57344
    s_add_u32 s61, s10, 43008
    buffer_load_dwordx4 v188, s[40:43], s61 offen sc1 lds
    v_mfma_f32_32x32x16_bf16 v[48:63], v[236:239], v[148:151], v[48:63]
    ds_read_b64_tr_b16 v[244:245], v181 offset:16384
    ds_read_b64_tr_b16 v[246:247], v181 offset:18432
    v_mfma_f32_32x32x16_bf16 v[64:79], v[232:235], v[152:155], v[64:79]
    ds_read_b128 v[132:135], v178 offset:4096
    s_add_u32 m0, s47, 61440
    s_add_u32 s61, s10, 44032
    buffer_load_dwordx4 v188, s[40:43], s61 offen sc1 lds
    s_add_u32 m0, s48, 40960
    s_add_u32 s61, s46, 164608
    buffer_load_dwordx4 v183, s[24:27], s61 offen lds
    v_mfma_f32_32x32x16_bf16 v[80:95], v[236:239], v[152:155], v[80:95]
    ds_read_b128 v[136:139], v178 offset:8192
    v_mfma_f32_32x32x16_bf16 v[96:111], v[232:235], v[156:159], v[96:111]
    ds_read_b128 v[140:143], v178 offset:12288
    v_mfma_f32_32x32x16_bf16 v[112:127], v[236:239], v[156:159], v[112:127]
    s_add_u32 m0, s47, 65536
    s_add_u32 s61, s10, 45056
    buffer_load_dwordx4 v188, s[40:43], s61 offen sc1 lds
    s_waitcnt lgkmcnt(5)
    v_mfma_f32_32x32x16_bf16 v[0:15], v[240:243], v[128:131], v[0:15]
    s_waitcnt lgkmcnt(3)
    v_mfma_f32_32x32x16_bf16 v[16:31], v[244:247], v[128:131], v[16:31]
    s_waitcnt vmcnt(12) lgkmcnt(0)
    s_barrier
    ds_read_b64_tr_b16 v[248:249], v180 offset:24576
    v_mfma_f32_32x32x16_bf16 v[32:47], v[240:243], v[132:135], v[32:47]
    ds_read_b64_tr_b16 v[250:251], v180 offset:26624
    ds_read_b128 v[144:147], v179 offset:0
    s_add_u32 m0, s47, 69632
    s_add_u32 s61, s10, 46080
    buffer_load_dwordx4 v188, s[40:43], s61 offen sc1 lds
    s_add_u32 m0, s48, 45056
    s_add_u32 s61, s46, 164736
    buffer_load_dwordx4 v183, s[24:27], s61 offen lds
    v_mfma_f32_32x32x16_bf16 v[48:63], v[244:247], v[132:135], v[48:63]
    ds_read_b64_tr_b16 v[252:253], v181 offset:24576
    ds_read_b64_tr_b16 v[254:255], v181 offset:26624
    v_mfma_f32_32x32x16_bf16 v[64:79], v[240:243], v[136:139], v[64:79]
    ds_read_b128 v[148:151], v179 offset:4096
    s_add_u32 m0, s47, 73728
    s_add_u32 s61, s10, 47104
    buffer_load_dwordx4 v188, s[40:43], s61 offen sc1 lds
    v_mfma_f32_32x32x16_bf16 v[80:95], v[244:247], v[136:139], v[80:95]
    ds_read_b128 v[152:155], v179 offset:8192
    v_mfma_f32_32x32x16_bf16 v[96:111], v[240:243], v[140:143], v[96:111]
    ds_read_b128 v[156:159], v179 offset:12288
    v_mfma_f32_32x32x16_bf16 v[112:127], v[244:247], v[140:143], v[112:127]
    s_add_u32 m0, s47, 77824
    s_add_u32 s61, s10, 48128
    buffer_load_dwordx4 v188, s[40:43], s61 offen sc1 lds
    s_waitcnt lgkmcnt(5)
    v_mfma_f32_32x32x16_bf16 v[0:15], v[248:251], v[144:147], v[0:15]
    s_waitcnt lgkmcnt(3)
    v_mfma_f32_32x32x16_bf16 v[16:31], v[252:255], v[144:147], v[16:31]
    s_waitcnt vmcnt(14) lgkmcnt(0)
    s_barrier
    ds_read_b128 v[160:163], v176 offset:16384
    v_mfma_f32_32x32x16_bf16 v[32:47], v[248:251], v[148:151], v[32:47]
    ds_read_b128 v[164:167], v177 offset:16384
    ds_read_b128 v[168:171], v178 offset:16384
    s_add_u32 m0, s47, 81920
    s_add_u32 s61, s10, 49152
    buffer_load_dwordx4 v188, s[40:43], s61 offen sc1 lds
    s_add_u32 m0, s48, 0
    s_add_u32 s61, s46, 164864
    buffer_load_dwordx4 v183, s[24:27], s61 offen lds
    v_mfma_f32_32x32x16_bf16 v[48:63], v[252:255], v[148:151], v[48:63]
    v_mfma_f32_32x32x16_bf16 v[64:79], v[248:251], v[152:155], v[64:79]
    s_add_u32 m0, s47, 86016
    s_add_u32 s61, s10, 50176
    buffer_load_dwordx4 v188, s[40:43], s61 offen sc1 lds
    v_mfma_f32_32x32x16_bf16 v[80:95], v[252:255], v[152:155], v[80:95]
    v_mfma_f32_32x32x16_bf16 v[96:111], v[248:251], v[156:159], v[96:111]
    v_mov_b32 v180, 163584
    v_mfma_f32_32x32x16_bf16 v[112:127], v[252:255], v[156:159], v[112:127]
    s_add_u32 m0, s47, 90112
    s_add_u32 s61, s10, 51200
    buffer_load_dwordx4 v188, s[40:43], s61 offen sc1 lds
    s_waitcnt lgkmcnt(2)
    v_mfma_f32_32x32x16_bf16 v[128:143], a[0:3], v[160:163], 0
    ds_read_b128 v[172:175], v179 offset:16384
    s_add_u32 m0, s48, 4096
    s_add_u32 s61, s46, 164992
    buffer_load_dwordx4 v183, s[24:27], s61 offen lds
    v_mfma_f32_32x32x16_bf16 v[144:159], a[4:7], v[160:163], 0
    s_waitcnt lgkmcnt(2)
    v_mfma_f32_32x32x16_bf16 v[128:143], a[8:11], v[164:167], v[128:143]
    ds_read_b128 v[160:163], v176 offset:20480
    s_add_u32 m0, s47, 94208
    s_add_u32 s61, s10, 52224
    buffer_load_dwordx4 v188, s[40:43], s61 offen sc1 lds
    v_mul_f32 v8, v0, v8
    v_mfma_f32_32x32x16_bf16 v[144:159], a[12:15], v[164:167], v[144:159]
    s_waitcnt lgkmcnt(2)
    v_mul_f32 v9, v1, v9
    v_mul_f32 v10, v2, v10
    v_mul_f32 v11, v3, v11
    v_mul_f32 v12, v4, v12
    v_mul_f32 v13, v5, v13
    v_mul_f32_e64 v14, v6, v14
    v_mfma_f32_32x32x16_bf16 v[128:143], a[16:19], v[168:171], v[128:143]
    ds_read_b128 v[164:167], v177 offset:20480
    v_mul_f32 v15, v7, v15
    v_mul_f32 v0, s17, v0
    v_mul_f32 v1, s17, v1
    v_mul_f32 v2, s17, v2
    v_mul_f32_e64 v3, s17, v3
    v_mfma_f32_32x32x16_bf16 v[144:159], a[20:23], v[168:171], v[144:159]
    s_add_u32 m0, s47, 0
    s_add_u32 s61, s10, 53248
    buffer_load_dwordx4 v188, s[40:43], s61 offen sc1 lds
    v_mul_f32 v4, s17, v4
    v_mul_f32 v5, s17, v5
    s_waitcnt lgkmcnt(2)
    v_mfma_f32_32x32x16_bf16 v[128:143], a[24:27], v[172:175], v[128:143]
    ds_read_b128 v[168:171], v178 offset:20480
    s_add_u32 m0, s48, 8192
    s_add_u32 s61, s46, 204800
    buffer_load_dwordx4 v183, s[24:27], s61 offen lds
    v_mfma_f32_32x32x16_bf16 v[144:159], a[28:31], v[172:175], v[144:159]
    s_waitcnt lgkmcnt(2)
    v_mul_f32 v6, s17, v6
    v_mul_f32 v7, s17, v7
    v_exp_f32 v0, v0
    v_exp_f32_e64 v1, v1
    v_mfma_f32_32x32x16_bf16 v[128:143], a[32:35], v[160:163], v[128:143]
    ds_read_b128 v[172:175], v179 offset:20480
    s_add_u32 m0, s47, 4096
    s_add_u32 s61, s10, 54272
    buffer_load_dwordx4 v188, s[40:43], s61 offen sc1 lds
    v_mfma_f32_32x32x16_bf16 v[144:159], a[36:39], v[160:163], v[144:159]
    s_waitcnt lgkmcnt(2)
    v_exp_f32 v2, v2
    v_exp_f32 v3, v3
    v_exp_f32 v4, v4
    v_mfma_f32_32x32x16_bf16 v[128:143], a[40:43], v[164:167], v[128:143]
    ds_read_b128 v[160:163], v176 offset:24576
    v_exp_f32 v5, v5
    v_exp_f32 v6, v6
    v_mfma_f32_32x32x16_bf16 v[144:159], a[44:47], v[164:167], v[144:159]
    s_add_u32 m0, s47, 8192
    s_add_u32 s61, s10, 55296
    buffer_load_dwordx4 v188, s[40:43], s61 offen sc1 lds
    v_exp_f32 v7, v7
    s_waitcnt lgkmcnt(2)
    v_mfma_f32_32x32x16_bf16 v[128:143], a[48:51], v[168:171], v[128:143]
    ds_read_b128 v[164:167], v177 offset:24576
    s_add_u32 m0, s48, 12288
    s_add_u32 s61, s46, 204928
    buffer_load_dwordx4 v183, s[24:27], s61 offen lds
    v_mfma_f32_32x32x16_bf16 v[144:159], a[52:55], v[168:171], v[144:159]
    s_waitcnt lgkmcnt(2)
    v_add_f32 v0, 1.0, v0
    v_add_f32 v1, 1.0, v1
    v_add_f32 v2, 1.0, v2
    v_add_f32 v3, 1.0, v3
    v_add_f32 v4, 1.0, v4
    v_add_f32_e64 v5, 1.0, v5
    v_mfma_f32_32x32x16_bf16 v[128:143], a[56:59], v[172:175], v[128:143]
    ds_read_b128 v[168:171], v178 offset:24576
    s_add_u32 m0, s47, 12288
    s_add_u32 s61, s10, 56320
    buffer_load_dwordx4 v188, s[40:43], s61 offen sc1 lds
    v_add_f32_e64 v6, 1.0, v6
    v_mfma_f32_32x32x16_bf16 v[144:159], a[60:63], v[172:175], v[144:159]
    s_waitcnt lgkmcnt(2)
    v_add_f32 v7, 1.0, v7
    v_rcp_f32 v0, v0
    v_rcp_f32 v1, v1
    v_mfma_f32_32x32x16_bf16 v[128:143], a[64:67], v[160:163], v[128:143]
    ds_read_b128 v[172:175], v179 offset:24576
    v_rcp_f32 v2, v2
    v_rcp_f32 v3, v3
    v_mfma_f32_32x32x16_bf16 v[144:159], a[68:71], v[160:163], v[144:159]
    s_add_u32 m0, s47, 16384
    s_add_u32 s61, s10, 57344
    buffer_load_dwordx4 v188, s[40:43], s61 offen sc1 lds
    v_rcp_f32 v4, v4
    s_waitcnt lgkmcnt(2)
    v_mfma_f32_32x32x16_bf16 v[128:143], a[72:75], v[164:167], v[128:143]
    ds_read_b128 v[160:163], v176 offset:28672
    v_rcp_f32 v5, v5
    v_rcp_f32 v6, v6
    v_mfma_f32_32x32x16_bf16 v[144:159], a[76:79], v[164:167], v[144:159]
    s_waitcnt lgkmcnt(2)
    v_rcp_f32 v7, v7
    v_mul_f32 v8, v0, v8
    v_mul_f32 v9, v1, v9
    v_mul_f32 v10, v2, v10
    v_mul_f32 v11, v3, v11
    v_mfma_f32_32x32x16_bf16 v[128:143], a[80:83], v[168:171], v[128:143]
    ds_read_b128 v[164:167], v177 offset:28672
    s_add_u32 m0, s47, 20480
    s_add_u32 s61, s10, 58368
    buffer_load_dwordx4 v188, s[40:43], s61 offen sc1 lds
    v_mul_f32_e64 v12, v4, v12
    v_mfma_f32_32x32x16_bf16 v[144:159], a[84:87], v[168:171], v[144:159]
    s_waitcnt lgkmcnt(2)
    v_mul_f32 v13, v5, v13
    v_mul_f32 v14, v6, v14
    v_mul_f32 v15, v7, v15
    v_cvt_pk_bf16_f32 v0, v8, v9
    v_cvt_pk_bf16_f32 v1, v10, v11
    v_cvt_pk_bf16_f32 v2, v12, v13
    v_mfma_f32_32x32x16_bf16 v[128:143], a[88:91], v[172:175], v[128:143]
    ds_read_b128 v[168:171], v178 offset:28672
    v_cvt_pk_bf16_f32 v3, v14, v15
    s_add_u32 s61, s16, 0
    buffer_store_dwordx4 v[0:3], v184, s[32:35], s61 offen offset:0 sc1
    v_mfma_f32_32x32x16_bf16 v[144:159], a[92:95], v[172:175], v[144:159]
    s_add_u32 m0, s47, 24576
    s_add_u32 s61, s10, 59392
    buffer_load_dwordx4 v188, s[40:43], s61 offen sc1 lds
    v_mul_f32 v24, v16, v24
    v_mul_f32 v25, v17, v25
    s_waitcnt lgkmcnt(2)
    v_mfma_f32_32x32x16_bf16 v[128:143], a[96:99], v[160:163], v[128:143]
    ds_read_b128 v[172:175], v179 offset:28672
    v_mul_f32 v26, v18, v26
    v_mul_f32 v27, v19, v27
    v_mul_f32 v28, v20, v28
    v_mul_f32 v29, v21, v29
    v_mul_f32_e64 v30, v22, v30
    v_mfma_f32_32x32x16_bf16 v[144:159], a[100:103], v[160:163], v[144:159]
    s_waitcnt lgkmcnt(2)
    v_mul_f32 v31, v23, v31
    v_mul_f32 v16, s17, v16
    v_mul_f32 v17, s17, v17
    v_mul_f32 v18, s17, v18
    v_mul_f32 v19, s17, v19
    v_mul_f32_e64 v20, s17, v20
    v_mfma_f32_32x32x16_bf16 v[128:143], a[104:107], v[164:167], v[128:143]
    s_waitcnt vmcnt(18) lgkmcnt(0)
    s_barrier
    ds_read_b128 v[160:163], v176 offset:32768
    s_add_u32 m0, s47, 28672
    s_add_u32 s61, s10, 60416
    buffer_load_dwordx4 v188, s[40:43], s61 offen sc1 lds
    v_mfma_f32_32x32x16_bf16 v[144:159], a[108:111], v[164:167], v[144:159]
    s_add_u32 m0, s48, 16384
    s_add_u32 s61, s46, 205056
    buffer_load_dwordx4 v183, s[24:27], s61 offen lds
    v_mul_f32_e64 v21, s17, v21
    v_mfma_f32_32x32x16_bf16 v[128:143], a[112:115], v[168:171], v[128:143]
    ds_read_b128 v[164:167], v177 offset:32768
    v_mul_f32 v22, s17, v22
    v_mul_f32 v23, s17, v23
    v_exp_f32_e64 v16, v16
    v_mfma_f32_32x32x16_bf16 v[144:159], a[116:119], v[168:171], v[144:159]
    v_exp_f32_e64 v17, v17
    v_mfma_f32_32x32x16_bf16 v[128:143], a[120:123], v[172:175], v[128:143]
    ds_read_b128 v[168:171], v178 offset:32768
    v_exp_f32 v18, v18
    v_exp_f32 v19, v19
    v_mfma_f32_32x32x16_bf16 v[144:159], a[124:127], v[172:175], v[144:159]
    s_waitcnt lgkmcnt(2)
    v_exp_f32 v20, v20
    v_exp_f32 v21, v21
    v_exp_f32 v22, v22
    v_mfma_f32_32x32x16_bf16 v[128:143], a[128:131], v[160:163], v[128:143]
    ds_read_b128 v[172:175], v179 offset:32768
    v_mfma_f32_32x32x16_bf16 v[144:159], a[132:135], v[160:163], v[144:159]
    s_waitcnt lgkmcnt(2)
    s_add_u32 m0, s48, 20480
    s_add_u32 s61, s46, 205184
    buffer_load_dwordx4 v183, s[24:27], s61 offen lds
    v_mfma_f32_32x32x16_bf16 v[128:143], a[136:139], v[164:167], v[128:143]
    ds_read_b128 v[160:163], v176 offset:36864
    v_exp_f32 v23, v23
    v_add_f32 v16, 1.0, v16
    v_add_f32 v17, 1.0, v17
    v_add_f32_e64 v18, 1.0, v18
    v_mfma_f32_32x32x16_bf16 v[144:159], a[140:143], v[164:167], v[144:159]
    s_waitcnt lgkmcnt(2)
    v_add_f32 v19, 1.0, v19
    v_add_f32_e64 v20, 1.0, v20
    v_mfma_f32_32x32x16_bf16 v[128:143], a[144:147], v[168:171], v[128:143]
    ds_read_b128 v[164:167], v177 offset:36864
    v_add_f32 v21, 1.0, v21
    v_add_f32 v22, 1.0, v22
    v_add_f32 v23, 1.0, v23
    v_rcp_f32 v16, v16
    v_mfma_f32_32x32x16_bf16 v[144:159], a[148:151], v[168:171], v[144:159]
    s_waitcnt lgkmcnt(2)
    v_rcp_f32 v17, v17
    v_rcp_f32 v18, v18
    v_rcp_f32 v19, v19
    v_mfma_f32_32x32x16_bf16 v[128:143], a[152:155], v[172:175], v[128:143]
    ds_read_b128 v[168:171], v178 offset:36864
    v_mfma_f32_32x32x16_bf16 v[144:159], a[156:159], v[172:175], v[144:159]
    s_waitcnt lgkmcnt(2)
    s_add_u32 m0, s48, 24576
    s_add_u32 s61, s46, 205312
    buffer_load_dwordx4 v183, s[24:27], s61 offen lds
    v_mfma_f32_32x32x16_bf16 v[128:143], a[160:163], v[160:163], v[128:143]
    ds_read_b128 v[172:175], v179 offset:36864
    v_rcp_f32 v20, v20
    v_rcp_f32_e64 v21, v21
    v_mfma_f32_32x32x16_bf16 v[144:159], a[164:167], v[160:163], v[144:159]
    s_waitcnt lgkmcnt(2)
    v_rcp_f32 v22, v22
    v_mfma_f32_32x32x16_bf16 v[128:143], a[168:171], v[164:167], v[128:143]
    ds_read_b128 v[160:163], v176 offset:40960
    v_rcp_f32 v23, v23
    v_mul_f32 v24, v16, v24
    v_mul_f32 v25, v17, v25
    v_mul_f32 v26, v18, v26
    v_mfma_f32_32x32x16_bf16 v[144:159], a[172:175], v[164:167], v[144:159]
    s_waitcnt lgkmcnt(2)
    v_mul_f32 v27, v19, v27
    v_mul_f32 v28, v20, v28
    v_mul_f32 v29, v21, v29
    v_mul_f32 v30, v22, v30
    v_mul_f32 v31, v23, v31
    v_cvt_pk_bf16_f32 v16, v24, v25
    v_mfma_f32_32x32x16_bf16 v[128:143], a[176:179], v[168:171], v[128:143]
    ds_read_b128 v[164:167], v177 offset:40960
    v_cvt_pk_bf16_f32 v17, v26, v27
    v_mfma_f32_32x32x16_bf16 v[144:159], a[180:183], v[168:171], v[144:159]
    s_waitcnt lgkmcnt(2)
    s_add_u32 m0, s48, 28672
    s_add_u32 s61, s46, 205440
    buffer_load_dwordx4 v183, s[24:27], s61 offen lds
    v_cvt_pk_bf16_f32 v18, v28, v29
    v_mfma_f32_32x32x16_bf16 v[128:143], a[184:187], v[172:175], v[128:143]
    ds_read_b128 v[168:171], v178 offset:40960
    v_cvt_pk_bf16_f32 v19, v30, v31
    s_add_u32 s61, s16, 0
    buffer_store_dwordx4 v[16:19], v184, s[32:35], s61 offen offset:512 sc1
    v_mfma_f32_32x32x16_bf16 v[144:159], a[188:191], v[172:175], v[144:159]
    s_waitcnt lgkmcnt(2)
    v_mul_f32 v40, v32, v40
    v_mul_f32_e64 v41, v33, v41
    v_mfma_f32_32x32x16_bf16 v[128:143], a[192:195], v[160:163], v[128:143]
    ds_read_b128 v[172:175], v179 offset:40960
    v_mul_f32 v42, v34, v42
    v_mul_f32 v43, v35, v43
    v_mul_f32 v44, v36, v44
    v_mul_f32 v45, v37, v45
    v_mul_f32_e64 v46, v38, v46
    v_mfma_f32_32x32x16_bf16 v[144:159], a[196:199], v[160:163], v[144:159]
    s_waitcnt lgkmcnt(2)
    v_mul_f32 v47, v39, v47
    v_mul_f32 v32, s17, v32
    v_mul_f32 v33, s17, v33
    v_mul_f32 v34, s17, v34
    v_mul_f32 v35, s17, v35
    v_mul_f32_e64 v36, s17, v36
    v_mfma_f32_32x32x16_bf16 v[128:143], a[200:203], v[164:167], v[128:143]
    ds_read_b128 v[160:163], v176 offset:45056
    v_mul_f32_e64 v37, s17, v37
    v_mfma_f32_32x32x16_bf16 v[144:159], a[204:207], v[164:167], v[144:159]
    s_waitcnt lgkmcnt(2)
    v_mul_f32 v38, s17, v38
    v_mul_f32 v39, s17, v39
    v_exp_f32 v32, v32
    v_exp_f32_e64 v33, v33
    v_mfma_f32_32x32x16_bf16 v[128:143], a[208:211], v[168:171], v[128:143]
    ds_read_b128 v[164:167], v177 offset:45056
    v_exp_f32 v34, v34
    v_exp_f32 v35, v35
    v_mfma_f32_32x32x16_bf16 v[144:159], a[212:215], v[168:171], v[144:159]
    s_waitcnt lgkmcnt(2)
    v_exp_f32 v36, v36
    v_mfma_f32_32x32x16_bf16 v[128:143], a[216:219], v[172:175], v[128:143]
    ds_read_b128 v[168:171], v178 offset:45056
    v_exp_f32 v37, v37
    v_exp_f32 v38, v38
    v_mfma_f32_32x32x16_bf16 v[144:159], a[220:223], v[172:175], v[144:159]
    s_waitcnt lgkmcnt(2)
    v_exp_f32 v39, v39
    v_add_f32 v32, 1.0, v32
    v_add_f32 v33, 1.0, v33
    v_add_f32 v34, 1.0, v34
    v_add_f32 v35, 1.0, v35
    v_mfma_f32_32x32x16_bf16 v[128:143], a[224:227], v[160:163], v[128:143]
    ds_read_b128 v[172:175], v179 offset:45056
    v_add_f32_e64 v36, 1.0, v36
    v_mfma_f32_32x32x16_bf16 v[144:159], a[228:231], v[160:163], v[144:159]
    s_waitcnt lgkmcnt(2)
    v_add_f32 v37, 1.0, v37
    v_add_f32 v38, 1.0, v38
    v_add_f32 v39, 1.0, v39
    v_rcp_f32_e64 v32, v32
    v_mfma_f32_32x32x16_bf16 v[128:143], a[232:235], v[164:167], v[128:143]
    s_waitcnt vmcnt(11) lgkmcnt(0)
    s_barrier
    ds_read_b128 v[160:163], v176 offset:0
    v_rcp_f32_e64 v33, v33
    v_mfma_f32_32x32x16_bf16 v[144:159], a[236:239], v[164:167], v[144:159]
    s_add_u32 m0, s48, 32768
    s_add_u32 s61, s46, 205568
    buffer_load_dwordx4 v183, s[24:27], s61 offen lds
    v_mfma_f32_32x32x16_bf16 v[128:143], a[240:243], v[168:171], v[128:143]
    ds_read_b128 v[164:167], v177 offset:0
    buffer_load_dword v191, v190, s[72:75], 0 offen sc1
    v_rcp_f32_e64 v34, v34
    v_mfma_f32_32x32x16_bf16 v[144:159], a[244:247], v[168:171], v[144:159]
    v_rcp_f32 v35, v35
    v_rcp_f32 v36, v36
    v_rcp_f32_e64 v37, v37
    v_mfma_f32_32x32x16_bf16 v[128:143], a[248:251], v[172:175], v[128:143]
    ds_read_b128 v[168:171], v178 offset:0
    v_mfma_f32_32x32x16_bf16 v[144:159], a[252:255], v[172:175], v[144:159]
    s_waitcnt lgkmcnt(2)
    v_rcp_f32 v38, v38
    v_rcp_f32 v39, v39
    v_mul_f32 v40, v32, v40
    v_mul_f32_e64 v41, v33, v41
    v_mfma_f32_32x32x16_bf16 v[128:143], v[192:195], v[160:163], v[128:143]
    ds_read_b128 v[172:175], v179 offset:0
    v_mul_f32 v42, v34, v42
    v_mul_f32 v43, v35, v43
    v_mul_f32 v44, v36, v44
    v_mul_f32 v45, v37, v45
    v_mul_f32_e64 v46, v38, v46
    v_mfma_f32_32x32x16_bf16 v[144:159], v[196:199], v[160:163], v[144:159]
    s_waitcnt lgkmcnt(2)
    s_add_u32 m0, s48, 36864
    s_add_u32 s61, s46, 205696
    buffer_load_dwordx4 v183, s[24:27], s61 offen lds
    v_mfma_f32_32x32x16_bf16 v[128:143], v[200:203], v[164:167], v[128:143]
    ds_read_b128 v[160:163], v176 offset:4096
    v_mul_f32 v47, v39, v47
    v_cvt_pk_bf16_f32 v32, v40, v41
    v_cvt_pk_bf16_f32 v33, v42, v43
    v_cvt_pk_bf16_f32 v34, v44, v45
    v_cvt_pk_bf16_f32 v35, v46, v47
    v_mfma_f32_32x32x16_bf16 v[144:159], v[204:207], v[164:167], v[144:159]
    s_waitcnt lgkmcnt(2)
    s_add_u32 s61, s16, 139264
    buffer_store_dwordx4 v[32:35], v184, s[32:35], s61 offen offset:0 sc1
    v_mul_f32 v56, v48, v56
    v_mul_f32_e64 v57, v49, v57
    v_mfma_f32_32x32x16_bf16 v[128:143], v[208:211], v[168:171], v[128:143]
    ds_read_b128 v[164:167], v177 offset:4096
    v_mul_f32_e64 v58, v50, v58
    v_mfma_f32_32x32x16_bf16 v[144:159], v[212:215], v[168:171], v[144:159]
    s_waitcnt lgkmcnt(2)
    v_mul_f32 v59, v51, v59
    v_mul_f32 v60, v52, v60
    v_mul_f32 v61, v53, v61
    v_mul_f32 v62, v54, v62
    v_mul_f32 v63, v55, v63
    v_mul_f32_e64 v48, s17, v48
    v_mfma_f32_32x32x16_bf16 v[128:143], v[216:219], v[172:175], v[128:143]
    ds_read_b128 v[168:171], v178 offset:4096
    v_mul_f32 v49, s17, v49
    v_mul_f32 v50, s17, v50
    v_mul_f32 v51, s17, v51
    v_mul_f32 v52, s17, v52
    v_mul_f32_e64 v53, s17, v53
    v_mfma_f32_32x32x16_bf16 v[144:159], v[220:223], v[172:175], v[144:159]
    s_waitcnt lgkmcnt(2)
    s_add_u32 m0, s48, 40960
    s_add_u32 s61, s46, 205824
    buffer_load_dwordx4 v183, s[24:27], s61 offen lds
    v_mfma_f32_32x32x16_bf16 v[128:143], v[224:227], v[160:163], v[128:143]
    ds_read_b128 v[172:175], v179 offset:4096
    v_mul_f32 v54, s17, v54
    v_mul_f32 v55, s17, v55
    v_exp_f32 v48, v48
    v_mfma_f32_32x32x16_bf16 v[144:159], v[228:231], v[160:163], v[144:159]
    s_waitcnt lgkmcnt(2)
    v_exp_f32 v49, v49
    v_exp_f32 v50, v50
    v_exp_f32 v51, v51
    v_mfma_f32_32x32x16_bf16 v[128:143], v[232:235], v[164:167], v[128:143]
    ds_read_b128 v[160:163], v176 offset:8192
    v_mfma_f32_32x32x16_bf16 v[144:159], v[236:239], v[164:167], v[144:159]
    s_waitcnt lgkmcnt(2)
    v_exp_f32 v52, v52
    v_exp_f32 v53, v53
    v_exp_f32 v54, v54
    v_mfma_f32_32x32x16_bf16 v[128:143], v[240:243], v[168:171], v[128:143]
    ds_read_b128 v[164:167], v177 offset:8192
    v_exp_f32 v55, v55
    v_add_f32 v48, 1.0, v48
    v_add_f32 v49, 1.0, v49
    v_add_f32 v50, 1.0, v50
    v_mfma_f32_32x32x16_bf16 v[144:159], v[244:247], v[168:171], v[144:159]
    s_waitcnt lgkmcnt(2)
    s_add_u32 m0, s48, 45056
    s_add_u32 s61, s46, 205952
    buffer_load_dwordx4 v183, s[24:27], s61 offen lds
    v_mfma_f32_32x32x16_bf16 v[128:143], v[248:251], v[172:175], v[128:143]
    ds_read_b128 v[168:171], v178 offset:8192
    v_add_f32 v51, 1.0, v51
    v_add_f32 v52, 1.0, v52
    v_add_f32 v53, 1.0, v53
    v_add_f32 v54, 1.0, v54
    v_add_f32 v55, 1.0, v55
    v_mfma_f32_32x32x16_bf16 v[144:159], v[252:255], v[172:175], v[144:159]
    s_waitcnt lgkmcnt(2)
    v_rcp_f32 v48, v48
    v_rcp_f32 v49, v49
    v_rcp_f32 v50, v50
    v_mfma_f32_32x32x16_bf16 v[0:15], a[0:3], v[160:163], 0
    ds_read_b128 v[172:175], v179 offset:8192
    v_mfma_f32_32x32x16_bf16 v[16:31], a[4:7], v[160:163], 0
    s_waitcnt lgkmcnt(2)
    v_rcp_f32 v51, v51
    v_rcp_f32 v52, v52
    v_rcp_f32 v53, v53
    v_mfma_f32_32x32x16_bf16 v[0:15], a[8:11], v[164:167], v[0:15]
    ds_read_b128 v[160:163], v176 offset:12288
    s_add_u32 s63, s10, 24576
    buffer_load_dwordx4 a[0:3], v188, s[40:43], s63 offen offset:0 sc1
    v_mfma_f32_32x32x16_bf16 v[16:31], a[12:15], v[164:167], v[16:31]
    s_waitcnt lgkmcnt(2)
    v_rcp_f32 v54, v54
    v_rcp_f32 v55, v55
    v_mul_f32 v56, v48, v56
    v_mul_f32_e64 v57, v49, v57
    v_mfma_f32_32x32x16_bf16 v[0:15], a[16:19], v[168:171], v[0:15]
    ds_read_b128 v[164:167], v177 offset:12288
    buffer_load_dwordx4 a[4:7], v188, s[40:43], s63 offen offset:1024 sc1
    v_mul_f32_e64 v58, v50, v58
    v_mfma_f32_32x32x16_bf16 v[16:31], a[20:23], v[168:171], v[16:31]
    s_waitcnt lgkmcnt(2)
    v_mul_f32 v59, v51, v59
    v_mul_f32 v60, v52, v60
    v_mul_f32 v61, v53, v61
    v_mul_f32 v62, v54, v62
    v_mul_f32 v63, v55, v63
    v_cvt_pk_bf16_f32 v48, v56, v57
    v_mfma_f32_32x32x16_bf16 v[0:15], a[24:27], v[172:175], v[0:15]
    ds_read_b128 v[168:171], v178 offset:12288
    buffer_load_dwordx4 a[8:11], v188, s[40:43], s63 offen offset:2048 sc1
    v_cvt_pk_bf16_f32 v49, v58, v59
    v_mfma_f32_32x32x16_bf16 v[16:31], a[28:31], v[172:175], v[16:31]
    s_waitcnt lgkmcnt(2)
    v_cvt_pk_bf16_f32 v50, v60, v61
    v_cvt_pk_bf16_f32 v51, v62, v63
    s_add_u32 s61, s16, 139264
    buffer_store_dwordx4 v[48:51], v184, s[32:35], s61 offen offset:512 sc1
    v_mfma_f32_32x32x16_bf16 v[0:15], a[32:35], v[160:163], v[0:15]
    ds_read_b128 v[172:175], v179 offset:12288
    buffer_load_dwordx4 a[12:15], v188, s[40:43], s63 offen offset:3072 sc1
    v_mul_f32 v72, v64, v72
    v_mfma_f32_32x32x16_bf16 v[16:31], a[36:39], v[160:163], v[16:31]
    s_waitcnt lgkmcnt(2)
    v_mul_f32 v73, v65, v73
    v_mul_f32 v74, v66, v74
    v_mul_f32 v75, v67, v75
    v_mul_f32 v76, v68, v76
    v_mul_f32 v77, v69, v77
    v_mul_f32_e64 v78, v70, v78
    v_mfma_f32_32x32x16_bf16 v[0:15], a[40:43], v[164:167], v[0:15]
    s_waitcnt vmcnt(12) lgkmcnt(0)
    s_barrier
    ds_read_b128 v[160:163], v176 offset:16384
    s_add_u32 s63, s10, 0
    buffer_load_dwordx4 v[32:35], v188, s[40:43], s63 offen offset:0 sc1
    s_waitcnt vmcnt(10)
    v_cmp_le_u32 vcc, 20, v191
    s_nop 0
    s_andn2_b32 s84, 0x4, vcc_lo
    s_cbranch_scc1 L_retry67
L_ok67:
    v_mfma_f32_32x32x16_bf16 v[16:31], a[44:47], v[164:167], v[16:31]
    v_mul_f32 v79, v71, v79
    v_mul_f32 v64, s17, v64
    v_mul_f32 v65, s17, v65
    v_mul_f32 v66, s17, v66
    v_mul_f32 v67, s17, v67
    v_mul_f32 v68, s17, v68
    s_and_b32 s57, s2, 6
    s_lshl_b32 s57, s57, 2
    v_mfma_f32_32x32x16_bf16 v[0:15], a[48:51], v[168:171], v[0:15]
    ds_read_b128 v[164:167], v177 offset:16384
    buffer_load_dwordx4 v[36:39], v188, s[40:43], s63 offen offset:1024 sc1
    v_mul_f32_e64 v69, s17, v69
    s_bfe_u32 s58, s2, 0x10005
    s_lshl_b32 s58, s58, 2
    v_mfma_f32_32x32x16_bf16 v[16:31], a[52:55], v[168:171], v[16:31]
    v_mul_f32 v70, s17, v70
    v_mul_f32 v71, s17, v71
    v_exp_f32 v64, v64
    v_exp_f32_e64 v65, v65
    s_add_u32 s57, s57, s58
    s_and_b32 s58, s55, 3
    v_mfma_f32_32x32x16_bf16 v[0:15], a[56:59], v[172:175], v[0:15]
    ds_read_b128 v[168:171], v178 offset:16384
    buffer_load_dwordx4 v[40:43], v188, s[40:43], s63 offen offset:2048 sc1
    s_add_u32 s58, s58, s57
    s_mul_i32 s59, s58, 43
    v_mfma_f32_32x32x16_bf16 v[16:31], a[60:63], v[172:175], v[16:31]
    s_waitcnt lgkmcnt(2)
    v_exp_f32 v66, v66
    v_exp_f32 v67, v67
    v_exp_f32_e64 v68, v68
    s_lshr_b32 s59, s59, 7
    s_bfe_u32 s60, s55, 0x20002
    v_mfma_f32_32x32x16_bf16 v[0:15], a[64:67], v[160:163], v[0:15]
    ds_read_b128 v[172:175], v179 offset:16384
    buffer_load_dwordx4 v[44:47], v188, s[40:43], s63 offen offset:3072 sc1
    s_mul_i32 s45, s59, 6144
    s_lshl_b32 s53, s60, 7
    v_mfma_f32_32x32x16_bf16 v[16:31], a[68:71], v[160:163], v[16:31]
    s_waitcnt lgkmcnt(2)
    v_exp_f32 v69, v69
    v_exp_f32 v70, v70
    v_exp_f32 v71, v71
    s_add_u32 s45, s45, s53
    s_cmp_lt_u32 s58, 30
    s_cselect_b32 s53, 3, 2
    v_mfma_f32_32x32x16_bf16 v[0:15], a[72:75], v[164:167], v[0:15]
    ds_read_b128 v[160:163], v176 offset:20480
    s_add_u32 s63, s10, 4096
    buffer_load_dwordx4 v[48:51], v188, s[40:43], s63 offen offset:0 sc1
    v_add_f32_e64 v64, 1.0, v64
    s_mul_i32 s60, s60, s53
    s_mul_i32 s4, s59, 9
    v_mfma_f32_32x32x16_bf16 v[16:31], a[76:79], v[164:167], v[16:31]
    s_waitcnt lgkmcnt(2)
    v_add_f32 v65, 1.0, v65
    v_add_f32 v66, 1.0, v66
    v_add_f32 v67, 1.0, v67
    v_add_f32 v68, 1.0, v68
    v_add_f32 v69, 1.0, v69
    v_add_f32_e64 v70, 1.0, v70
    s_add_u32 s4, s4, s58
    s_add_u32 s4, s4, s60
    v_mfma_f32_32x32x16_bf16 v[0:15], a[80:83], v[168:171], v[0:15]
    ds_read_b128 v[164:167], v177 offset:20480
    buffer_load_dwordx4 v[52:55], v188, s[40:43], s63 offen offset:1024 sc1
    v_add_f32_e64 v71, 1.0, v71
    s_add_u32 s55, s55, s56
    s_and_b32 s58, s55, 3
    v_mfma_f32_32x32x16_bf16 v[16:31], a[84:87], v[168:171], v[16:31]
    s_waitcnt lgkmcnt(2)
    v_rcp_f32 v64, v64
    v_rcp_f32 v65, v65
    v_rcp_f32 v66, v66
    s_add_u32 s58, s58, s57
    s_mul_i32 s59, s58, 43
    v_mfma_f32_32x32x16_bf16 v[0:15], a[88:91], v[172:175], v[0:15]
    ds_read_b128 v[168:171], v178 offset:20480
    buffer_load_dwordx4 v[56:59], v188, s[40:43], s63 offen offset:2048 sc1
    s_lshr_b32 s59, s59, 7
    s_bfe_u32 s60, s55, 0x20002
    v_mfma_f32_32x32x16_bf16 v[16:31], a[92:95], v[172:175], v[16:31]
    s_waitcnt lgkmcnt(2)
    v_rcp_f32 v67, v67
    v_rcp_f32 v68, v68
    v_rcp_f32_e64 v69, v69
    s_mul_i32 s46, s59, 6144
    s_lshl_b32 s53, s60, 7
    v_mfma_f32_32x32x16_bf16 v[0:15], a[96:99], v[160:163], v[0:15]
    ds_read_b128 v[172:175], v179 offset:20480
    buffer_load_dwordx4 v[60:63], v188, s[40:43], s63 offen offset:3072 sc1
    s_add_u32 s46, s46, s53
    s_cmp_lt_u32 s58, 30
    s_cselect_b32 s53, 3, 2
    v_mfma_f32_32x32x16_bf16 v[16:31], a[100:103], v[160:163], v[16:31]
    s_waitcnt lgkmcnt(2)
    v_rcp_f32 v70, v70
    v_rcp_f32 v71, v71
    v_mul_f32 v72, v64, v72
    v_mul_f32_e64 v73, v65, v73
    s_mul_i32 s60, s60, s53
    s_mul_i32 s5, s59, 9
    v_mfma_f32_32x32x16_bf16 v[0:15], a[104:107], v[164:167], v[0:15]
    ds_read_b128 v[160:163], v176 offset:24576
    s_add_u32 s63, s10, 28672
    buffer_load_dwordx4 a[16:19], v188, s[40:43], s63 offen offset:0 sc1
    v_mul_f32_e64 v74, v66, v74
    s_add_u32 s5, s5, s58
    s_add_u32 s5, s5, s60
    v_mfma_f32_32x32x16_bf16 v[16:31], a[108:111], v[164:167], v[16:31]
    s_waitcnt lgkmcnt(2)
    v_mul_f32 v75, v67, v75
    v_mul_f32 v76, v68, v76
    v_mul_f32 v77, v69, v77
    v_mul_f32 v78, v70, v78
    v_mul_f32 v79, v71, v79
    v_cvt_pk_bf16_f32 v64, v72, v73
    s_mul_i32 s12, s44, 12288
    s_add_u32 s12, s12, 20480
    v_mfma_f32_32x32x16_bf16 v[0:15], a[112:115], v[168:171], v[0:15]
    ds_read_b128 v[164:167], v177 offset:24576
    buffer_load_dwordx4 a[20:23], v188, s[40:43], s63 offen offset:1024 sc1
    v_cvt_pk_bf16_f32 v65, v74, v75
    s_mul_i32 s59, s44, 3
    v_add_u32 v190, s59, v185
    v_mfma_f32_32x32x16_bf16 v[16:31], a[116:119], v[168:171], v[16:31]
    s_waitcnt lgkmcnt(2)
    v_cvt_pk_bf16_f32 v66, v76, v77
    v_cvt_pk_bf16_f32 v67, v78, v79
    s_add_u32 s61, s16, 278528
    buffer_store_dwordx4 v[64:67], v184, s[32:35], s61 offen offset:0 sc1
    v_lshlrev_b32 v190, 9, v190
    s_mov_b32 vcc_lo, 7
    s_mov_b32 vcc_hi, 0
    v_mfma_f32_32x32x16_bf16 v[0:15], a[120:123], v[172:175], v[0:15]
    ds_read_b128 v[168:171], v178 offset:24576
    buffer_load_dwordx4 a[24:27], v188, s[40:43], s63 offen offset:2048 sc1
    v_mul_f32 v88, v80, v88
    v_mov_b32_e64 v191, 0x40000000
    v_cndmask_b32 v190, v191, v190, vcc
    v_mfma_f32_32x32x16_bf16 v[16:31], a[124:127], v[172:175], v[16:31]
    s_waitcnt lgkmcnt(2)
    s_waitcnt vmcnt(13)
    s_mov_b64 exec, 1
    v_mov_b32 v187, s19
    ds_or_rtn_b32 v187, v180, v187 offset:0
    s_mov_b64 exec, -1
    v_mfma_f32_32x32x16_bf16 v[0:15], a[128:131], v[160:163], v[0:15]
    ds_read_b128 v[172:175], v179 offset:24576
    buffer_load_dwordx4 a[28:31], v188, s[40:43], s63 offen offset:3072 sc1
    v_mul_f32 v89, v81, v89
    v_mfma_f32_32x32x16_bf16 v[16:31], a[132:135], v[160:163], v[16:31]
    s_waitcnt lgkmcnt(3)
    v_mul_f32 v90, v82, v90
    v_mul_f32 v91, v83, v91
    v_mul_f32 v92, v84, v92
    v_mul_f32 v93, v85, v93
    v_mul_f32 v94, v86, v94
    v_mul_f32_e64 v95, v87, v95
    v_mfma_f32_32x32x16_bf16 v[0:15], a[136:139], v[164:167], v[0:15]
    ds_read_b128 v[160:163], v176 offset:28672
    s_add_u32 s63, s11, 12288
    buffer_load_dwordx4 a[80:83], v188, s[40:43], s63 offen offset:0 sc1
    v_mul_f32_e64 v80, s17, v80
    v_mfma_f32_32x32x16_bf16 v[16:31], a[140:143], v[164:167], v[16:31]
    s_waitcnt lgkmcnt(3)
    s_waitcnt lgkmcnt(2)
    v_readfirstlane_b32 s84, v187
    v_mov_b32_e64 v187, 1
    s_or_b32 s84, s84, s19
    s_cmp_lg_u32 s84, 15
    s_cbranch_scc1 L_pb68
    buffer_store_dword v187, v189, s[68:71], s18 offen offset:0 sc1
    L_pb68:
    v_mfma_f32_32x32x16_bf16 v[0:15], a[144:147], v[168:171], v[0:15]
    ds_read_b128 v[164:167], v177 offset:28672
    buffer_load_dwordx4 a[84:87], v188, s[40:43], s63 offen offset:1024 sc1
    v_mul_f32_e64 v81, s17, v81
    v_mfma_f32_32x32x16_bf16 v[16:31], a[148:151], v[168:171], v[16:31]
    s_waitcnt lgkmcnt(2)
    v_mul_f32 v82, s17, v82
    v_mul_f32 v83, s17, v83
    v_mul_f32 v84, s17, v84
    v_mul_f32 v85, s17, v85
    v_mul_f32 v86, s17, v86
    v_mul_f32_e64 v87, s17, v87
    v_mfma_f32_32x32x16_bf16 v[0:15], a[152:155], v[172:175], v[0:15]
    ds_read_b128 v[168:171], v178 offset:28672
    s_add_u32 s63, s10, 32768
    buffer_load_dwordx4 a[144:147], v188, s[40:43], s63 offen offset:0 sc1
    v_mfma_f32_32x32x16_bf16 v[16:31], a[156:159], v[172:175], v[16:31]
    s_waitcnt lgkmcnt(2)
    v_exp_f32 v80, v80
    v_exp_f32 v81, v81
    v_exp_f32 v82, v82
    v_mfma_f32_32x32x16_bf16 v[0:15], a[160:163], v[160:163], v[0:15]
    ds_read_b128 v[172:175], v179 offset:28672
    s_add_u32 s63, s11, 12288
    buffer_load_dwordx4 a[88:91], v188, s[40:43], s63 offen offset:2048 sc1
    v_mfma_f32_32x32x16_bf16 v[16:31], a[164:167], v[160:163], v[16:31]
    s_waitcnt lgkmcnt(2)
    v_exp_f32 v83, v83
    v_exp_f32 v84, v84
    v_exp_f32 v85, v85
    v_mfma_f32_32x32x16_bf16 v[0:15], a[168:171], v[164:167], v[0:15]
    s_waitcnt lgkmcnt(0)
    s_barrier
    ds_read_b128 v[160:163], v176 offset:32768
    buffer_load_dwordx4 a[92:95], v188, s[40:43], s63 offen offset:3072 sc1
    v_mfma_f32_32x32x16_bf16 v[16:31], a[172:175], v[164:167], v[16:31]
    v_exp_f32 v86, v86
    v_exp_f32 v87, v87
    v_add_f32 v80, 1.0, v80
    v_add_f32 v81, 1.0, v81
    v_mfma_f32_32x32x16_bf16 v[0:15], a[176:179], v[168:171], v[0:15]
    ds_read_b128 v[164:167], v177 offset:32768
    s_add_u32 s63, s11, 0
    buffer_load_dwordx4 a[96:99], v188, s[40:43], s63 offen offset:0 sc1
    v_add_f32 v82, 1.0, v82
    v_mfma_f32_32x32x16_bf16 v[16:31], a[180:183], v[168:171], v[16:31]
    v_add_f32 v83, 1.0, v83
    v_add_f32 v84, 1.0, v84
    v_add_f32 v85, 1.0, v85
    v_add_f32 v86, 1.0, v86
    v_add_f32_e64 v87, 1.0, v87
    v_mfma_f32_32x32x16_bf16 v[0:15], a[184:187], v[172:175], v[0:15]
    ds_read_b128 v[168:171], v178 offset:32768
    buffer_load_dwordx4 a[100:103], v188, s[40:43], s63 offen offset:1024 sc1
    v_mfma_f32_32x32x16_bf16 v[16:31], a[188:191], v[172:175], v[16:31]
    s_waitcnt lgkmcnt(2)
    v_rcp_f32 v80, v80
    v_rcp_f32 v81, v81
    v_rcp_f32 v82, v82
    v_mfma_f32_32x32x16_bf16 v[0:15], a[192:195], v[160:163], v[0:15]
    ds_read_b128 v[172:175], v179 offset:32768
    buffer_load_dwordx4 a[104:107], v188, s[40:43], s63 offen offset:2048 sc1
    v_mfma_f32_32x32x16_bf16 v[16:31], a[196:199], v[160:163], v[16:31]
    s_waitcnt lgkmcnt(2)
    v_rcp_f32 v83, v83
    v_rcp_f32 v84, v84
    v_rcp_f32 v85, v85
    v_mfma_f32_32x32x16_bf16 v[0:15], a[200:203], v[164:167], v[0:15]
    ds_read_b128 v[160:163], v176 offset:36864
    buffer_load_dwordx4 a[108:111], v188, s[40:43], s63 offen offset:3072 sc1
    v_mfma_f32_32x32x16_bf16 v[16:31], a[204:207], v[164:167], v[16:31]
    s_waitcnt lgkmcnt(2)
    v_rcp_f32 v86, v86
    v_rcp_f32 v87, v87
    v_mul_f32 v88, v80, v88
    v_mul_f32_e64 v89, v81, v89
    v_mfma_f32_32x32x16_bf16 v[0:15], a[208:211], v[168:171], v[0:15]
    ds_read_b128 v[164:167], v177 offset:36864
    s_add_u32 s63, s11, 4096
    buffer_load_dwordx4 a[112:115], v188, s[40:43], s63 offen offset:0 sc1
    v_mul_f32_e64 v90, v82, v90
    v_mfma_f32_32x32x16_bf16 v[16:31], a[212:215], v[168:171], v[16:31]
    s_waitcnt lgkmcnt(2)
    v_mul_f32 v91, v83, v91
    v_mul_f32 v92, v84, v92
    v_mul_f32 v93, v85, v93
    v_mul_f32 v94, v86, v94
    v_mul_f32 v95, v87, v95
    v_cvt_pk_bf16_f32 v80, v88, v89
    v_mfma_f32_32x32x16_bf16 v[0:15], a[216:219], v[172:175], v[0:15]
    ds_read_b128 v[168:171], v178 offset:36864
    buffer_load_dwordx4 a[116:119], v188, s[40:43], s63 offen offset:1024 sc1
    v_cvt_pk_bf16_f32 v81, v90, v91
    v_mfma_f32_32x32x16_bf16 v[16:31], a[220:223], v[172:175], v[16:31]
    s_waitcnt lgkmcnt(2)
    v_cvt_pk_bf16_f32 v82, v92, v93
    v_cvt_pk_bf16_f32 v83, v94, v95
    s_add_u32 s61, s16, 278528
    buffer_store_dwordx4 v[80:83], v184, s[32:35], s61 offen offset:512 sc1
    v_mfma_f32_32x32x16_bf16 v[0:15], a[224:227], v[160:163], v[0:15]
    ds_read_b128 v[172:175], v179 offset:36864
    buffer_load_dwordx4 a[120:123], v188, s[40:43], s63 offen offset:2048 sc1
    v_mul_f32 v104, v96, v104
    v_mfma_f32_32x32x16_bf16 v[16:31], a[228:231], v[160:163], v[16:31]
    s_waitcnt lgkmcnt(2)
    v_mul_f32 v105, v97, v105
    v_mul_f32 v106, v98, v106
    v_mul_f32 v107, v99, v107
    v_mul_f32 v108, v100, v108
    v_mul_f32 v109, v101, v109
    v_mul_f32_e64 v110, v102, v110
    v_mfma_f32_32x32x16_bf16 v[0:15], a[232:235], v[164:167], v[0:15]
    ds_read_b128 v[160:163], v176 offset:40960
    s_add_u32 s63, s10, 8192
    buffer_load_dwordx4 v[64:67], v188, s[40:43], s63 offen offset:0 sc1
    v_mul_f32_e64 v111, v103, v111
    v_mfma_f32_32x32x16_bf16 v[16:31], a[236:239], v[164:167], v[16:31]
    s_waitcnt lgkmcnt(2)
    v_mul_f32 v96, s17, v96
    v_mul_f32 v97, s17, v97
    v_mul_f32 v98, s17, v98
    v_mul_f32 v99, s17, v99
    v_mul_f32 v100, s17, v100
    v_mul_f32_e64 v101, s17, v101
    v_mfma_f32_32x32x16_bf16 v[0:15], a[240:243], v[168:171], v[0:15]
    ds_read_b128 v[164:167], v177 offset:40960
    buffer_load_dwordx4 v[68:71], v188, s[40:43], s63 offen offset:1024 sc1
    v_mul_f32_e64 v102, s17, v102
    v_mfma_f32_32x32x16_bf16 v[16:31], a[244:247], v[168:171], v[16:31]
    s_waitcnt lgkmcnt(2)
    v_mul_f32 v103, s17, v103
    v_exp_f32 v96, v96
    v_exp_f32 v97, v97
    v_mfma_f32_32x32x16_bf16 v[0:15], a[248:251], v[172:175], v[0:15]
    ds_read_b128 v[168:171], v178 offset:40960
    buffer_load_dwordx4 v[72:75], v188, s[40:43], s63 offen offset:2048 sc1
    v_mfma_f32_32x32x16_bf16 v[16:31], a[252:255], v[172:175], v[16:31]
    s_waitcnt lgkmcnt(2)
    v_exp_f32 v98, v98
    v_exp_f32 v99, v99
    v_exp_f32 v100, v100
    v_mfma_f32_32x32x16_bf16 v[0:15], v[192:195], v[160:163], v[0:15]
    ds_read_b128 v[172:175], v179 offset:40960
    buffer_load_dwordx4 v[76:79], v188, s[40:43], s63 offen offset:3072 sc1
    v_mfma_f32_32x32x16_bf16 v[16:31], v[196:199], v[160:163], v[16:31]
    s_waitcnt lgkmcnt(2)
    v_exp_f32 v101, v101
    v_exp_f32 v102, v102
    v_exp_f32 v103, v103
    v_mfma_f32_32x32x16_bf16 v[0:15], v[200:203], v[164:167], v[0:15]
    ds_read_b128 v[160:163], v176 offset:45056
    s_add_u32 s63, s10, 12288
    buffer_load_dwordx4 v[80:83], v188, s[40:43], s63 offen offset:0 sc1
    v_add_f32_e64 v96, 1.0, v96
    v_mfma_f32_32x32x16_bf16 v[16:31], v[204:207], v[164:167], v[16:31]
    s_waitcnt lgkmcnt(2)
    v_add_f32 v97, 1.0, v97
    v_add_f32 v98, 1.0, v98
    v_add_f32 v99, 1.0, v99
    v_add_f32 v100, 1.0, v100
    v_add_f32 v101, 1.0, v101
    v_add_f32_e64 v102, 1.0, v102
    v_mfma_f32_32x32x16_bf16 v[0:15], v[208:211], v[168:171], v[0:15]
    ds_read_b128 v[164:167], v177 offset:45056
    buffer_load_dwordx4 v[84:87], v188, s[40:43], s63 offen offset:1024 sc1
    v_add_f32_e64 v103, 1.0, v103
    v_mfma_f32_32x32x16_bf16 v[16:31], v[212:215], v[168:171], v[16:31]
    s_waitcnt lgkmcnt(2)
    v_rcp_f32 v96, v96
    v_rcp_f32 v97, v97
    v_rcp_f32 v98, v98
    v_mfma_f32_32x32x16_bf16 v[0:15], v[216:219], v[172:175], v[0:15]
    ds_read_b128 v[168:171], v178 offset:45056
    buffer_load_dwordx4 v[88:91], v188, s[40:43], s63 offen offset:2048 sc1
    v_mfma_f32_32x32x16_bf16 v[16:31], v[220:223], v[172:175], v[16:31]
    s_waitcnt lgkmcnt(2)
    v_rcp_f32 v99, v99
    v_rcp_f32 v100, v100
    v_rcp_f32 v101, v101
    v_mfma_f32_32x32x16_bf16 v[0:15], v[224:227], v[160:163], v[0:15]
    ds_read_b128 v[172:175], v179 offset:45056
    buffer_load_dwordx4 v[92:95], v188, s[40:43], s63 offen offset:3072 sc1
    v_mfma_f32_32x32x16_bf16 v[16:31], v[228:231], v[160:163], v[16:31]
    s_waitcnt lgkmcnt(2)
    v_rcp_f32 v102, v102
    v_rcp_f32 v103, v103
    v_mul_f32 v104, v96, v104
    v_mul_f32_e64 v105, v97, v105
    v_mfma_f32_32x32x16_bf16 v[0:15], v[232:235], v[164:167], v[0:15]
    s_add_u32 s63, s11, 4096
    buffer_load_dwordx4 a[124:127], v188, s[40:43], s63 offen offset:3072 sc1
    v_mul_f32 v106, v98, v106
    v_mul_f32 v107, v99, v107
    v_mul_f32_e64 v108, v100, v108
    v_mfma_f32_32x32x16_bf16 v[16:31], v[236:239], v[164:167], v[16:31]
    s_waitcnt lgkmcnt(1)
    v_mul_f32 v109, v101, v109
    v_mul_f32 v110, v102, v110
    v_mul_f32 v111, v103, v111
    v_cvt_pk_bf16_f32 v96, v104, v105
    v_cvt_pk_bf16_f32 v97, v106, v107
    v_cvt_pk_bf16_f32 v98, v108, v109
    v_mfma_f32_32x32x16_bf16 v[0:15], v[240:243], v[168:171], v[0:15]
    s_add_u32 s63, s11, 8192
    buffer_load_dwordx4 a[128:131], v188, s[40:43], s63 offen offset:0 sc1
    v_cvt_pk_bf16_f32 v99, v110, v111
    v_mfma_f32_32x32x16_bf16 v[16:31], v[244:247], v[168:171], v[16:31]
    s_waitcnt lgkmcnt(0)
    s_add_u32 s61, s16, 417792
    buffer_store_dwordx4 v[96:99], v184, s[32:35], s61 offen offset:0 sc1
    v_mul_f32 v120, v112, v120
    v_mul_f32_e64 v121, v113, v121
    v_mfma_f32_32x32x16_bf16 v[0:15], v[248:251], v[172:175], v[0:15]
    buffer_load_dwordx4 a[132:135], v188, s[40:43], s63 offen offset:1024 sc1
    v_mul_f32 v122, v114, v122
    v_mul_f32 v123, v115, v123
    v_mul_f32_e64 v124, v116, v124
    v_mfma_f32_32x32x16_bf16 v[16:31], v[252:255], v[172:175], v[16:31]
    s_waitcnt vmcnt(13)
    s_mov_b64 exec, 1
    v_mov_b32_e64 v187, s19
    ds_or_rtn_b32 v187, v180, v187 offset:4
    s_mov_b64 exec, -1
    s_waitcnt lgkmcnt(0)
    v_readfirstlane_b32 s84, v187
    v_mov_b32_e64 v187, 2
    s_or_b32 s84, s84, s19
    s_cmp_lg_u32 s84, 15
    s_cbranch_scc1 L_pb69
    buffer_store_dword v187, v189, s[68:71], s18 offen offset:128 sc1
    L_pb69:
    v_mul_f32 v125, v117, v125
    v_mul_f32 v126, v118, v126
    v_mul_f32 v127, v119, v127
    v_mul_f32 v112, s17, v112
    v_mul_f32 v113, s17, v113
    v_mul_f32 v114, s17, v114
    v_mul_f32 v115, s17, v115
    v_mul_f32 v116, s17, v116
    v_mul_f32 v117, s17, v117
    v_mul_f32 v118, s17, v118
    v_mul_f32 v119, s17, v119
    v_exp_f32 v112, v112
    v_exp_f32 v113, v113
    v_exp_f32 v114, v114
    v_exp_f32 v115, v115
    v_exp_f32 v116, v116
    v_exp_f32 v117, v117
    v_exp_f32 v118, v118
    v_exp_f32 v119, v119
    v_add_f32 v112, 1.0, v112
    v_add_f32 v113, 1.0, v113
    v_add_f32 v114, 1.0, v114
    v_add_f32 v115, 1.0, v115
    v_add_f32 v116, 1.0, v116
    v_add_f32 v117, 1.0, v117
    v_add_f32 v118, 1.0, v118
    v_add_f32 v119, 1.0, v119
    v_rcp_f32 v112, v112
    v_rcp_f32 v113, v113
    v_rcp_f32 v114, v114
    v_rcp_f32 v115, v115
    v_rcp_f32 v116, v116
    v_rcp_f32 v117, v117
    v_rcp_f32 v118, v118
    v_rcp_f32 v119, v119
    v_mul_f32 v120, v112, v120
    v_mul_f32 v121, v113, v121
    v_mul_f32 v122, v114, v122
    v_mul_f32 v123, v115, v123
    v_mul_f32 v124, v116, v124
    v_mul_f32 v125, v117, v125
    v_mul_f32 v126, v118, v126
    v_mul_f32_e64 v127, v119, v127
    v_cvt_pk_bf16_f32 v112, v120, v121
    v_cvt_pk_bf16_f32 v113, v122, v123
    v_cvt_pk_bf16_f32 v114, v124, v125
    v_cvt_pk_bf16_f32 v115, v126, v127
    s_add_u32 s61, s16, 417792
    buffer_store_dwordx4 v[112:115], v184, s[32:35], s61 offen offset:512 sc1
    v_mul_f32 v136, v128, v136
    v_mul_f32 v137, v129, v137
    v_mul_f32 v138, v130, v138
    v_mul_f32 v139, v131, v139
    v_mul_f32 v140, v132, v140
    v_mul_f32 v141, v133, v141
    v_mul_f32 v142, v134, v142
    v_mul_f32 v143, v135, v143
    v_mul_f32 v128, s17, v128
    v_mul_f32 v129, s17, v129
    v_mul_f32 v130, s17, v130
    v_mul_f32 v131, s17, v131
    v_mul_f32 v132, s17, v132
    v_mul_f32 v133, s17, v133
    v_mul_f32 v134, s17, v134
    v_mul_f32 v135, s17, v135
    v_exp_f32 v128, v128
    v_exp_f32 v129, v129
    v_exp_f32 v130, v130
    v_exp_f32 v131, v131
    v_exp_f32 v132, v132
    v_exp_f32 v133, v133
    v_exp_f32 v134, v134
    v_exp_f32 v135, v135
    v_add_f32 v128, 1.0, v128
    v_add_f32 v129, 1.0, v129
    v_add_f32 v130, 1.0, v130
    v_add_f32 v131, 1.0, v131
    v_add_f32 v132, 1.0, v132
    v_add_f32 v133, 1.0, v133
    v_add_f32 v134, 1.0, v134
    v_add_f32 v135, 1.0, v135
    v_rcp_f32 v128, v128
    v_rcp_f32 v129, v129
    v_rcp_f32 v130, v130
    v_rcp_f32 v131, v131
    v_rcp_f32 v132, v132
    v_rcp_f32 v133, v133
    v_rcp_f32 v134, v134
    v_rcp_f32 v135, v135
    v_mul_f32 v136, v128, v136
    v_mul_f32 v137, v129, v137
    v_mul_f32 v138, v130, v138
    v_mul_f32 v139, v131, v139
    v_mul_f32 v140, v132, v140
    v_mul_f32 v141, v133, v141
    v_mul_f32 v142, v134, v142
    v_mul_f32 v143, v135, v143
    v_cvt_pk_bf16_f32 v128, v136, v137
    v_cvt_pk_bf16_f32 v129, v138, v139
    v_cvt_pk_bf16_f32 v130, v140, v141
    v_cvt_pk_bf16_f32 v131, v142, v143
    s_add_u32 s61, s16, 557056
    buffer_store_dwordx4 v[128:131], v184, s[32:35], s61 offen offset:0 sc1
    v_mul_f32 v152, v144, v152
    v_mul_f32 v153, v145, v153
    v_mul_f32 v154, v146, v154
    v_mul_f32 v155, v147, v155
    v_mul_f32 v156, v148, v156
    v_mul_f32 v157, v149, v157
    v_mul_f32 v158, v150, v158
    v_mul_f32 v159, v151, v159
    v_mul_f32 v144, s17, v144
    v_mul_f32 v145, s17, v145
    v_mul_f32 v146, s17, v146
    v_mul_f32 v147, s17, v147
    v_mul_f32 v148, s17, v148
    v_mul_f32 v149, s17, v149
    v_mul_f32 v150, s17, v150
    v_mul_f32 v151, s17, v151
    v_exp_f32 v144, v144
    v_exp_f32 v145, v145
    v_exp_f32 v146, v146
    v_exp_f32 v147, v147
    v_exp_f32 v148, v148
    v_exp_f32 v149, v149
    v_exp_f32 v150, v150
    v_exp_f32 v151, v151
    v_add_f32 v144, 1.0, v144
    v_add_f32 v145, 1.0, v145
    v_add_f32 v146, 1.0, v146
    v_add_f32 v147, 1.0, v147
    v_add_f32 v148, 1.0, v148
    v_add_f32 v149, 1.0, v149
    v_add_f32 v150, 1.0, v150
    v_add_f32 v151, 1.0, v151
    v_rcp_f32 v144, v144
    v_rcp_f32 v145, v145
    v_rcp_f32 v146, v146
    v_rcp_f32 v147, v147
    v_rcp_f32 v148, v148
    v_rcp_f32 v149, v149
    v_rcp_f32 v150, v150
    v_rcp_f32 v151, v151
    v_mul_f32 v152, v144, v152
    v_mul_f32 v153, v145, v153
    v_mul_f32 v154, v146, v154
    v_mul_f32 v155, v147, v155
    v_mul_f32 v156, v148, v156
    v_mul_f32 v157, v149, v157
    v_mul_f32 v158, v150, v158
    v_mul_f32 v159, v151, v159
    v_cvt_pk_bf16_f32 v144, v152, v153
    v_cvt_pk_bf16_f32 v145, v154, v155
    v_cvt_pk_bf16_f32 v146, v156, v157
    v_cvt_pk_bf16_f32 v147, v158, v159
    s_add_u32 s61, s16, 557056
    buffer_store_dwordx4 v[144:147], v184, s[32:35], s61 offen offset:512 sc1
    s_lshl_b32 s59, s44, 10
    v_add_u32 v249, s59, v188
    v_add_u32 v250, 0x10000, v249
    v_add_u32 v251, 0x20000, v249
    s_nop 5
    v_mul_f32 v8, v0, v8
    v_mul_f32 v24, v16, v24
    v_mul_f32 v9, v1, v9
    v_mul_f32 v25, v17, v25
    v_mul_f32 v10, v2, v10
    v_mul_f32 v26, v18, v26
    v_mul_f32 v11, v3, v11
    v_mul_f32 v27, v19, v27
    v_mul_f32 v12, v4, v12
    v_mul_f32 v28, v20, v28
    v_mul_f32 v13, v5, v13
    v_mul_f32 v29, v21, v29
    v_mul_f32 v14, v6, v14
    v_mul_f32 v30, v22, v30
    v_mul_f32 v15, v7, v15
    v_mul_f32_e64 v31, v23, v31
    buffer_load_dword v191, v190, s[68:71], s45 offen sc1
    v_mul_f32 v0, s17, v0
    v_mul_f32 v16, s17, v16
    v_mul_f32 v1, s17, v1
    v_mul_f32 v17, s17, v17
    v_mul_f32 v2, s17, v2
    v_mul_f32 v18, s17, v18
    v_mul_f32 v3, s17, v3
    v_mul_f32 v19, s17, v19
    v_mul_f32 v4, s17, v4
    v_mul_f32 v20, s17, v20
    v_mul_f32 v5, s17, v5
    v_mul_f32 v21, s17, v21
    v_mul_f32 v6, s17, v6
    v_mul_f32 v22, s17, v22
    v_mul_f32 v7, s17, v7
    v_mul_f32 v23, s17, v23
    v_exp_f32_e64 v0, v0
    s_add_u32 s63, s10, 16384
    buffer_load_dwordx4 v[96:99], v188, s[40:43], s63 offen offset:0 sc1
    v_exp_f32 v16, v16
    v_exp_f32 v1, v1
    v_exp_f32 v17, v17
    v_exp_f32 v2, v2
    v_exp_f32 v18, v18
    v_exp_f32 v3, v3
    v_exp_f32 v19, v19
    v_exp_f32 v4, v4
    v_exp_f32_e64 v20, v20
    buffer_load_dwordx4 v[100:103], v188, s[40:43], s63 offen offset:1024 sc1
    v_exp_f32 v5, v5
    v_exp_f32 v21, v21
    v_exp_f32 v6, v6
    v_exp_f32 v22, v22
    v_exp_f32 v7, v7
    v_exp_f32 v23, v23
    v_add_f32 v0, 1.0, v0
    v_add_f32 v16, 1.0, v16
    v_add_f32 v1, 1.0, v1
    v_add_f32 v17, 1.0, v17
    v_add_f32 v2, 1.0, v2
    v_add_f32 v18, 1.0, v18
    buffer_load_dwordx4 v[104:107], v188, s[40:43], s63 offen offset:2048 sc1
    v_add_f32 v3, 1.0, v3
    v_add_f32 v19, 1.0, v19
    v_add_f32 v4, 1.0, v4
    v_add_f32 v20, 1.0, v20
    v_add_f32 v5, 1.0, v5
    v_add_f32 v21, 1.0, v21
    v_add_f32 v6, 1.0, v6
    v_add_f32 v22, 1.0, v22
    v_add_f32 v7, 1.0, v7
    v_add_f32 v23, 1.0, v23
    v_rcp_f32 v0, v0
    v_rcp_f32 v16, v16
    v_rcp_f32 v1, v1
    v_rcp_f32 v17, v17
    buffer_load_dwordx4 v[108:111], v188, s[40:43], s63 offen offset:3072 sc1
    v_rcp_f32 v2, v2
    s_waitcnt vmcnt(5)
    s_mov_b64 exec, 1
    v_mov_b32 v187, s19
    ds_or_rtn_b32 v187, v180, v187 offset:8
    s_mov_b64 exec, -1
    v_rcp_f32 v18, v18
    v_rcp_f32 v3, v3
    v_rcp_f32 v19, v19
    v_rcp_f32 v4, v4
    v_rcp_f32 v20, v20
    v_rcp_f32_e64 v5, v5
    s_add_u32 s63, s10, 20480
    buffer_load_dwordx4 v[112:115], v188, s[40:43], s63 offen offset:0 sc1
    v_rcp_f32 v21, v21
    v_rcp_f32 v6, v6
    v_rcp_f32 v22, v22
    v_rcp_f32 v7, v7
    v_rcp_f32 v23, v23
    v_mul_f32 v8, v0, v8
    v_mul_f32 v24, v16, v24
    v_mul_f32 v9, v1, v9
    v_mul_f32 v25, v17, v25
    v_mul_f32 v10, v2, v10
    v_mul_f32 v26, v18, v26
    v_mul_f32 v11, v3, v11
    v_mul_f32_e64 v27, v19, v27
    buffer_load_dwordx4 v[116:119], v188, s[40:43], s63 offen offset:1024 sc1
    v_mul_f32 v12, v4, v12
    s_waitcnt lgkmcnt(0)
    v_readfirstlane_b32 s84, v187
    v_mov_b32_e64 v187, 3
    s_or_b32 s84, s84, s19
    s_cmp_lg_u32 s84, 15
    s_cbranch_scc1 L_pb70
    buffer_store_dword v187, v189, s[68:71], s18 offen offset:256 sc1
    L_pb70:
    v_mul_f32 v28, v20, v28
    v_mul_f32 v13, v5, v13
    v_mul_f32 v29, v21, v29
    v_mul_f32 v14, v6, v14
    v_mul_f32 v30, v22, v30
    v_mul_f32 v15, v7, v15
    v_mul_f32_e64 v31, v23, v31
    v_cvt_pk_bf16_f32 v0, v8, v9
    v_cvt_pk_bf16_f32 v16, v24, v25
    v_cvt_pk_bf16_f32 v1, v10, v11
    v_cvt_pk_bf16_f32 v17, v26, v27
    v_cvt_pk_bf16_f32 v2, v12, v13
    v_cvt_pk_bf16_f32 v18, v28, v29
    v_cvt_pk_bf16_f32 v3, v14, v15
    v_cvt_pk_bf16_f32 v19, v30, v31
    s_add_u32 s61, s16, 696320
    buffer_store_dwordx4 v[0:3], v184, s[32:35], s61 offen offset:0 sc1
    s_add_u32 s61, s16, 696320
    buffer_store_dwordx4 v[16:19], v184, s[32:35], s61 offen offset:512 sc1
    s_add_u32 s55, s55, s56
    s_and_b32 s58, s55, 3
    s_add_u32 s58, s58, s57
    s_mul_i32 s59, s58, 43
    s_lshr_b32 s59, s59, 7
    s_bfe_u32 s60, s55, 0x20002
    s_mul_i32 s47, s59, 6144
    s_lshl_b32 s53, s60, 7
    s_add_u32 s47, s47, s53
    s_cmp_lt_u32 s58, 30
    s_cselect_b32 s53, 3, 2
    s_mul_i32 s60, s60, s53
    s_mul_i32 s6, s59, 9
    s_add_u32 s6, s6, s58
    s_add_u32 s6, s6, s60
    s_waitcnt vmcnt(8)
    v_cmp_le_u32 vcc, 1, v191
    s_nop 0
    s_andn2_b32 s84, 0x7, vcc_lo
    s_cbranch_scc1 L_retry71
L_ok71:
    s_mul_i32 s51, s4, 69632
    s_add_u32 s62, s51, s12
    buffer_load_dwordx4 a[32:35], v188, s[32:35], s62 offen offset:0 sc1
    buffer_load_dwordx4 a[36:39], v188, s[32:35], s62 offen offset:1024 sc1
    buffer_load_dwordx4 a[40:43], v188, s[32:35], s62 offen offset:2048 sc1
    v_mov_b32_e64 v191, 0
    s_nop 0
    buffer_load_dword v191, v190, s[68:71], s46 offen sc1
    buffer_load_dwordx4 a[44:47], v188, s[32:35], s62 offen offset:3072 sc1
    s_add_u32 s62, s62, 4096
    buffer_load_dwordx4 a[48:51], v188, s[32:35], s62 offen offset:0 sc1
    buffer_load_dwordx4 v[120:123], v188, s[40:43], s63 offen offset:2048 sc1
    buffer_load_dwordx4 v[124:127], v188, s[40:43], s63 offen offset:3072 sc1
    buffer_load_dwordx4 a[52:55], v188, s[32:35], s62 offen offset:1024 sc1
    buffer_load_dwordx4 a[56:59], v188, s[32:35], s62 offen offset:2048 sc1
    buffer_load_dwordx4 a[60:63], v188, s[32:35], s62 offen offset:3072 sc1
    s_add_u32 s62, s62, 4096
    buffer_load_dwordx4 a[64:67], v188, s[32:35], s62 offen offset:0 sc1
    buffer_load_dwordx4 a[68:71], v188, s[32:35], s62 offen offset:1024 sc1
    s_waitcnt vmcnt(12)
    v_mfma_f32_16x16x32_bf16 v[128:131], v[32:35], a[32:35], 0
    buffer_load_dwordx4 a[72:75], v188, s[32:35], s62 offen offset:2048 sc1
    s_mov_b64 exec, 1
    v_mov_b32_e64 v187, s19
    ds_or_rtn_b32 v187, v180, v187 offset:12
    s_mov_b64 exec, -1
    v_mfma_f32_16x16x32_bf16 v[132:135], v[36:39], a[32:35], 0
    s_add_u32 s55, s55, s56
    s_and_b32 s58, s55, 3
    s_add_u32 s58, s58, s57
    v_mfma_f32_16x16x32_bf16 v[136:139], v[40:43], a[32:35], 0
    s_mul_i32 s59, s58, 43
    s_lshr_b32 s59, s59, 7
    s_bfe_u32 s60, s55, 0x20002
    v_mfma_f32_16x16x32_bf16 v[140:143], v[44:47], a[32:35], 0
    s_mul_i32 s48, s59, 6144
    s_lshl_b32 s53, s60, 7
    s_add_u32 s48, s48, s53
    v_mfma_f32_16x16x32_bf16 v[144:147], v[48:51], a[32:35], 0
    s_waitcnt vmcnt(12)
    s_cmp_lt_u32 s58, 30
    s_cselect_b32 s53, 3, 2
    v_mfma_f32_16x16x32_bf16 v[128:131], v[52:55], a[36:39], v[128:131]
    buffer_load_dwordx4 a[76:79], v188, s[32:35], s62 offen offset:3072 sc1
    v_mfma_f32_16x16x32_bf16 v[132:135], v[56:59], a[36:39], v[132:135]
    v_cmp_le_u32 vcc, 1, v191
    s_mul_i32 s60, s60, s53
    s_mul_i32 s7, s59, 9
    s_waitcnt lgkmcnt(0)
    v_readfirstlane_b32 s84, v187
    v_mov_b32 v187, 4
    s_or_b32 s84, s84, s19
    s_cmp_lg_u32 s84, 15
    s_cbranch_scc1 L_pb72
    buffer_store_dword v187, v189, s[68:71], s18 offen offset:384 sc1
    L_pb72:
    v_mfma_f32_16x16x32_bf16 v[136:139], v[60:63], a[36:39], v[136:139]
    s_andn2_b32 s84, 0x7, vcc_lo
    s_cbranch_scc1 L_retry73
L_ok73:
    s_add_u32 s7, s7, s58
    v_mfma_f32_16x16x32_bf16 v[140:143], v[64:67], a[36:39], v[140:143]
    s_mul_i32 s51, s5, 69632
    s_add_u32 s7, s7, s60
    v_lshlrev_b32_e64 v248, 7, v185
    v_mfma_f32_16x16x32_bf16 v[144:147], v[68:71], a[36:39], v[144:147]
    s_waitcnt vmcnt(12)
    s_add_u32 s62, s51, s12
    s_mul_i32 s59, s4, 205
    v_mfma_f32_16x16x32_bf16 v[128:131], v[72:75], a[40:43], v[128:131]
    buffer_load_dwordx4 a[32:35], v188, s[32:35], s62 offen offset:0 sc1
    v_mfma_f32_16x16x32_bf16 v[132:135], v[76:79], a[40:43], v[132:135]
    ds_read_b128 a[148:151], v251 offset:16384
    s_lshr_b32 s59, s59, 11
    v_mfma_f32_16x16x32_bf16 v[136:139], v[80:83], a[40:43], v[136:139]
    ds_read_b128 a[152:155], v251 offset:20480
    s_lshl_b32 s59, s59, 10
    v_mfma_f32_16x16x32_bf16 v[140:143], v[84:87], a[40:43], v[140:143]
    ds_read_b128 a[156:159], v251 offset:24576
    s_lshl_b32 s60, s44, 8
    v_mfma_f32_16x16x32_bf16 v[144:147], v[88:91], a[40:43], v[144:147]
    s_waitcnt vmcnt(11)
    ds_read_b128 a[160:163], v249 offset:32768
    v_mfma_f32_16x16x32_bf16 v[128:131], v[92:95], a[44:47], v[128:131]
    buffer_load_dwordx4 a[36:39], v188, s[32:35], s62 offen offset:1024 sc1
    v_mfma_f32_16x16x32_bf16 v[132:135], v[96:99], a[44:47], v[132:135]
    ds_read_b128 a[164:167], v249 offset:36864
    s_add_u32 s59, s59, s60
    v_mfma_f32_16x16x32_bf16 v[136:139], v[100:103], a[44:47], v[136:139]
    ds_read_b128 a[168:171], v249 offset:40960
    s_add_u32 s59, s59, 67584
    v_mfma_f32_16x16x32_bf16 v[140:143], v[104:107], a[44:47], v[140:143]
    ds_read_b128 a[172:175], v249 offset:45056
    v_add_u32 v21, s59, v248
    v_mfma_f32_16x16x32_bf16 v[144:147], v[108:111], a[44:47], v[144:147]
    s_waitcnt vmcnt(11)
    ds_read_b128 a[176:179], v249 offset:49152
    v_mfma_f32_16x16x32_bf16 v[128:131], v[112:115], a[48:51], v[128:131]
    buffer_load_dwordx4 a[40:43], v188, s[32:35], s62 offen offset:2048 sc1
    v_mfma_f32_16x16x32_bf16 v[132:135], v[116:119], a[48:51], v[132:135]
    s_waitcnt vmcnt(11)
    v_mov_b32_e64 v191, 0
    ds_read_b128 a[180:183], v249 offset:53248
    v_mfma_f32_16x16x32_bf16 v[136:139], v[120:123], a[48:51], v[136:139]
    s_waitcnt vmcnt(10)
    buffer_load_dword v191, v190, s[68:71], s47 offen sc1
    v_mfma_f32_16x16x32_bf16 v[140:143], v[124:127], a[48:51], v[140:143]
    buffer_load_dwordx4 a[44:47], v188, s[32:35], s62 offen offset:3072 sc1
    v_mfma_f32_16x16x32_bf16 v[144:147], a[0:3], a[48:51], v[144:147]
    s_waitcnt vmcnt(11)
    s_add_u32 s62, s62, 4096
    s_mul_i32 s59, s5, 205
    v_mfma_f32_16x16x32_bf16 v[128:131], a[4:7], a[52:55], v[128:131]
    buffer_load_dwordx4 a[48:51], v188, s[32:35], s62 offen offset:0 sc1
    v_mfma_f32_16x16x32_bf16 v[132:135], a[8:11], a[52:55], v[132:135]
    s_add_u32 s63, s11, 8192
    buffer_load_dwordx4 a[136:139], v188, s[40:43], s63 offen offset:2048 sc1
    v_mfma_f32_16x16x32_bf16 v[136:139], a[12:15], a[52:55], v[136:139]
    ds_read_b128 a[184:187], v249 offset:57344
    s_lshr_b32 s59, s59, 11
    v_mfma_f32_16x16x32_bf16 v[140:143], a[16:19], a[52:55], v[140:143]
    ds_read_b128 a[188:191], v249 offset:61440
    s_lshl_b32 s59, s59, 10
    v_mfma_f32_16x16x32_bf16 v[144:147], a[20:23], a[52:55], v[144:147]
    s_waitcnt vmcnt(12)
    ds_read_b128 a[192:195], v250 offset:0
    v_mfma_f32_16x16x32_bf16 v[128:131], a[24:27], a[56:59], v[128:131]
    buffer_load_dwordx4 a[52:55], v188, s[32:35], s62 offen offset:1024 sc1
    v_mfma_f32_16x16x32_bf16 v[132:135], a[28:31], a[56:59], v[132:135]
    ds_read_b128 a[196:199], v250 offset:4096
    s_lshl_b32 s60, s44, 8
    v_mfma_f32_16x16x32_bf16 v[136:139], a[144:147], a[56:59], v[136:139]
    s_waitcnt lgkmcnt(12)
    ds_read_b128 a[200:203], v250 offset:8192
    s_add_u32 s59, s59, s60
    v_mfma_f32_16x16x32_bf16 v[140:143], a[148:151], a[56:59], v[140:143]
    s_waitcnt lgkmcnt(12)
    ds_read_b128 a[204:207], v250 offset:12288
    s_add_u32 s59, s59, 67328
    v_mfma_f32_16x16x32_bf16 v[144:147], a[152:155], a[56:59], v[144:147]
    s_waitcnt vmcnt(12) lgkmcnt(12)
    ds_read_b128 a[208:211], v250 offset:16384
    v_mfma_f32_16x16x32_bf16 v[128:131], a[156:159], a[60:63], v[128:131]
    s_waitcnt lgkmcnt(12)
    buffer_load_dwordx4 a[140:143], v188, s[40:43], s63 offen offset:3072 sc1
    v_mfma_f32_16x16x32_bf16 v[132:135], a[160:163], a[60:63], v[132:135]
    s_waitcnt lgkmcnt(11)
    ds_read_b128 a[212:215], v250 offset:20480
    v_cmp_le_u32 s[8:9], 2, v185
    v_mfma_f32_16x16x32_bf16 v[136:139], a[164:167], a[60:63], v[136:139]
    s_waitcnt lgkmcnt(11)
    ds_read_b128 a[216:219], v250 offset:24576
    v_add_u32 v22, s59, v248
    v_mfma_f32_16x16x32_bf16 v[140:143], a[168:171], a[60:63], v[140:143]
    s_waitcnt lgkmcnt(11)
    ds_read_b128 a[220:223], v250 offset:28672
    s_nop 0
    v_mfma_f32_16x16x32_bf16 v[144:147], a[172:175], a[60:63], v[144:147]
    s_waitcnt vmcnt(12) lgkmcnt(11)
    ds_read_b128 a[224:227], v249 offset:0
    v_mfma_f32_16x16x32_bf16 v[128:131], a[176:179], a[64:67], v[128:131]
    s_waitcnt lgkmcnt(11)
    buffer_load_dwordx4 a[56:59], v188, s[32:35], s62 offen offset:2048 sc1
    v_mfma_f32_16x16x32_bf16 v[132:135], a[180:183], a[64:67], v[132:135]
    s_waitcnt lgkmcnt(10)
    ds_read_b128 a[228:231], v249 offset:4096
    v_cndmask_b32 v21, v21, v22, s[8:9]
    v_mfma_f32_16x16x32_bf16 v[136:139], a[184:187], a[64:67], v[136:139]
    s_waitcnt lgkmcnt(10)
    ds_read_b128 a[232:235], v249 offset:8192
    s_mul_i32 s59, s6, 205
    v_mfma_f32_16x16x32_bf16 v[140:143], a[188:191], a[64:67], v[140:143]
    s_waitcnt lgkmcnt(10)
    ds_read_b128 a[236:239], v249 offset:12288
    s_lshr_b32 s59, s59, 11
    v_mfma_f32_16x16x32_bf16 v[144:147], a[192:195], a[64:67], v[144:147]
    s_waitcnt vmcnt(12) lgkmcnt(10)
    ds_read_b128 a[240:243], v249 offset:16384
    v_mfma_f32_16x16x32_bf16 v[128:131], a[196:199], a[68:71], v[128:131]
    s_waitcnt lgkmcnt(10)
    buffer_load_dwordx4 a[60:63], v188, s[32:35], s62 offen offset:3072 sc1
    v_mfma_f32_16x16x32_bf16 v[132:135], a[200:203], a[68:71], v[132:135]
    s_waitcnt lgkmcnt(9)
    ds_read_b128 a[244:247], v249 offset:20480
    s_lshl_b32 s59, s59, 10
    v_mfma_f32_16x16x32_bf16 v[136:139], a[204:207], a[68:71], v[136:139]
    s_waitcnt lgkmcnt(9)
    ds_read_b128 a[248:251], v249 offset:24576
    s_lshl_b32 s60, s44, 8
    v_mfma_f32_16x16x32_bf16 v[140:143], a[208:211], a[68:71], v[140:143]
    s_waitcnt lgkmcnt(9)
    ds_read_b128 a[252:255], v249 offset:28672
    s_add_u32 s59, s59, s60
    v_mfma_f32_16x16x32_bf16 v[144:147], a[212:215], a[68:71], v[144:147]
    s_waitcnt vmcnt(12) lgkmcnt(9)
    s_add_u32 s59, s59, 67072
    v_cmp_le_u32 s[8:9], 4, v185
    v_mfma_f32_16x16x32_bf16 v[128:131], a[216:219], a[72:75], v[128:131]
    s_waitcnt lgkmcnt(8)
    s_add_u32 s63, s11, 16384
    buffer_load_dwordx4 v[192:195], v188, s[40:43], s63 offen offset:0 sc1
    v_mfma_f32_16x16x32_bf16 v[132:135], a[220:223], a[72:75], v[132:135]
    s_waitcnt lgkmcnt(7)
    v_add_u32_e64 v22, s59, v248
    s_nop 0
    v_cndmask_b32 v21, v21, v22, s[8:9]
    v_mfma_f32_16x16x32_bf16 v[136:139], a[224:227], a[72:75], v[136:139]
    s_waitcnt lgkmcnt(6)
    s_mul_i32 s59, s7, 205
    s_lshr_b32 s59, s59, 11
    s_lshl_b32 s59, s59, 10
    v_mfma_f32_16x16x32_bf16 v[140:143], a[228:231], a[72:75], v[140:143]
    s_waitcnt lgkmcnt(5)
    s_lshl_b32 s60, s44, 8
    s_add_u32 s59, s59, s60
    s_add_u32 s59, s59, 66816
    v_mfma_f32_16x16x32_bf16 v[144:147], a[232:235], a[72:75], v[144:147]
    s_waitcnt vmcnt(12) lgkmcnt(4)
    s_add_u32 s62, s62, 4096
    v_cmp_le_u32 s[8:9], 6, v185
    v_mfma_f32_16x16x32_bf16 v[128:131], a[236:239], a[76:79], v[128:131]
    s_waitcnt lgkmcnt(3)
    buffer_load_dwordx4 a[64:67], v188, s[32:35], s62 offen offset:0 sc1
    v_mfma_f32_16x16x32_bf16 v[132:135], a[240:243], a[76:79], v[132:135]
    s_waitcnt lgkmcnt(2)
    v_add_u32_e64 v22, s59, v248
    s_nop 0
    v_cndmask_b32 v21, v21, v22, s[8:9]
    v_mfma_f32_16x16x32_bf16 v[136:139], a[244:247], a[76:79], v[136:139]
    s_waitcnt lgkmcnt(1)
    v_cmp_le_u32 s[8:9], 8, v185
    v_mov_b32_e64 v22, 0x40000000
    s_nop 0
    v_mfma_f32_16x16x32_bf16 v[140:143], a[248:251], a[76:79], v[140:143]
    s_waitcnt lgkmcnt(0)
    v_cndmask_b32 v21, v21, v22, s[8:9]
    v_mov_b32_e64 v22, 0
    s_lshl_b32 s13, s44, 12
    v_mfma_f32_16x16x32_bf16 v[144:147], a[252:255], a[76:79], v[144:147]
    s_waitcnt vmcnt(12)
    s_lshl_b32 s14, s44, 10
    s_add_u32 s14, s14, 16384
    v_mfma_f32_16x16x32_bf16 v[148:151], v[32:35], a[32:35], 0
    buffer_load_dwordx4 v[196:199], v188, s[40:43], s63 offen offset:1024 sc1
    v_mfma_f32_16x16x32_bf16 v[152:155], v[36:39], a[32:35], 0
    v_lshrrev_b32 v248, 4, v185
    v_lshlrev_b32 v248, 8, v248
    v_mfma_f32_16x16x32_bf16 v[156:159], v[40:43], a[32:35], 0
    v_and_b32_e64 v20, 15, v185
    v_lshl_add_u32 v20, v20, 3, v248
    v_mfma_f32_16x16x32_bf16 v[160:163], v[44:47], a[32:35], 0
    v_and_b32 v24, 15, v185
    v_lshlrev_b32_e64 v24, 2, v24
    s_lshl_b32 s59, s44, 13
    v_mfma_f32_16x16x32_bf16 v[164:167], v[48:51], a[32:35], 0
    s_waitcnt vmcnt(12)
    v_add_u32 v24, s59, v24
    s_mul_i32 s59, s44, 5376
    v_mfma_f32_16x16x32_bf16 v[148:151], v[52:55], a[36:39], v[148:151]
    buffer_load_dwordx4 v[200:203], v188, s[40:43], s63 offen offset:2048 sc1
    v_mfma_f32_16x16x32_bf16 v[152:155], v[56:59], a[36:39], v[152:155]
    s_add_u32 s59, s59, 98304
    v_bfe_u32 v248, v185, 4, 1
    v_mul_u32_u24 v248, 2624, v248
    v_mfma_f32_16x16x32_bf16 v[156:159], v[60:63], a[36:39], v[156:159]
    v_and_b32_e64 v28, 15, v185
    v_mul_u32_u24 v28, 160, v28
    v_mfma_f32_16x16x32_bf16 v[160:163], v[64:67], a[36:39], v[160:163]
    v_add3_u32 v28, v248, v28, s59
    v_lshrrev_b32_e64 v248, 5, v185
    v_mfma_f32_16x16x32_bf16 v[164:167], v[68:71], a[36:39], v[164:167]
    s_waitcnt vmcnt(12)
    v_lshl_add_u32 v28, v248, 4, v28
    v_add_u32 v29, 0xfffe8000, v28
    v_mfma_f32_16x16x32_bf16 v[148:151], v[72:75], a[40:43], v[148:151]
    buffer_load_dwordx4 a[68:71], v188, s[32:35], s62 offen offset:1024 sc1
    v_mfma_f32_16x16x32_bf16 v[152:155], v[76:79], a[40:43], v[152:155]
    v_mul_u32_u24 v248, 205, v185
    v_lshrrev_b32 v248, 11, v248
    v_mfma_f32_16x16x32_bf16 v[156:159], v[80:83], a[40:43], v[156:159]
    v_mul_u32_u24 v23, 10, v248
    v_sub_u32_e64 v23, v185, v23
    s_lshl_b32 s59, s44, 2
    v_mfma_f32_16x16x32_bf16 v[160:163], v[84:87], a[40:43], v[160:163]
    v_add_u32 v248, s59, v248
    v_and_b32 v248, 15, v248
    s_mul_i32 s59, s44, 640
    v_mfma_f32_16x16x32_bf16 v[164:167], v[88:91], a[40:43], v[164:167]
    s_waitcnt vmcnt(11)
    s_add_u32 s59, s59, 98304
    v_add_u32 v30, s59, v188
    v_mfma_f32_16x16x32_bf16 v[148:151], v[92:95], a[44:47], v[148:151]
    buffer_load_dwordx4 v[204:207], v188, s[40:43], s63 offen offset:3072 sc1
    v_mfma_f32_16x16x32_bf16 v[152:155], v[96:99], a[44:47], v[152:155]
    v_add_u32 v31, 0xfffe8000, v30
    v_lshlrev_b32_e64 v23, 4, v23
    v_mfma_f32_16x16x32_bf16 v[156:159], v[100:103], a[44:47], v[156:159]
    v_mul_u32_u24 v248, 1280, v248
    v_add_u32_e64 v23, v23, v248
    v_mfma_f32_16x16x32_bf16 v[160:163], v[104:107], a[44:47], v[160:163]
    v_cmp_gt_u32 s[8:9], 40, v185
    v_mov_b32_e64 v248, 0x40000000
    s_mul_i32 s15, s54, 160
    v_mfma_f32_16x16x32_bf16 v[164:167], v[108:111], a[44:47], v[164:167]
    s_waitcnt vmcnt(11)
    v_cndmask_b32 v23, v248, v23, s[8:9]
    v_mfma_f32_16x16x32_bf16 v[148:151], v[112:115], a[48:51], v[148:151]
    s_add_u32 s63, s3, 0
    buffer_load_dwordx4 v[208:211], v188, s[40:43], s63 offen offset:0 sc1
    v_mfma_f32_16x16x32_bf16 v[152:155], v[116:119], a[48:51], v[152:155]
    v_mfma_f32_16x16x32_bf16 v[156:159], v[120:123], a[48:51], v[156:159]
    v_mfma_f32_16x16x32_bf16 v[160:163], v[124:127], a[48:51], v[160:163]
    v_mfma_f32_16x16x32_bf16 v[164:167], a[0:3], a[48:51], v[164:167]
    s_waitcnt vmcnt(10)
    v_mfma_f32_16x16x32_bf16 v[148:151], a[4:7], a[52:55], v[148:151]
    buffer_load_dwordx4 a[72:75], v188, s[32:35], s62 offen offset:2048 sc1
    v_mfma_f32_16x16x32_bf16 v[152:155], a[8:11], a[52:55], v[152:155]
    buffer_load_dwordx4 v[212:215], v188, s[40:43], s63 offen offset:1024 sc1
    v_mfma_f32_16x16x32_bf16 v[156:159], a[12:15], a[52:55], v[156:159]
    buffer_load_dwordx4 v[216:219], v188, s[40:43], s63 offen offset:2048 sc1
    v_mfma_f32_16x16x32_bf16 v[160:163], a[16:19], a[52:55], v[160:163]
    v_mfma_f32_16x16x32_bf16 v[164:167], a[20:23], a[52:55], v[164:167]
    s_waitcnt vmcnt(11)
    v_mfma_f32_16x16x32_bf16 v[148:151], a[24:27], a[56:59], v[148:151]
    buffer_load_dwordx4 a[76:79], v188, s[32:35], s62 offen offset:3072 sc1
    v_mfma_f32_16x16x32_bf16 v[152:155], a[28:31], a[56:59], v[152:155]
    v_mfma_f32_16x16x32_bf16 v[156:159], a[144:147], a[56:59], v[156:159]
    v_mfma_f32_16x16x32_bf16 v[160:163], a[148:151], a[56:59], v[160:163]
    v_mfma_f32_16x16x32_bf16 v[164:167], a[152:155], a[56:59], v[164:167]
    s_waitcnt vmcnt(11)
    v_mfma_f32_16x16x32_bf16 v[148:151], a[156:159], a[60:63], v[148:151]
    buffer_load_dwordx4 v[220:223], v188, s[40:43], s63 offen offset:3072 sc1
    v_mfma_f32_16x16x32_bf16 v[152:155], a[160:163], a[60:63], v[152:155]
    v_mfma_f32_16x16x32_bf16 v[156:159], a[164:167], a[60:63], v[156:159]
    v_mfma_f32_16x16x32_bf16 v[160:163], a[168:171], a[60:63], v[160:163]
    s_add_u32 s63, s3, 4096
    buffer_load_dwordx4 v[224:227], v188, s[40:43], s63 offen offset:0 sc1
    v_mfma_f32_16x16x32_bf16 v[164:167], a[172:175], a[60:63], v[164:167]
    s_waitcnt vmcnt(11)
    v_cmp_le_u32_e64 vcc, 1, v191
    v_mfma_f32_16x16x32_bf16 v[148:151], a[176:179], a[64:67], v[148:151]
    s_andn2_b32 s84, 0x7, vcc_lo
    s_cbranch_scc1 L_retry74
L_ok74:
    s_barrier
    v_mfma_f32_16x16x32_bf16 v[152:155], a[180:183], a[64:67], v[152:155]
    s_mul_i32 s51, s6, 69632
    v_mfma_f32_16x16x32_bf16 v[156:159], a[184:187], a[64:67], v[156:159]
    s_add_u32 s62, s51, s12
    v_mfma_f32_16x16x32_bf16 v[160:163], a[188:191], a[64:67], v[160:163]
    buffer_load_dwordx4 a[32:35], v188, s[32:35], s62 offen offset:0 sc1
    v_mfma_f32_16x16x32_bf16 v[164:167], a[192:195], a[64:67], v[164:167]
    s_waitcnt vmcnt(9)
    v_mfma_f32_16x16x32_bf16 v[148:151], a[196:199], a[68:71], v[148:151]
    buffer_load_dwordx4 a[36:39], v188, s[32:35], s62 offen offset:1024 sc1
    v_mfma_f32_16x16x32_bf16 v[152:155], a[200:203], a[68:71], v[152:155]
    buffer_load_dwordx4 a[40:43], v188, s[32:35], s62 offen offset:2048 sc1
    v_mfma_f32_16x16x32_bf16 v[156:159], a[204:207], a[68:71], v[156:159]
    v_mov_b32 v191, 0
    v_mfma_f32_16x16x32_bf16 v[160:163], a[208:211], a[68:71], v[160:163]
    buffer_load_dword v191, v190, s[68:71], s48 offen sc1
    v_mfma_f32_16x16x32_bf16 v[164:167], a[212:215], a[68:71], v[164:167]
    s_waitcnt vmcnt(9)
    v_mfma_f32_16x16x32_bf16 v[148:151], a[216:219], a[72:75], v[148:151]
    buffer_load_dwordx4 a[44:47], v188, s[32:35], s62 offen offset:3072 sc1
    v_mfma_f32_16x16x32_bf16 v[152:155], a[220:223], a[72:75], v[152:155]
    s_add_u32 s62, s62, 4096
    v_mfma_f32_16x16x32_bf16 v[156:159], a[224:227], a[72:75], v[156:159]
    buffer_load_dwordx4 a[48:51], v188, s[32:35], s62 offen offset:0 sc1
    v_mfma_f32_16x16x32_bf16 v[160:163], a[228:231], a[72:75], v[160:163]
    buffer_load_dwordx4 a[52:55], v188, s[32:35], s62 offen offset:1024 sc1
    v_mfma_f32_16x16x32_bf16 v[164:167], a[232:235], a[72:75], v[164:167]
    s_waitcnt vmcnt(9)
    v_mfma_f32_16x16x32_bf16 v[148:151], a[236:239], a[76:79], v[148:151]
    buffer_load_dwordx4 a[56:59], v188, s[32:35], s62 offen offset:2048 sc1
    v_mfma_f32_16x16x32_bf16 v[152:155], a[240:243], a[76:79], v[152:155]
    buffer_load_dwordx4 a[60:63], v188, s[32:35], s62 offen offset:3072 sc1
    v_mfma_f32_16x16x32_bf16 v[156:159], a[244:247], a[76:79], v[156:159]
    s_add_u32 s62, s62, 4096
    v_mfma_f32_16x16x32_bf16 v[160:163], a[248:251], a[76:79], v[160:163]
    buffer_load_dwordx4 a[64:67], v188, s[32:35], s62 offen offset:0 sc1
    v_mfma_f32_16x16x32_bf16 v[164:167], a[252:255], a[76:79], v[164:167]
    s_waitcnt vmcnt(9)
    v_mfma_f32_16x16x32_bf16 v[228:231], v[32:35], a[32:35], 0
    buffer_load_dwordx4 a[68:71], v188, s[32:35], s62 offen offset:1024 sc1
    v_mfma_f32_16x16x32_bf16 v[232:235], v[36:39], a[32:35], 0
    buffer_load_dwordx4 a[72:75], v188, s[32:35], s62 offen offset:2048 sc1
    v_mfma_f32_16x16x32_bf16 v[236:239], v[40:43], a[32:35], 0
    buffer_load_dwordx4 a[76:79], v188, s[32:35], s62 offen offset:3072 sc1
    v_mfma_f32_16x16x32_bf16 v[240:243], v[44:47], a[32:35], 0
    v_cmp_le_u32 vcc, 1, v191
    v_mfma_f32_16x16x32_bf16 v[244:247], v[48:51], a[32:35], 0
    s_waitcnt vmcnt(11)
    s_andn2_b32 s84, 0x7, vcc_lo
    s_cbranch_scc1 L_retry75
L_ok75:
    v_mfma_f32_16x16x32_bf16 v[228:231], v[52:55], a[36:39], v[228:231]
    s_mul_i32 s51, s7, 69632
    v_mfma_f32_16x16x32_bf16 v[232:235], v[56:59], a[36:39], v[232:235]
    s_add_u32 s62, s51, s12
    v_mfma_f32_16x16x32_bf16 v[236:239], v[60:63], a[36:39], v[236:239]
    buffer_load_dwordx4 a[32:35], v188, s[32:35], s62 offen offset:0 sc1
    v_mfma_f32_16x16x32_bf16 v[240:243], v[64:67], a[36:39], v[240:243]
    v_mfma_f32_16x16x32_bf16 v[244:247], v[68:71], a[36:39], v[244:247]
    s_waitcnt vmcnt(11)
    v_mfma_f32_16x16x32_bf16 v[228:231], v[72:75], a[40:43], v[228:231]
    buffer_load_dwordx4 a[36:39], v188, s[32:35], s62 offen offset:1024 sc1
    v_mfma_f32_16x16x32_bf16 v[232:235], v[76:79], a[40:43], v[232:235]
    v_mfma_f32_16x16x32_bf16 v[236:239], v[80:83], a[40:43], v[236:239]
    v_mfma_f32_16x16x32_bf16 v[240:243], v[84:87], a[40:43], v[240:243]
    v_mfma_f32_16x16x32_bf16 v[244:247], v[88:91], a[40:43], v[244:247]
    s_waitcnt vmcnt(10)
    v_mfma_f32_16x16x32_bf16 v[228:231], v[92:95], a[44:47], v[228:231]
    buffer_load_dwordx4 a[40:43], v188, s[32:35], s62 offen offset:2048 sc1
    v_mfma_f32_16x16x32_bf16 v[232:235], v[96:99], a[44:47], v[232:235]
    v_mfma_f32_16x16x32_bf16 v[236:239], v[100:103], a[44:47], v[236:239]
    v_mfma_f32_16x16x32_bf16 v[240:243], v[104:107], a[44:47], v[240:243]
    v_cmp_le_u32 s[22:23], 1, v22
    v_mfma_f32_16x16x32_bf16 v[244:247], v[108:111], a[44:47], v[244:247]
    s_waitcnt vmcnt(10)
    s_andn2_b32 s84, 0xff, s22
    s_cbranch_scc1 L_ps76
L_pr76:
    v_mfma_f32_16x16x32_bf16 v[228:231], v[112:115], a[48:51], v[228:231]
    buffer_load_dwordx4 a[44:47], v188, s[32:35], s62 offen offset:3072 sc1
    v_mfma_f32_16x16x32_bf16 v[232:235], v[116:119], a[48:51], v[232:235]
    v_mfma_f32_16x16x32_bf16 v[236:239], v[120:123], a[48:51], v[236:239]
    v_mfma_f32_16x16x32_bf16 v[240:243], v[124:127], a[48:51], v[240:243]
    v_mfma_f32_16x16x32_bf16 v[244:247], a[0:3], a[48:51], v[244:247]
    s_waitcnt vmcnt(10)
    s_add_u32 s62, s62, 4096
    v_mfma_f32_16x16x32_bf16 v[228:231], a[4:7], a[52:55], v[228:231]
    buffer_load_dwordx4 a[48:51], v188, s[32:35], s62 offen offset:0 sc1
    v_mfma_f32_16x16x32_bf16 v[232:235], a[8:11], a[52:55], v[232:235]
    v_mfma_f32_16x16x32_bf16 v[236:239], a[12:15], a[52:55], v[236:239]
    v_mfma_f32_16x16x32_bf16 v[240:243], a[16:19], a[52:55], v[240:243]
    v_mfma_f32_16x16x32_bf16 v[244:247], a[20:23], a[52:55], v[244:247]
    s_waitcnt vmcnt(10)
    v_mfma_f32_16x16x32_bf16 v[228:231], a[24:27], a[56:59], v[228:231]
    buffer_load_dwordx4 a[52:55], v188, s[32:35], s62 offen offset:1024 sc1
    v_mfma_f32_16x16x32_bf16 v[232:235], a[28:31], a[56:59], v[232:235]
    v_mfma_f32_16x16x32_bf16 v[236:239], a[144:147], a[56:59], v[236:239]
    v_mfma_f32_16x16x32_bf16 v[240:243], a[148:151], a[56:59], v[240:243]
    v_mfma_f32_16x16x32_bf16 v[244:247], a[152:155], a[56:59], v[244:247]
    s_waitcnt vmcnt(10)
    v_mfma_f32_16x16x32_bf16 v[228:231], a[156:159], a[60:63], v[228:231]
    buffer_load_dwordx4 a[56:59], v188, s[32:35], s62 offen offset:2048 sc1
    v_mfma_f32_16x16x32_bf16 v[232:235], a[160:163], a[60:63], v[232:235]
    v_mfma_f32_16x16x32_bf16 v[236:239], a[164:167], a[60:63], v[236:239]
    v_mfma_f32_16x16x32_bf16 v[240:243], a[168:171], a[60:63], v[240:243]
    v_mfma_f32_16x16x32_bf16 v[244:247], a[172:175], a[60:63], v[244:247]
    s_waitcnt vmcnt(10)
    v_mfma_f32_16x16x32_bf16 v[228:231], a[176:179], a[64:67], v[228:231]
    buffer_load_dwordx4 a[60:63], v188, s[32:35], s62 offen offset:3072 sc1
    v_mfma_f32_16x16x32_bf16 v[232:235], a[180:183], a[64:67], v[232:235]
    v_mfma_f32_16x16x32_bf16 v[236:239], a[184:187], a[64:67], v[236:239]
    v_mfma_f32_16x16x32_bf16 v[240:243], a[188:191], a[64:67], v[240:243]
    v_mfma_f32_16x16x32_bf16 v[244:247], a[192:195], a[64:67], v[244:247]
    s_waitcnt vmcnt(10)
    s_add_u32 s62, s62, 4096
    v_mfma_f32_16x16x32_bf16 v[228:231], a[196:199], a[68:71], v[228:231]
    buffer_load_dwordx4 a[64:67], v188, s[32:35], s62 offen offset:0 sc1
    v_mfma_f32_16x16x32_bf16 v[232:235], a[200:203], a[68:71], v[232:235]
    v_mfma_f32_16x16x32_bf16 v[236:239], a[204:207], a[68:71], v[236:239]
    v_mfma_f32_16x16x32_bf16 v[240:243], a[208:211], a[68:71], v[240:243]
    v_mfma_f32_16x16x32_bf16 v[244:247], a[212:215], a[68:71], v[244:247]
    s_waitcnt vmcnt(10)
    v_mfma_f32_16x16x32_bf16 v[228:231], a[216:219], a[72:75], v[228:231]
    buffer_load_dwordx4 a[68:71], v188, s[32:35], s62 offen offset:1024 sc1
    v_mfma_f32_16x16x32_bf16 v[232:235], a[220:223], a[72:75], v[232:235]
    v_mfma_f32_16x16x32_bf16 v[236:239], a[224:227], a[72:75], v[236:239]
    v_mfma_f32_16x16x32_bf16 v[240:243], a[228:231], a[72:75], v[240:243]
    v_mfma_f32_16x16x32_bf16 v[244:247], a[232:235], a[72:75], v[244:247]
    s_waitcnt vmcnt(10)
    v_mfma_f32_16x16x32_bf16 v[228:231], a[236:239], a[76:79], v[228:231]
    buffer_load_dwordx4 a[72:75], v188, s[32:35], s62 offen offset:2048 sc1
    v_mfma_f32_16x16x32_bf16 v[232:235], a[240:243], a[76:79], v[232:235]
    v_mfma_f32_16x16x32_bf16 v[236:239], a[244:247], a[76:79], v[236:239]
    v_mfma_f32_16x16x32_bf16 v[240:243], a[248:251], a[76:79], v[240:243]
    v_mfma_f32_16x16x32_bf16 v[244:247], a[252:255], a[76:79], v[244:247]
    s_waitcnt vmcnt(10)
    v_mfma_f32_16x16x32_bf16 v[0:3], v[32:35], a[32:35], 0
    buffer_load_dwordx4 a[76:79], v188, s[32:35], s62 offen offset:3072 sc1
    v_mfma_f32_16x16x32_bf16 v[4:7], v[36:39], a[32:35], 0
    v_cmp_le_u32_e64 vcc, 1, v22
    v_mfma_f32_16x16x32_bf16 v[8:11], v[40:43], a[32:35], 0
    s_andn2_b32 s84, 0x3, vcc_lo
    s_cbranch_scc1 L_retry77
L_ok77:
    v_mfma_f32_16x16x32_bf16 v[12:15], v[44:47], a[32:35], 0
    s_mul_i32 s51, s4, 69632
    v_mfma_f32_16x16x32_bf16 v[16:19], v[48:51], a[32:35], 0
    s_waitcnt vmcnt(10)
    v_cmp_le_u32 s[22:23], 1, v22
    v_mfma_f32_16x16x32_bf16 v[0:3], v[52:55], a[36:39], v[0:3]
    s_andn2_b32 s84, 0xff, s22
    s_cbranch_scc1 L_ps78
L_pr78:
    v_mfma_f32_16x16x32_bf16 v[4:7], v[56:59], a[36:39], v[4:7]
    s_lshl_b32 s62, s4, 6
    v_mfma_f32_16x16x32_bf16 v[8:11], v[60:63], a[36:39], v[8:11]
    buffer_load_dword v25, v24, s[64:67], s62 offen sc1
    v_mfma_f32_16x16x32_bf16 v[12:15], v[64:67], a[36:39], v[12:15]
    s_add_u32 s62, s51, s13
    v_mfma_f32_16x16x32_bf16 v[16:19], v[68:71], a[36:39], v[16:19]
    s_waitcnt vmcnt(10)
    v_mfma_f32_16x16x32_bf16 v[0:3], v[72:75], a[40:43], v[0:3]
    buffer_load_dwordx4 a[32:35], v188, s[32:35], s62 offen offset:0 sc1
    v_mfma_f32_16x16x32_bf16 v[4:7], v[76:79], a[40:43], v[4:7]
    buffer_load_dwordx4 a[36:39], v188, s[32:35], s62 offen offset:1024 sc1
    v_mfma_f32_16x16x32_bf16 v[8:11], v[80:83], a[40:43], v[8:11]
    v_mfma_f32_16x16x32_bf16 v[12:15], v[84:87], a[40:43], v[12:15]
    v_mfma_f32_16x16x32_bf16 v[16:19], v[88:91], a[40:43], v[16:19]
    s_waitcnt vmcnt(11)
    v_mfma_f32_16x16x32_bf16 v[0:3], v[92:95], a[44:47], v[0:3]
    buffer_load_dwordx4 a[40:43], v188, s[32:35], s62 offen offset:2048 sc1
    v_mfma_f32_16x16x32_bf16 v[4:7], v[96:99], a[44:47], v[4:7]
    v_mfma_f32_16x16x32_bf16 v[8:11], v[100:103], a[44:47], v[8:11]
    v_mfma_f32_16x16x32_bf16 v[12:15], v[104:107], a[44:47], v[12:15]
    v_mfma_f32_16x16x32_bf16 v[16:19], v[108:111], a[44:47], v[16:19]
    s_waitcnt vmcnt(11)
    v_mfma_f32_16x16x32_bf16 v[0:3], v[112:115], a[48:51], v[0:3]
    buffer_load_dwordx4 a[44:47], v188, s[32:35], s62 offen offset:3072 sc1
    v_mfma_f32_16x16x32_bf16 v[4:7], v[116:119], a[48:51], v[4:7]
    v_mfma_f32_16x16x32_bf16 v[8:11], v[120:123], a[48:51], v[8:11]
    v_mfma_f32_16x16x32_bf16 v[12:15], v[124:127], a[48:51], v[12:15]
    v_mfma_f32_16x16x32_bf16 v[16:19], a[0:3], a[48:51], v[16:19]
    s_waitcnt vmcnt(11)
    s_add_u32 s62, s51, s14
    v_mfma_f32_16x16x32_bf16 v[0:3], a[4:7], a[52:55], v[0:3]
    buffer_load_dwordx2 a[48:49], v20, s[32:35], s62 offen sc1
    v_mfma_f32_16x16x32_bf16 v[4:7], a[8:11], a[52:55], v[4:7]
    buffer_load_dwordx2 a[50:51], v20, s[32:35], s62 offen offset:128 sc1
    v_mfma_f32_16x16x32_bf16 v[8:11], a[12:15], a[52:55], v[8:11]
    v_cmp_le_u32 vcc, 1, v22
    v_mfma_f32_16x16x32_bf16 v[12:15], a[16:19], a[52:55], v[12:15]
    s_andn2_b32 s84, 0xc, vcc_lo
    s_cbranch_scc1 L_retry79
L_ok79:
    v_mfma_f32_16x16x32_bf16 v[16:19], a[20:23], a[52:55], v[16:19]
    s_waitcnt vmcnt(12)
    s_mul_i32 s51, s5, 69632
    v_mfma_f32_16x16x32_bf16 v[0:3], a[24:27], a[56:59], v[0:3]
    v_cmp_le_u32 s[22:23], 1, v22
    v_mfma_f32_16x16x32_bf16 v[4:7], a[28:31], a[56:59], v[4:7]
    s_andn2_b32 s84, 0xff, s22
    s_cbranch_scc1 L_ps80
L_pr80:
    v_mfma_f32_16x16x32_bf16 v[8:11], a[144:147], a[56:59], v[8:11]
    s_lshl_b32 s62, s5, 6
    v_mfma_f32_16x16x32_bf16 v[12:15], a[148:151], a[56:59], v[12:15]
    buffer_load_dword v26, v24, s[64:67], s62 offen sc1
    v_mfma_f32_16x16x32_bf16 v[16:19], a[152:155], a[56:59], v[16:19]
    s_waitcnt vmcnt(12)
    s_add_u32 s62, s51, s13
    v_mfma_f32_16x16x32_bf16 v[0:3], a[156:159], a[60:63], v[0:3]
    buffer_load_dwordx4 a[52:55], v188, s[32:35], s62 offen offset:0 sc1
    v_mfma_f32_16x16x32_bf16 v[4:7], a[160:163], a[60:63], v[4:7]
    buffer_load_dwordx4 a[56:59], v188, s[32:35], s62 offen offset:1024 sc1
    v_mfma_f32_16x16x32_bf16 v[8:11], a[164:167], a[60:63], v[8:11]
    s_waitcnt vmcnt(9)
    v_mul_f32 v128, v25, v128
    v_mul_f32 v129, v25, v129
    v_mfma_f32_16x16x32_bf16 v[12:15], a[168:171], a[60:63], v[12:15]
    v_mul_f32 v130, v25, v130
    v_mul_f32 v131, v25, v131
    v_mfma_f32_16x16x32_bf16 v[16:19], a[172:175], a[60:63], v[16:19]
    v_mul_f32 v132, v25, v132
    v_mul_f32 v133, v25, v133
    v_mfma_f32_16x16x32_bf16 v[0:3], a[176:179], a[64:67], v[0:3]
    buffer_load_dwordx4 a[60:63], v188, s[32:35], s62 offen offset:2048 sc1
    v_mfma_f32_16x16x32_bf16 v[4:7], a[180:183], a[64:67], v[4:7]
    v_mul_f32 v134, v25, v134
    v_mul_f32 v135, v25, v135
    v_mfma_f32_16x16x32_bf16 v[8:11], a[184:187], a[64:67], v[8:11]
    v_mul_f32 v136, v25, v136
    v_mul_f32 v137, v25, v137
    v_mfma_f32_16x16x32_bf16 v[12:15], a[188:191], a[64:67], v[12:15]
    v_mul_f32 v138, v25, v138
    v_mul_f32 v139, v25, v139
    v_mfma_f32_16x16x32_bf16 v[16:19], a[192:195], a[64:67], v[16:19]
    v_mul_f32 v140, v25, v140
    v_mul_f32 v141, v25, v141
    v_mfma_f32_16x16x32_bf16 v[0:3], a[196:199], a[68:71], v[0:3]
    buffer_load_dwordx4 a[64:67], v188, s[32:35], s62 offen offset:3072 sc1
    v_mfma_f32_16x16x32_bf16 v[4:7], a[200:203], a[68:71], v[4:7]
    v_mul_f32 v142, v25, v142
    v_mul_f32 v143, v25, v143
    v_mfma_f32_16x16x32_bf16 v[8:11], a[204:207], a[68:71], v[8:11]
    v_mul_f32 v144, v25, v144
    v_mul_f32 v145, v25, v145
    v_mfma_f32_16x16x32_bf16 v[12:15], a[208:211], a[68:71], v[12:15]
    v_mul_f32 v146, v25, v146
    v_mul_f32 v147, v25, v147
    v_mfma_f32_16x16x32_bf16 v[16:19], a[212:215], a[68:71], v[16:19]
    s_add_u32 s62, s51, s14
    v_mfma_f32_16x16x32_bf16 v[0:3], a[216:219], a[72:75], v[0:3]
    buffer_load_dwordx2 a[68:69], v20, s[32:35], s62 offen sc1
    v_mfma_f32_16x16x32_bf16 v[4:7], a[220:223], a[72:75], v[4:7]
    buffer_load_dwordx2 a[70:71], v20, s[32:35], s62 offen offset:128 sc1
    v_mfma_f32_16x16x32_bf16 v[8:11], a[224:227], a[72:75], v[8:11]
    v_cmp_le_u32 vcc, 1, v22
    v_mfma_f32_16x16x32_bf16 v[12:15], a[228:231], a[72:75], v[12:15]
    s_andn2_b32 s84, 0x30, vcc_lo
    s_cbranch_scc1 L_retry81
L_ok81:
    v_mfma_f32_16x16x32_bf16 v[16:19], a[232:235], a[72:75], v[16:19]
    s_mul_i32 s51, s6, 69632
    v_mfma_f32_16x16x32_bf16 v[0:3], a[236:239], a[76:79], v[0:3]
    v_cmp_le_u32 s[22:23], 1, v22
    v_mfma_f32_16x16x32_bf16 v[4:7], a[240:243], a[76:79], v[4:7]
    s_andn2_b32 s84, 0xff, s22
    s_cbranch_scc1 L_ps82
L_pr82:
    v_mfma_f32_16x16x32_bf16 v[8:11], a[244:247], a[76:79], v[8:11]
    s_lshl_b32 s62, s6, 6
    v_mfma_f32_16x16x32_bf16 v[12:15], a[248:251], a[76:79], v[12:15]
    buffer_load_dword v27, v24, s[64:67], s62 offen sc1
    v_mfma_f32_16x16x32_bf16 v[16:19], a[252:255], a[76:79], v[16:19]
    s_waitcnt vmcnt(13)
    s_add_u32 s62, s51, s13
    v_mfma_f32_16x16x32_bf16 v[128:131], a[96:99], a[32:35], v[128:131]
    buffer_load_dwordx4 a[72:75], v188, s[32:35], s62 offen offset:0 sc1
    v_mfma_f32_16x16x32_bf16 v[132:135], a[100:103], a[32:35], v[132:135]
    buffer_load_dwordx4 a[76:79], v188, s[32:35], s62 offen offset:1024 sc1
    v_mfma_f32_16x16x32_bf16 v[136:139], a[104:107], a[32:35], v[136:139]
    s_waitcnt vmcnt(9)
    v_mul_f32 v148, v26, v148
    v_mul_f32_e64 v149, v26, v149
    v_mfma_f32_16x16x32_bf16 v[140:143], a[108:111], a[32:35], v[140:143]
    v_mul_f32 v150, v26, v150
    v_mul_f32 v151, v26, v151
    v_mfma_f32_16x16x32_bf16 v[144:147], a[112:115], a[32:35], v[144:147]
    v_mul_f32 v152, v26, v152
    v_mul_f32 v153, v26, v153
    v_mfma_f32_16x16x32_bf16 v[128:131], a[116:119], a[36:39], v[128:131]
    buffer_load_dwordx4 a[32:35], v188, s[32:35], s62 offen offset:2048 sc1
    v_mfma_f32_16x16x32_bf16 v[132:135], a[120:123], a[36:39], v[132:135]
    v_mul_f32 v154, v26, v154
    v_mul_f32 v155, v26, v155
    v_mfma_f32_16x16x32_bf16 v[136:139], a[124:127], a[36:39], v[136:139]
    v_mul_f32 v156, v26, v156
    v_mul_f32 v157, v26, v157
    v_mfma_f32_16x16x32_bf16 v[140:143], a[128:131], a[36:39], v[140:143]
    v_mul_f32 v158, v26, v158
    v_mul_f32 v159, v26, v159
    v_mfma_f32_16x16x32_bf16 v[144:147], a[132:135], a[36:39], v[144:147]
    v_mul_f32 v160, v26, v160
    v_mul_f32 v161, v26, v161
    v_mfma_f32_16x16x32_bf16 v[128:131], a[136:139], a[40:43], v[128:131]
    buffer_load_dwordx4 a[36:39], v188, s[32:35], s62 offen offset:3072 sc1
    v_mfma_f32_16x16x32_bf16 v[132:135], a[140:143], a[40:43], v[132:135]
    v_mul_f32 v162, v26, v162
    v_mul_f32 v163, v26, v163
    v_mfma_f32_16x16x32_bf16 v[136:139], a[80:83], a[40:43], v[136:139]
    v_mul_f32 v164, v26, v164
    v_mul_f32 v165, v26, v165
    v_mfma_f32_16x16x32_bf16 v[140:143], a[84:87], a[40:43], v[140:143]
    v_mul_f32 v166, v26, v166
    v_mul_f32 v167, v26, v167
    v_mfma_f32_16x16x32_bf16 v[144:147], a[88:91], a[40:43], v[144:147]
    s_add_u32 s62, s51, s14
    v_mfma_f32_16x16x32_bf16 v[128:131], a[92:95], a[44:47], v[128:131]
    buffer_load_dwordx2 a[40:41], v20, s[32:35], s62 offen sc1
    v_mfma_f32_16x16x32_bf16 v[132:135], v[192:195], a[44:47], v[132:135]
    buffer_load_dwordx2 a[42:43], v20, s[32:35], s62 offen offset:128 sc1
    v_mfma_f32_16x16x32_bf16 v[136:139], v[196:199], a[44:47], v[136:139]
    v_cmp_le_u32 vcc, 1, v22
    v_mfma_f32_16x16x32_bf16 v[140:143], v[200:203], a[44:47], v[140:143]
    s_andn2_b32 s84, 0xc0, vcc_lo
    s_cbranch_scc1 L_retry83
L_ok83:
    v_mfma_f32_16x16x32_bf16 v[144:147], v[204:207], a[44:47], v[144:147]
    s_mul_i32 s51, s7, 69632
    v_mfma_f32_16x16x32_bf16 v[128:131], v[208:211], a[48:51], v[128:131]
    s_lshl_b32 s62, s7, 6
    v_mfma_f32_16x16x32_bf16 v[132:135], v[212:215], a[48:51], v[132:135]
    buffer_load_dword v25, v24, s[64:67], s62 offen sc1
    v_mfma_f32_16x16x32_bf16 v[136:139], v[216:219], a[48:51], v[136:139]
    s_add_u32 s62, s51, s13
    v_mfma_f32_16x16x32_bf16 v[140:143], v[220:223], a[48:51], v[140:143]
    buffer_load_dwordx4 a[44:47], v188, s[32:35], s62 offen offset:0 sc1
    v_mfma_f32_16x16x32_bf16 v[144:147], v[224:227], a[48:51], v[144:147]
    s_waitcnt vmcnt(14)
    v_mfma_f32_16x16x32_bf16 v[148:151], a[96:99], a[52:55], v[148:151]
    buffer_load_dwordx4 a[48:51], v188, s[32:35], s62 offen offset:1024 sc1
    v_mfma_f32_16x16x32_bf16 v[152:155], a[100:103], a[52:55], v[152:155]
    ds_write_b128 v28, v[128:131] offset:0
    v_mfma_f32_16x16x32_bf16 v[156:159], a[104:107], a[52:55], v[156:159]
    s_waitcnt vmcnt(9)
    v_mul_f32 v228, v27, v228
    v_mul_f32_e64 v229, v27, v229
    v_mfma_f32_16x16x32_bf16 v[160:163], a[108:111], a[52:55], v[160:163]
    v_mul_f32 v230, v27, v230
    v_mul_f32 v231, v27, v231
    v_mfma_f32_16x16x32_bf16 v[164:167], a[112:115], a[52:55], v[164:167]
    v_mul_f32 v232, v27, v232
    v_mul_f32 v233, v27, v233
    v_mfma_f32_16x16x32_bf16 v[148:151], a[116:119], a[56:59], v[148:151]
    buffer_load_dwordx4 a[52:55], v188, s[32:35], s62 offen offset:2048 sc1
    v_mfma_f32_16x16x32_bf16 v[152:155], a[120:123], a[56:59], v[152:155]
    ds_write_b128 v28, v[132:135] offset:32
    v_mfma_f32_16x16x32_bf16 v[156:159], a[124:127], a[56:59], v[156:159]
    v_mul_f32 v234, v27, v234
    v_mul_f32 v235, v27, v235
    v_mfma_f32_16x16x32_bf16 v[160:163], a[128:131], a[56:59], v[160:163]
    v_mul_f32 v236, v27, v236
    v_mul_f32 v237, v27, v237
    v_mfma_f32_16x16x32_bf16 v[164:167], a[132:135], a[56:59], v[164:167]
    v_mul_f32 v238, v27, v238
    v_mul_f32 v239, v27, v239
    v_mfma_f32_16x16x32_bf16 v[148:151], a[136:139], a[60:63], v[148:151]
    buffer_load_dwordx4 a[56:59], v188, s[32:35], s62 offen offset:3072 sc1
    v_mfma_f32_16x16x32_bf16 v[152:155], a[140:143], a[60:63], v[152:155]
    ds_write_b128 v28, v[136:139] offset:64
    v_mfma_f32_16x16x32_bf16 v[156:159], a[80:83], a[60:63], v[156:159]
    v_mul_f32 v240, v27, v240
    v_mul_f32 v241, v27, v241
    v_mfma_f32_16x16x32_bf16 v[160:163], a[84:87], a[60:63], v[160:163]
    v_mul_f32 v242, v27, v242
    v_mul_f32 v243, v27, v243
    v_mfma_f32_16x16x32_bf16 v[164:167], a[88:91], a[60:63], v[164:167]
    s_add_u32 s62, s51, s14
    v_mul_f32 v244, v27, v244
    v_mfma_f32_16x16x32_bf16 v[148:151], a[92:95], a[64:67], v[148:151]
    buffer_load_dwordx2 a[60:61], v20, s[32:35], s62 offen sc1
    v_mfma_f32_16x16x32_bf16 v[152:155], v[192:195], a[64:67], v[152:155]
    buffer_load_dwordx2 a[62:63], v20, s[32:35], s62 offen offset:128 sc1
    v_mfma_f32_16x16x32_bf16 v[156:159], v[196:199], a[64:67], v[156:159]
    ds_write_b128 v28, v[140:143] offset:96
    v_mfma_f32_16x16x32_bf16 v[160:163], v[200:203], a[64:67], v[160:163]
    v_mul_f32 v245, v27, v245
    v_mul_f32 v246, v27, v246
    v_mfma_f32_16x16x32_bf16 v[164:167], v[204:207], a[64:67], v[164:167]
    v_mul_f32_e64 v247, v27, v247
    v_mfma_f32_16x16x32_bf16 v[148:151], v[208:211], a[68:71], v[148:151]
    ds_write_b128 v28, v[144:147] offset:128
    v_mfma_f32_16x16x32_bf16 v[152:155], v[212:215], a[68:71], v[152:155]
    v_mfma_f32_16x16x32_bf16 v[156:159], v[216:219], a[68:71], v[156:159]
    v_mfma_f32_16x16x32_bf16 v[160:163], v[220:223], a[68:71], v[160:163]
    s_waitcnt lgkmcnt(0)
    s_barrier
    v_mfma_f32_16x16x32_bf16 v[164:167], v[224:227], a[68:71], v[164:167]
    s_waitcnt vmcnt(12)
    ds_read_b128 v[128:131], v30 offset:0
    v_mfma_f32_16x16x32_bf16 v[228:231], a[96:99], a[72:75], v[228:231]
    ds_read_b128 v[132:135], v30 offset:5376
    v_mfma_f32_16x16x32_bf16 v[232:235], a[100:103], a[72:75], v[232:235]
    ds_write_b128 v28, v[148:151] offset:21760
    v_mfma_f32_16x16x32_bf16 v[236:239], a[104:107], a[72:75], v[236:239]
    s_waitcnt vmcnt(6)
    v_mul_f32 v0, v25, v0
    v_mul_f32 v1, v25, v1
    v_mfma_f32_16x16x32_bf16 v[240:243], a[108:111], a[72:75], v[240:243]
    v_mul_f32 v2, v25, v2
    v_mul_f32 v3, v25, v3
    v_mfma_f32_16x16x32_bf16 v[244:247], a[112:115], a[72:75], v[244:247]
    v_mul_f32 v4, v25, v4
    v_mul_f32 v5, v25, v5
    v_mfma_f32_16x16x32_bf16 v[228:231], a[116:119], a[76:79], v[228:231]
    ds_write_b128 v28, v[152:155] offset:21792
    v_mfma_f32_16x16x32_bf16 v[232:235], a[120:123], a[76:79], v[232:235]
    v_mul_f32 v6, v25, v6
    v_mul_f32 v7, v25, v7
    v_mfma_f32_16x16x32_bf16 v[236:239], a[124:127], a[76:79], v[236:239]
    v_mul_f32 v8, v25, v8
    v_mul_f32 v9, v25, v9
    v_mfma_f32_16x16x32_bf16 v[240:243], a[128:131], a[76:79], v[240:243]
    ds_write_b128 v28, v[156:159] offset:21824
    v_mfma_f32_16x16x32_bf16 v[244:247], a[132:135], a[76:79], v[244:247]
    v_mul_f32 v10, v25, v10
    v_mul_f32 v11, v25, v11
    v_mfma_f32_16x16x32_bf16 v[228:231], a[136:139], a[32:35], v[228:231]
    v_mul_f32 v12, v25, v12
    v_mul_f32 v13, v25, v13
    v_mfma_f32_16x16x32_bf16 v[232:235], a[140:143], a[32:35], v[232:235]
    ds_write_b128 v28, v[160:163] offset:21856
    v_mfma_f32_16x16x32_bf16 v[236:239], a[80:83], a[32:35], v[236:239]
    v_mul_f32 v14, v25, v14
    v_mul_f32 v15, v25, v15
    v_mfma_f32_16x16x32_bf16 v[240:243], a[84:87], a[32:35], v[240:243]
    v_mul_f32 v16, v25, v16
    v_mul_f32 v17, v25, v17
    v_mfma_f32_16x16x32_bf16 v[244:247], a[88:91], a[32:35], v[244:247]
    v_mul_f32 v18, v25, v18
    v_mul_f32 v19, v25, v19
    v_mfma_f32_16x16x32_bf16 v[228:231], a[92:95], a[36:39], v[228:231]
    ds_write_b128 v28, v[164:167] offset:21888
    v_mfma_f32_16x16x32_bf16 v[232:235], v[192:195], a[36:39], v[232:235]
    ds_read_b128 v[136:139], v30 offset:10752
    v_mfma_f32_16x16x32_bf16 v[236:239], v[196:199], a[36:39], v[236:239]
    ds_read_b128 v[140:143], v30 offset:16128
    v_mfma_f32_16x16x32_bf16 v[240:243], v[200:203], a[36:39], v[240:243]
    s_waitcnt lgkmcnt(2)
    s_barrier
    v_mfma_f32_16x16x32_bf16 v[244:247], v[204:207], a[36:39], v[244:247]
    ds_read_b128 v[32:35], v30 offset:2624
    v_mfma_f32_16x16x32_bf16 v[228:231], v[208:211], a[40:43], v[228:231]
    ds_read_b128 v[36:39], v30 offset:8000
    v_mfma_f32_16x16x32_bf16 v[232:235], v[212:215], a[40:43], v[232:235]
    ds_read_b128 v[40:43], v30 offset:13376
    v_mfma_f32_16x16x32_bf16 v[236:239], v[216:219], a[40:43], v[236:239]
    ds_read_b128 v[44:47], v30 offset:18752
    v_mfma_f32_16x16x32_bf16 v[240:243], v[220:223], a[40:43], v[240:243]
    v_mfma_f32_16x16x32_bf16 v[244:247], v[224:227], a[40:43], v[244:247]
    s_waitcnt vmcnt(5)
    s_waitcnt lgkmcnt(4)
    v_add_f32 v128, v128, v132
    v_add_f32 v129, v129, v133
    v_mfma_f32_16x16x32_bf16 v[0:3], a[96:99], a[44:47], v[0:3]
    v_add_f32 v130, v130, v134
    v_add_f32 v131, v131, v135
    v_mfma_f32_16x16x32_bf16 v[4:7], a[100:103], a[44:47], v[4:7]
    ds_write_b128 v29, v[228:231] offset:0
    v_mfma_f32_16x16x32_bf16 v[8:11], a[104:107], a[44:47], v[8:11]
    v_add_f32 v136, v136, v140
    v_add_f32 v137, v137, v141
    v_mfma_f32_16x16x32_bf16 v[12:15], a[108:111], a[44:47], v[12:15]
    v_add_f32 v138, v138, v142
    v_add_f32 v139, v139, v143
    v_mfma_f32_16x16x32_bf16 v[16:19], a[112:115], a[44:47], v[16:19]
    s_waitcnt vmcnt(4)
    v_add_f32 v128, v128, v136
    v_add_f32_e64 v129, v129, v137
    v_mfma_f32_16x16x32_bf16 v[0:3], a[116:119], a[48:51], v[0:3]
    ds_write_b128 v29, v[232:235] offset:32
    v_mfma_f32_16x16x32_bf16 v[4:7], a[120:123], a[48:51], v[4:7]
    v_add_f32 v130, v130, v138
    v_add_f32 v131, v131, v139
    v_mfma_f32_16x16x32_bf16 v[8:11], a[124:127], a[48:51], v[8:11]
    v_cvt_pk_bf16_f32 v144, v128, v129
    v_cvt_pk_bf16_f32 v145, v130, v131
    v_mfma_f32_16x16x32_bf16 v[12:15], a[128:131], a[48:51], v[12:15]
    ds_write_b128 v29, v[236:239] offset:64
    v_mfma_f32_16x16x32_bf16 v[16:19], a[132:135], a[48:51], v[16:19]
    s_waitcnt vmcnt(3)
    s_waitcnt lgkmcnt(3)
    v_add_f32 v32, v32, v36
    v_add_f32 v33, v33, v37
    v_mfma_f32_16x16x32_bf16 v[0:3], a[136:139], a[52:55], v[0:3]
    v_add_f32 v34, v34, v38
    v_add_f32 v35, v35, v39
    v_mfma_f32_16x16x32_bf16 v[4:7], a[140:143], a[52:55], v[4:7]
    ds_write_b128 v29, v[240:243] offset:96
    v_mfma_f32_16x16x32_bf16 v[8:11], a[80:83], a[52:55], v[8:11]
    v_add_f32 v40, v40, v44
    v_add_f32 v41, v41, v45
    v_mfma_f32_16x16x32_bf16 v[12:15], a[84:87], a[52:55], v[12:15]
    v_add_f32 v42, v42, v46
    v_add_f32 v43, v43, v47
    v_mfma_f32_16x16x32_bf16 v[16:19], a[88:91], a[52:55], v[16:19]
    s_waitcnt vmcnt(2)
    v_add_f32 v32, v32, v40
    v_add_f32_e64 v33, v33, v41
    v_mfma_f32_16x16x32_bf16 v[0:3], a[92:95], a[56:59], v[0:3]
    ds_write_b128 v29, v[244:247] offset:128
    v_mfma_f32_16x16x32_bf16 v[4:7], v[192:195], a[56:59], v[4:7]
    v_add_f32 v34, v34, v42
    v_add_f32 v35, v35, v43
    v_mfma_f32_16x16x32_bf16 v[8:11], v[196:199], a[56:59], v[8:11]
    v_cvt_pk_bf16_f32 v146, v32, v33
    v_cvt_pk_bf16_f32 v147, v34, v35
    v_mfma_f32_16x16x32_bf16 v[12:15], v[200:203], a[56:59], v[12:15]
    s_waitcnt lgkmcnt(0)
    s_barrier
    v_mfma_f32_16x16x32_bf16 v[16:19], v[204:207], a[56:59], v[16:19]
    s_waitcnt vmcnt(0)
    v_mfma_f32_16x16x32_bf16 v[0:3], v[208:211], a[60:63], v[0:3]
    s_mul_i32 s60, s4, 20480
    s_add_u32 s60, s60, s15
    buffer_store_dwordx4 v[144:147], v23, s[76:79], s60 offen sc1
    v_mfma_f32_16x16x32_bf16 v[4:7], v[212:215], a[60:63], v[4:7]
    ds_read_b128 v[148:151], v30 offset:21760
    v_mfma_f32_16x16x32_bf16 v[8:11], v[216:219], a[60:63], v[8:11]
    ds_read_b128 v[152:155], v30 offset:27136
    v_mfma_f32_16x16x32_bf16 v[12:15], v[220:223], a[60:63], v[12:15]
    ds_read_b128 v[156:159], v30 offset:32512
    v_mfma_f32_16x16x32_bf16 v[16:19], v[224:227], a[60:63], v[16:19]
    ds_read_b128 v[160:163], v30 offset:37888
    ds_read_b128 v[48:51], v30 offset:24384
    ds_read_b128 v[52:55], v30 offset:29760
    ds_read_b128 v[56:59], v30 offset:35136
    ds_read_b128 v[60:63], v30 offset:40512
    s_waitcnt lgkmcnt(4)
    v_add_f32 v148, v148, v152
    v_add_f32 v149, v149, v153
    v_add_f32 v150, v150, v154
    v_add_f32 v151, v151, v155
    v_add_f32 v156, v156, v160
    v_add_f32 v157, v157, v161
    v_add_f32 v158, v158, v162
    v_add_f32_e64 v159, v159, v163
    ds_write_b128 v29, v[0:3] offset:21760
    v_add_f32 v148, v148, v156
    v_add_f32 v149, v149, v157
    v_add_f32 v150, v150, v158
    v_add_f32 v151, v151, v159
    v_cvt_pk_bf16_f32 v164, v148, v149
    ds_write_b128 v29, v[4:7] offset:21792
    v_cvt_pk_bf16_f32 v165, v150, v151
    s_waitcnt lgkmcnt(2)
    v_add_f32 v48, v48, v52
    v_add_f32 v49, v49, v53
    v_add_f32 v50, v50, v54
    v_add_f32_e64 v51, v51, v55
    ds_write_b128 v29, v[8:11] offset:21824
    v_add_f32 v56, v56, v60
    v_add_f32 v57, v57, v61
    v_add_f32 v58, v58, v62
    v_add_f32 v59, v59, v63
    v_add_f32_e64 v48, v48, v56
    ds_write_b128 v29, v[12:15] offset:21856
    v_add_f32 v49, v49, v57
    v_add_f32 v50, v50, v58
    v_add_f32_e64 v51, v51, v59
    v_cvt_pk_bf16_f32 v166, v48, v49
    ds_write_b128 v29, v[16:19] offset:21888
    s_waitcnt lgkmcnt(0)
    s_barrier
    ds_read_b128 v[0:3], v31 offset:21760
    ds_read_b128 v[4:7], v31 offset:27136
    ds_read_b128 v[8:11], v31 offset:32512
    ds_read_b128 v[12:15], v31 offset:37888
    ds_read_b128 v[80:83], v31 offset:24384
    ds_read_b128 v[84:87], v31 offset:29760
    ds_read_b128 v[88:91], v31 offset:35136
    ds_read_b128 v[92:95], v31 offset:40512
    v_cvt_pk_bf16_f32 v167, v50, v51
    s_mul_i32 s60, s5, 20480
    s_add_u32 s60, s60, s15
    buffer_store_dwordx4 v[164:167], v23, s[76:79], s60 offen sc1
    ds_read_b128 v[228:231], v31 offset:0
    ds_read_b128 v[232:235], v31 offset:5376
    ds_read_b128 v[236:239], v31 offset:10752
    ds_read_b128 v[240:243], v31 offset:16128
    ds_read_b128 v[64:67], v31 offset:2624
    ds_read_b128 v[68:71], v31 offset:8000
    ds_read_b128 v[72:75], v31 offset:13376
    ds_read_b128 v[76:79], v31 offset:18752
    s_waitcnt lgkmcnt(4)
    v_add_f32 v228, v228, v232
    v_add_f32 v229, v229, v233
    v_add_f32 v230, v230, v234
    v_add_f32 v231, v231, v235
    v_add_f32 v236, v236, v240
    v_add_f32 v237, v237, v241
    v_add_f32 v238, v238, v242
    v_add_f32 v239, v239, v243
    v_add_f32 v228, v228, v236
    v_add_f32 v229, v229, v237
    v_add_f32 v230, v230, v238
    v_add_f32 v231, v231, v239
    v_cvt_pk_bf16_f32 v244, v228, v229
    v_cvt_pk_bf16_f32 v245, v230, v231
    s_waitcnt lgkmcnt(0)
    v_add_f32 v64, v64, v68
    v_add_f32 v65, v65, v69
    v_add_f32 v66, v66, v70
    v_add_f32 v67, v67, v71
    v_add_f32 v72, v72, v76
    v_add_f32 v73, v73, v77
    v_add_f32 v74, v74, v78
    v_add_f32 v75, v75, v79
    v_add_f32 v64, v64, v72
    v_add_f32 v65, v65, v73
    v_add_f32 v66, v66, v74
    v_add_f32_e64 v67, v67, v75
    v_cvt_pk_bf16_f32 v246, v64, v65
    v_cvt_pk_bf16_f32 v247, v66, v67
    s_mul_i32 s60, s6, 20480
    s_add_u32 s60, s60, s15
    buffer_store_dwordx4 v[244:247], v23, s[76:79], s60 offen sc1
    v_pk_add_f32 v[0:1], v[0:1], v[4:5]
    v_pk_add_f32 v[2:3], v[2:3], v[6:7]
    v_pk_add_f32 v[8:9], v[8:9], v[12:13]
    v_pk_add_f32 v[10:11], v[10:11], v[14:15]
    v_pk_add_f32 v[0:1], v[0:1], v[8:9]
    v_pk_add_f32 v[2:3], v[2:3], v[10:11]
    v_cvt_pk_bf16_f32 v16, v0, v1
    v_cvt_pk_bf16_f32 v17, v2, v3
    v_pk_add_f32 v[80:81], v[80:81], v[84:85]
    v_pk_add_f32 v[82:83], v[82:83], v[86:87]
    v_pk_add_f32 v[88:89], v[88:89], v[92:93]
    v_pk_add_f32 v[90:91], v[90:91], v[94:95]
    v_pk_add_f32 v[80:81], v[80:81], v[88:89]
    v_pk_add_f32 v[82:83], v[82:83], v[90:91]
    v_cvt_pk_bf16_f32 v18, v80, v81
    v_cvt_pk_bf16_f32 v19, v82, v83
    s_mul_i32 s60, s7, 20480
    s_add_u32 s60, s60, s15
    buffer_store_dwordx4 v[16:19], v23, s[76:79], s60 offen sc1
    s_endpgm
L_ps76:
    buffer_load_dword v22, v21, s[68:71], 0 offen sc1
    s_branch L_pr76
L_ps78:
    buffer_load_dword v22, v21, s[68:71], 0 offen sc1
    s_branch L_pr78
L_ps80:
    buffer_load_dword v22, v21, s[68:71], 0 offen sc1
    s_branch L_pr80
L_ps82:
    buffer_load_dword v22, v21, s[68:71], 0 offen sc1
    s_branch L_pr82
L_retry66:
    s_mov_b32 s85, 0x8000
L_spin66:
    s_waitcnt vmcnt(0)
    v_cmp_le_u32_e64 vcc, 20, v191
    s_sub_u32 s85, s85, 1
    s_cbranch_scc1 L_ok66
    s_andn2_b32 s84, 0x2, vcc_lo
    s_cbranch_scc0 L_ok66
    s_cmp_eq_u32 s85, 0x7fff
    s_cbranch_scc1 L_nosl66
    s_sleep 8
L_nosl66:
    buffer_load_dword v191, v190, s[72:75], 0 offen sc1
    s_branch L_spin66
L_retry67:
    s_mov_b32 s85, 0x8000
L_spin67:
    s_waitcnt vmcnt(0)
    v_cmp_le_u32_e64 vcc, 20, v191
    s_sub_u32 s85, s85, 1
    s_cbranch_scc1 L_ok67
    s_andn2_b32 s84, 0x4, vcc_lo
    s_cbranch_scc0 L_ok67
    s_cmp_eq_u32 s85, 0x7fff
    s_cbranch_scc1 L_nosl67
    s_sleep 8
L_nosl67:
    buffer_load_dword v191, v190, s[72:75], 0 offen sc1
    s_branch L_spin67
L_retry71:
    s_waitcnt vmcnt(0)
    s_mov_b64 exec, 1
    v_mov_b32 v187, s19
    ds_or_rtn_b32 v187, v180, v187 offset:12
    s_mov_b64 exec, -1
    s_waitcnt lgkmcnt(0)
    v_readfirstlane_b32 s84, v187
    v_mov_b32_e64 v187, 4
    s_or_b32 s84, s84, s19
    s_cmp_lg_u32 s84, 15
    s_cbranch_scc1 L_pb84
    buffer_store_dword v187, v189, s[68:71], s18 offen offset:384 sc1
    L_pb84:
    s_mov_b32 s85, 0x8000
L_spin71:
    s_waitcnt vmcnt(0)
    v_cmp_le_u32 vcc, 1, v191
    s_sub_u32 s85, s85, 1
    s_cbranch_scc1 L_ok71
    s_andn2_b32 s84, 0x7, vcc_lo
    s_cbranch_scc0 L_ok71
    s_cmp_eq_u32 s85, 0x7fff
    s_cbranch_scc1 L_nosl71
    s_sleep 8
L_nosl71:
    buffer_load_dword v191, v190, s[68:71], s45 offen sc1
    s_branch L_spin71
L_retry73:
    s_mov_b32 s85, 0x8000
L_spin73:
    s_waitcnt vmcnt(0)
    v_cmp_le_u32_e64 vcc, 1, v191
    s_sub_u32 s85, s85, 1
    s_cbranch_scc1 L_ok73
    s_andn2_b32 s84, 0x7, vcc_lo
    s_cbranch_scc0 L_ok73
    s_cmp_eq_u32 s85, 0x7fff
    s_cbranch_scc1 L_nosl73
    s_sleep 8
L_nosl73:
    buffer_load_dword v191, v190, s[68:71], s46 offen sc1
    s_branch L_spin73
L_retry74:
    s_mov_b32 s85, 0x8000
L_spin74:
    s_waitcnt vmcnt(0)
    v_cmp_le_u32_e64 vcc, 1, v191
    s_sub_u32 s85, s85, 1
    s_cbranch_scc1 L_ok74
    s_andn2_b32 s84, 0x7, vcc_lo
    s_cbranch_scc0 L_ok74
    s_cmp_eq_u32 s85, 0x7fff
    s_cbranch_scc1 L_nosl74
    s_sleep 8
L_nosl74:
    buffer_load_dword v191, v190, s[68:71], s47 offen sc1
    s_branch L_spin74
L_retry75:
    s_mov_b32 s85, 0x8000
L_spin75:
    s_waitcnt vmcnt(0)
    v_cmp_le_u32_e64 vcc, 1, v191
    s_sub_u32 s85, s85, 1
    s_cbranch_scc1 L_ok75
    s_andn2_b32 s84, 0x7, vcc_lo
    s_cbranch_scc0 L_ok75
    s_cmp_eq_u32 s85, 0x7fff
    s_cbranch_scc1 L_nosl75
    s_sleep 8
L_nosl75:
    buffer_load_dword v191, v190, s[68:71], s48 offen sc1
    s_branch L_spin75
L_retry77:
    s_mov_b32 s85, 0x8000
L_spin77:
    s_waitcnt vmcnt(0)
    v_cmp_le_u32_e64 vcc, 1, v22
    s_sub_u32 s85, s85, 1
    s_cbranch_scc1 L_ok77
    s_andn2_b32 s84, 0x3, vcc_lo
    s_cbranch_scc0 L_ok77
    s_cmp_eq_u32 s85, 0x7fff
    s_cbranch_scc1 L_nosl77
    s_sleep 8
L_nosl77:
    buffer_load_dword v22, v21, s[68:71], 0 offen sc1
    s_branch L_spin77
L_retry79:
    s_mov_b32 s85, 0x8000
L_spin79:
    s_waitcnt vmcnt(0)
    v_cmp_le_u32_e64 vcc, 1, v22
    s_sub_u32 s85, s85, 1
    s_cbranch_scc1 L_ok79
    s_andn2_b32 s84, 0xc, vcc_lo
    s_cbranch_scc0 L_ok79
    s_cmp_eq_u32 s85, 0x7fff
    s_cbranch_scc1 L_nosl79
    s_sleep 8
L_nosl79:
    buffer_load_dword v22, v21, s[68:71], 0 offen sc1
    s_branch L_spin79
L_retry81:
    s_mov_b32 s85, 0x8000
L_spin81:
    s_waitcnt vmcnt(0)
    v_cmp_le_u32_e64 vcc, 1, v22
    s_sub_u32 s85, s85, 1
    s_cbranch_scc1 L_ok81
    s_andn2_b32 s84, 0x30, vcc_lo
    s_cbranch_scc0 L_ok81
    s_cmp_eq_u32 s85, 0x7fff
    s_cbranch_scc1 L_nosl81
    s_sleep 8
L_nosl81:
    buffer_load_dword v22, v21, s[68:71], 0 offen sc1
    s_branch L_spin81
L_retry83:
    s_mov_b32 s85, 0x8000
L_spin83:
    s_waitcnt vmcnt(0)
    v_cmp_le_u32_e64 vcc, 1, v22
    s_sub_u32 s85, s85, 1
    s_cbranch_scc1 L_ok83
    s_andn2_b32 s84, 0xc0, vcc_lo
    s_cbranch_scc0 L_ok83
    s_cmp_eq_u32 s85, 0x7fff
    s_cbranch_scc1 L_nosl83
    s_sleep 8
L_nosl83:
    buffer_load_dword v22, v21, s[68:71], 0 offen sc1
    s_branch L_spin83
L_exit:
    s_endpgm
CODE_END:
    s_endpgm
.section .rodata,"a"
.p2align 6
.amdhsa_kernel gated_mix__sliding_local_dilated__swiglu_ffn__prompt_kernel
  .amdhsa_next_free_vgpr 512
  .amdhsa_next_free_sgpr 102
  .amdhsa_accum_offset 256
  .amdhsa_group_segment_fixed_size 0
  .amdhsa_kernarg_size 88
  .amdhsa_user_sgpr_count 2
  .amdhsa_user_sgpr_kernarg_segment_ptr 1
  .amdhsa_system_sgpr_workgroup_id_x 1
.end_amdhsa_kernel
```
